```python
import torch

def _softmax(x, axis=-1):
    return torch.softmax(x, dim=axis)
def _gelu(x):
    return torch.nn.functional.gelu(x, approximate="tanh")
def _silu(x):
    return torch.nn.functional.silu(x)
def _sigmoid(x):
    return torch.sigmoid(x)
def _layernorm(x, axis=-1, eps=1e-5):
    m = x.mean(dim=axis, keepdim=True)
    v = x.var(dim=axis, keepdim=True, unbiased=False)
    return (x - m) / torch.sqrt(v + eps)
def _scatter_add(tgt, idx, src, axis=0):
    return tgt.clone().index_add_(axis, idx, src)
def _segment_sum(src, seg, n):
    out = torch.zeros((n,) + src.shape[1:], dtype=src.dtype)
    return out.index_add_(0, seg, src)
def _pad(x, pw):
    flat = tuple(v for pair in reversed(pw) for v in pair)
    return torch.nn.functional.pad(x, flat)

kernel_name = 'concat_heads__mha_block_cached__sliding_block_cached__decode'

def setup_inputs():

    _w = (lambda a: (lambda t: t.to(torch.bfloat16) if t.is_floating_point() else t)(torch.as_tensor(a)))
    def _A_setup():
        B, Sq, D = 1, 1, 512
        H, Sk, Dh = 32, 32768, 128
        return {
            "x": _w((lambda *s: torch.randn(*s, dtype=torch.bfloat16) * 0.8)(B, Sq, D)),
            "k_cache": _w((lambda *s: torch.randn(*s, dtype=torch.bfloat16) * 1.6)(B, H, Sk, Dh)),
            "v_cache": _w((lambda *s: torch.randn(*s, dtype=torch.bfloat16) * 0.2)(B, H, Sk, Dh)),
            "wq": _w((lambda *s: torch.randn(*s, dtype=torch.bfloat16) * 1.6)(D, H * Dh) * (D ** -0.5)),
            "wo": _w((lambda *s: torch.randn(*s, dtype=torch.bfloat16) * 0.2)(H * Dh, D) * ((H * Dh) ** -0.5)),
        }
    _A_in = _A_setup()

    def _B_setup():
        B, Sq, D = 1, 1, 512
        Hq, Hkv, Sk, Dh = 32, 8, 32768, 128
        assert Hq % Hkv == 0, (Hq, Hkv)
        return {
            "x": _w((lambda *s: torch.randn(*s, dtype=torch.bfloat16) * 0.8)(B, Sq, D)),
            "k_cache": _w((lambda *s: torch.randn(*s, dtype=torch.bfloat16) * 1.6)(B, Hkv, Sk, Dh)),
            "v_cache": _w((lambda *s: torch.randn(*s, dtype=torch.bfloat16) * 0.2)(B, Hkv, Sk, Dh)),
            "wq": _w((lambda *s: torch.randn(*s, dtype=torch.bfloat16) * 1.6)(D, Hq * Dh) * (D ** -0.5)),
            "wo": _w((lambda *s: torch.randn(*s, dtype=torch.bfloat16) * 0.2)(Hq * Dh, D) * ((Hq * Dh) ** -0.5)),
        }
    _B_in = _B_setup()

    return {
        "A_x": _A_in["x"],
        "A_k_cache": _A_in["k_cache"],
        "A_v_cache": _A_in["v_cache"],
        "A_wq": _A_in["wq"],
        "A_wo": _A_in["wo"],
        "B_x": _B_in["x"],
        "B_k_cache": _B_in["k_cache"],
        "B_v_cache": _B_in["v_cache"],
        "B_wq": _B_in["wq"],
        "B_wo": _B_in["wo"],
    }

def reference(A_x, A_k_cache, A_v_cache, A_wq, A_wo, B_x, B_k_cache, B_v_cache, B_wq, B_wo):
    def _A_ref(x, k_cache, v_cache, wq, wo):
        B, Sq, D = x.shape
        H, Dh = 32, 128
        q = (lambda x, *d: x.permute(*d))((x @ wq).reshape(B, Sq, H, Dh), 0, 2, 1, 3)
        scores = torch.einsum("bhqd,bhkd->bhqk", q, k_cache) * (Dh ** -0.5)
        p = _softmax(scores, axis=-1)
        o = torch.einsum("bhqk,bhkd->bhqd", p, v_cache)
        return (lambda x, *d: x.permute(*d))(o, 0, 2, 1, 3).reshape(B, Sq, H * Dh) @ wo

    def _B_ref(x, k_cache, v_cache, wq, wo):
        B, Sq, D = x.shape
        Hq, Dh = 32, 128
        Hkv, Sk = k_cache.shape[1], k_cache.shape[2]
        W = min(4096, max(256, Sk // 4))
        rep = Hq // Hkv
        q = (lambda x, *d: x.permute(*d))((x @ wq).reshape(B, Sq, Hq, Dh), 0, 2, 1, 3)
        k = (lambda x, n, axis: torch.repeat_interleave(x, n, dim=axis))(k_cache[:, :, Sk - W:, :], rep, axis=1)
        v = (lambda x, n, axis: torch.repeat_interleave(x, n, dim=axis))(v_cache[:, :, Sk - W:, :], rep, axis=1)
        scores = torch.einsum("bhqd,bhkd->bhqk", q, k) * (Dh ** -0.5)
        p = _softmax(scores, axis=-1)
        o = torch.einsum("bhqk,bhkd->bhqd", p, v)
        return (lambda x, *d: x.permute(*d))(o, 0, 2, 1, 3).reshape(B, Sq, Hq * Dh) @ wo

    a = _A_ref(A_x, A_k_cache, A_v_cache, A_wq, A_wo)
    b = _B_ref(B_x, B_k_cache, B_v_cache, B_wq, B_wo)
    return torch.concatenate([a, b], axis=-1)
```

```asm
; @launch grid=(256,1,1) block=(320,1,1) lds=40960
.amdgcn_target "amdgcn-amd-amdhsa--gfx950"
.text
.globl concat_heads__mha_block_cached__sliding_block_cached__decode_kernel
.p2align 8
.type concat_heads__mha_block_cached__sliding_block_cached__decode_kernel,@function
concat_heads__mha_block_cached__sliding_block_cached__decode_kernel:
  s_cmp_ge_u32 s2, 256
  s_cbranch_scc1 L_end
  s_load_dwordx16 s[32:47], s[0:1], 0
  s_load_dwordx8 s[48:55], s[0:1], 64
  s_load_dwordx2 s[56:57], s[0:1], 96
  v_lshrrev_b32 v1, 6, v0
  v_and_b32 v0, 63, v0
  s_nop 0
  v_readfirstlane_b32 s3, v1
  v_and_b32 v1, 15, v0
  v_lshrrev_b32 v2, 4, v0
  v_lshlrev_b32 v3, 8, v1
  v_lshl_add_u32 v3, v2, 4, v3
  v_lshlrev_b32 v4, 10, v2
  v_lshl_add_u32 v4, v1, 4, v4
  s_lshr_b32 s60, s2, 3
  s_and_b32 s61, s2, 7
  s_lshl_b32 s95, s60, 23
  s_mul_i32 s96, s61, 126
  s_mov_b32 s93, 126
  s_mul_i32 s65, s61, 130
  s_add_u32 s65, s65, 4294967280
  s_cmp_ge_u32 s61, 4
  s_cselect_b32 s96, s65, s96
  s_cselect_b32 s93, 130, s93
  s_mul_i32 s65, s61, 112
  s_add_u32 s65, s65, 92
  s_cmp_ge_u32 s61, 6
  s_cselect_b32 s96, s65, s96
  s_cselect_b32 s93, 112, s93
  s_mov_b32 s64, s93
  s_mov_b32 s75, s96
  s_add_u32 s65, s96, s3
  s_lshl_b32 s62, s65, 13
  s_add_u32 s62, s62, s95
  s_waitcnt lgkmcnt(0)
  s_mov_b32 s16, s56
  s_mov_b32 s17, s57
  s_mov_b32 s18, 0x1000000
  s_mov_b32 s19, 0x00020000
  s_cmp_eq_u32 s3, 4
  s_cbranch_scc1 L_service
  s_mov_b32 s4, s34
  s_mov_b32 s5, s35
  s_mov_b32 s6, 0x10000000
  s_mov_b32 s7, 0x00020000
  s_cmp_lt_u32 s61, 4
  s_cbranch_scc1 L_s_prod
  v_lshlrev_b32 v62, 4, v0
  s_cmp_ge_u32 s61, 6
  s_cbranch_scc1 L_s_bwg
  s_add_u32 s89, s62, 4096
  buffer_load_dwordx2 v[64:65], v62, s[4:7], s62 offen offset:0 nt
  buffer_load_dwordx2 v[66:67], v62, s[4:7], s62 offen offset:8 nt
  buffer_load_dwordx2 v[68:69], v62, s[4:7], s62 offen offset:1024 nt
  buffer_load_dwordx2 v[70:71], v62, s[4:7], s62 offen offset:1032 nt
  buffer_load_dwordx2 v[72:73], v62, s[4:7], s62 offen offset:2048 nt
  buffer_load_dwordx2 v[74:75], v62, s[4:7], s62 offen offset:2056 nt
  buffer_load_dwordx2 v[76:77], v62, s[4:7], s62 offen offset:3072 nt
  buffer_load_dwordx2 v[78:79], v62, s[4:7], s62 offen offset:3080 nt
  buffer_load_dwordx4 v[80:83], v62, s[4:7], s89 offen offset:0 nt
  buffer_load_dwordx4 v[84:87], v62, s[4:7], s89 offen offset:1024 nt
  buffer_load_dwordx4 v[88:91], v62, s[4:7], s89 offen offset:2048 nt
  buffer_load_dwordx4 v[92:95], v62, s[4:7], s89 offen offset:3072 nt
  s_add_u32 s62, s62, 32768
  s_add_u32 s89, s62, 4096
  buffer_load_dwordx2 v[96:97], v62, s[4:7], s62 offen offset:0 nt
  buffer_load_dwordx2 v[98:99], v62, s[4:7], s62 offen offset:8 nt
  buffer_load_dwordx2 v[100:101], v62, s[4:7], s62 offen offset:1024 nt
  buffer_load_dwordx2 v[102:103], v62, s[4:7], s62 offen offset:1032 nt
  buffer_load_dwordx2 v[104:105], v62, s[4:7], s62 offen offset:2048 nt
  buffer_load_dwordx2 v[106:107], v62, s[4:7], s62 offen offset:2056 nt
  buffer_load_dwordx2 v[108:109], v62, s[4:7], s62 offen offset:3072 nt
  buffer_load_dwordx2 v[110:111], v62, s[4:7], s62 offen offset:3080 nt
  buffer_load_dwordx4 v[112:115], v62, s[4:7], s89 offen offset:0 nt
  buffer_load_dwordx4 v[116:119], v62, s[4:7], s89 offen offset:1024 nt
  buffer_load_dwordx4 v[120:123], v62, s[4:7], s89 offen offset:2048 nt
  buffer_load_dwordx4 v[124:127], v62, s[4:7], s89 offen offset:3072 nt
  s_add_u32 s62, s62, 32768
  s_add_u32 s89, s62, 4096
  buffer_load_dwordx2 v[128:129], v62, s[4:7], s62 offen offset:0 nt
  buffer_load_dwordx2 v[130:131], v62, s[4:7], s62 offen offset:8 nt
  buffer_load_dwordx2 v[132:133], v62, s[4:7], s62 offen offset:1024 nt
  buffer_load_dwordx2 v[134:135], v62, s[4:7], s62 offen offset:1032 nt
  buffer_load_dwordx2 v[136:137], v62, s[4:7], s62 offen offset:2048 nt
  buffer_load_dwordx2 v[138:139], v62, s[4:7], s62 offen offset:2056 nt
  buffer_load_dwordx2 v[140:141], v62, s[4:7], s62 offen offset:3072 nt
  buffer_load_dwordx2 v[142:143], v62, s[4:7], s62 offen offset:3080 nt
  buffer_load_dwordx4 v[144:147], v62, s[4:7], s89 offen offset:0 nt
  buffer_load_dwordx4 v[148:151], v62, s[4:7], s89 offen offset:1024 nt
  buffer_load_dwordx4 v[152:155], v62, s[4:7], s89 offen offset:2048 nt
  buffer_load_dwordx4 v[156:159], v62, s[4:7], s89 offen offset:3072 nt
  s_add_u32 s62, s62, 32768
  s_add_u32 s89, s62, 4096
  buffer_load_dwordx2 v[160:161], v62, s[4:7], s62 offen offset:0 nt
  buffer_load_dwordx2 v[162:163], v62, s[4:7], s62 offen offset:8 nt
  buffer_load_dwordx2 v[164:165], v62, s[4:7], s62 offen offset:1024 nt
  buffer_load_dwordx2 v[166:167], v62, s[4:7], s62 offen offset:1032 nt
  buffer_load_dwordx2 v[168:169], v62, s[4:7], s62 offen offset:2048 nt
  buffer_load_dwordx2 v[170:171], v62, s[4:7], s62 offen offset:2056 nt
  buffer_load_dwordx2 v[172:173], v62, s[4:7], s62 offen offset:3072 nt
  buffer_load_dwordx2 v[174:175], v62, s[4:7], s62 offen offset:3080 nt
  buffer_load_dwordx4 v[176:179], v62, s[4:7], s89 offen offset:0 nt
  buffer_load_dwordx4 v[180:183], v62, s[4:7], s89 offen offset:1024 nt
  buffer_load_dwordx4 v[184:187], v62, s[4:7], s89 offen offset:2048 nt
  buffer_load_dwordx4 v[188:191], v62, s[4:7], s89 offen offset:3072 nt
  s_add_u32 s62, s62, 32768
  v_and_b32 v50, 1, v1
  v_mov_b32 v51, 0xffff
  v_lshlrev_b32 v50, 4, v50
  v_lshlrev_b32 v51, v50, v51
  v_bfe_u32 v50, v1, 1, 2
  v_cmp_eq_u32 vcc, 0, v50
  s_nop 1
  v_cndmask_b32 v5, 0, v51, vcc
  v_cmp_eq_u32 vcc, 1, v50
  s_nop 1
  v_cndmask_b32 v6, 0, v51, vcc
  v_cmp_eq_u32 vcc, 2, v50
  s_nop 1
  v_cndmask_b32 v7, 0, v51, vcc
  v_cmp_eq_u32 vcc, 3, v50
  s_nop 1
  v_cndmask_b32 v8, 0, v51, vcc
  v_cmp_lt_u32 s[72:73], 7, v1
  s_mov_b32 s58, 0x3e0293ee
  s_mov_b32 s70, 0x01000100
  s_mov_b32 s71, 0x03020302
L_s_join:
  v_mov_b32 v48, 0xff800000
  v_mov_b32 v49, 0
  v_mov_b32 v28, 0
  v_mov_b32 v29, 0
  v_mov_b32 v30, 0
  v_mov_b32 v31, 0
  s_mov_b32 s76, 0
  s_add_u32 s85, s3, 0
  s_mov_b32 s77, 0
  s_add_u32 s86, s3, 4
  s_mov_b32 s78, 0
  s_add_u32 s87, s3, 8
  s_mov_b32 s79, 0
  s_add_u32 s88, s3, 12
  s_mov_b32 s63, 0
  s_mov_b32 s82, -1
  s_mov_b32 s83, 0
  v_lshlrev_b32 v53, 4, v1
  v_lshlrev_b32 v63, 5, v2
  v_mov_b32 v10, 0
  v_mov_b32 v9, 1
  s_barrier
L_s_join2:
  ds_read_b128 v[12:15], v53 offset:4096
  v_lshlrev_b32 v53, 4, v2
  ds_read_b128 v[224:227], v53 offset:4096
  ds_read_b128 v[228:231], v53 offset:4160
  ds_read_b128 v[232:235], v53 offset:4224
  ds_read_b128 v[236:239], v53 offset:4288
  s_mov_b32 s8, s36
  s_mov_b32 s9, s37
  s_mov_b32 s10, 0x10000000
  s_mov_b32 s11, 0x00020000
  s_mov_b32 s20, s34
  s_mov_b32 s21, s35
  s_mov_b32 s22, 0x10000000
  s_mov_b32 s23, 0x00020000
  s_mov_b64 exec, 1
  ds_add_rtn_u32 v11, v10, v9 offset:10304
  s_mov_b64 exec, -1
  s_cmp_lg_u32 s3, 0
  s_cselect_b32 s101, 0, 1
  s_waitcnt lgkmcnt(0)
L_kloop:
  s_cmp_lg_u32 s76, 0
  s_cbranch_scc1 L_sw0
  s_waitcnt vmcnt(40)
  v_dot2_f32_bf16 v16, v64, v12, 0
  v_dot2_f32_bf16 v17, v68, v12, 0
  v_dot2_f32_bf16 v18, v72, v12, 0
  v_dot2_f32_bf16 v19, v76, v12, 0
  v_dot2_f32_bf16 v16, v65, v13, v16
  v_dot2_f32_bf16 v17, v69, v13, v17
  v_dot2_f32_bf16 v18, v73, v13, v18
  v_dot2_f32_bf16 v19, v77, v13, v19
  v_dot2_f32_bf16 v16, v66, v14, v16
  v_dot2_f32_bf16 v17, v70, v14, v17
  v_dot2_f32_bf16 v18, v74, v14, v18
  v_dot2_f32_bf16 v19, v78, v14, v19
  v_dot2_f32_bf16 v16, v67, v15, v16
  v_dot2_f32_bf16 v17, v71, v15, v17
  v_dot2_f32_bf16 v18, v75, v15, v18
  v_dot2_f32_bf16 v19, v79, v15, v19
  s_waitcnt lgkmcnt(0)
  v_readfirstlane_b32 s66, v11
  s_mov_b64 exec, 1
  ds_add_rtn_u32 v11, v10, v9 offset:10304
  s_mov_b64 exec, -1
  s_lshl_b32 s65, s85, 7
  v_add_u32 v54, s65, v63
  s_cmp_lt_u32 s66, s93
  s_cselect_b32 s67, s96, s75
  s_add_u32 s67, s67, s66
  s_sub_u32 s65, s66, s64
  s_add_u32 s68, s65, s96
  s_cmp_lt_u32 s66, s64
  s_cselect_b32 s67, s67, s68
  s_cselect_b32 s85, s66, s65
  s_cselect_b32 s76, 0, 1
  s_cselect_b64 s[4:5], s[34:35], s[36:37]
  s_lshl_b32 s62, s67, 13
  s_add_u32 s62, s62, s95
  s_add_u32 s89, s62, 4096
  buffer_load_dwordx2 v[64:65], v62, s[4:7], s62 offen offset:0 nt
  buffer_load_dwordx2 v[66:67], v62, s[4:7], s62 offen offset:8 nt
  buffer_load_dwordx2 v[68:69], v62, s[4:7], s62 offen offset:1024 nt
  buffer_load_dwordx2 v[70:71], v62, s[4:7], s62 offen offset:1032 nt
  buffer_load_dwordx2 v[72:73], v62, s[4:7], s62 offen offset:2048 nt
  buffer_load_dwordx2 v[74:75], v62, s[4:7], s62 offen offset:2056 nt
  buffer_load_dwordx2 v[76:77], v62, s[4:7], s62 offen offset:3072 nt
  buffer_load_dwordx2 v[78:79], v62, s[4:7], s62 offen offset:3080 nt
  v_add_f32_dpp v16, v16, v16 row_ror:8 row_mask:0xf bank_mask:0xf
  v_add_f32_dpp v17, v17, v17 row_ror:8 row_mask:0xf bank_mask:0xf
  v_add_f32_dpp v18, v18, v18 row_ror:8 row_mask:0xf bank_mask:0xf
  v_add_f32_dpp v19, v19, v19 row_ror:8 row_mask:0xf bank_mask:0xf
  v_add_f32_dpp v16, v16, v16 row_ror:4 row_mask:0xf bank_mask:0xf
  v_add_f32_dpp v17, v17, v17 row_ror:4 row_mask:0xf bank_mask:0xf
  v_add_f32_dpp v18, v18, v18 row_ror:4 row_mask:0xf bank_mask:0xf
  v_add_f32_dpp v19, v19, v19 row_ror:4 row_mask:0xf bank_mask:0xf
  v_add_f32_dpp v16, v16, v16 row_ror:2 row_mask:0xf bank_mask:0xf
  v_add_f32_dpp v17, v17, v17 row_ror:2 row_mask:0xf bank_mask:0xf
  v_add_f32_dpp v18, v18, v18 row_ror:2 row_mask:0xf bank_mask:0xf
  v_add_f32_dpp v19, v19, v19 row_ror:2 row_mask:0xf bank_mask:0xf
  v_add_f32_dpp v16, v16, v16 row_ror:1 row_mask:0xf bank_mask:0xf
  v_add_f32_dpp v17, v17, v17 row_ror:1 row_mask:0xf bank_mask:0xf
  v_add_f32_dpp v18, v18, v18 row_ror:1 row_mask:0xf bank_mask:0xf
  v_add_f32_dpp v19, v19, v19 row_ror:1 row_mask:0xf bank_mask:0xf
  s_waitcnt vmcnt(44)
  v_dot2_f32_bf16 v20, v80, v12, 0
  v_dot2_f32_bf16 v21, v84, v12, 0
  v_dot2_f32_bf16 v22, v88, v12, 0
  v_dot2_f32_bf16 v23, v92, v12, 0
  v_dot2_f32_bf16 v20, v81, v13, v20
  v_dot2_f32_bf16 v21, v85, v13, v21
  v_dot2_f32_bf16 v22, v89, v13, v22
  v_dot2_f32_bf16 v23, v93, v13, v23
  v_dot2_f32_bf16 v20, v82, v14, v20
  v_dot2_f32_bf16 v21, v86, v14, v21
  v_dot2_f32_bf16 v22, v90, v14, v22
  v_dot2_f32_bf16 v23, v94, v14, v23
  v_dot2_f32_bf16 v20, v83, v15, v20
  v_dot2_f32_bf16 v21, v87, v15, v21
  v_dot2_f32_bf16 v22, v91, v15, v22
  v_dot2_f32_bf16 v23, v95, v15, v23
  buffer_load_dwordx4 v[80:83], v62, s[4:7], s89 offen offset:0 nt
  buffer_load_dwordx4 v[84:87], v62, s[4:7], s89 offen offset:1024 nt
  buffer_load_dwordx4 v[88:91], v62, s[4:7], s89 offen offset:2048 nt
  buffer_load_dwordx4 v[92:95], v62, s[4:7], s89 offen offset:3072 nt
  v_add_f32_dpp v20, v20, v20 row_ror:8 row_mask:0xf bank_mask:0xf
  v_add_f32_dpp v21, v21, v21 row_ror:8 row_mask:0xf bank_mask:0xf
  v_add_f32_dpp v22, v22, v22 row_ror:8 row_mask:0xf bank_mask:0xf
  v_add_f32_dpp v23, v23, v23 row_ror:8 row_mask:0xf bank_mask:0xf
  v_add_f32_dpp v20, v20, v20 row_ror:4 row_mask:0xf bank_mask:0xf
  v_add_f32_dpp v21, v21, v21 row_ror:4 row_mask:0xf bank_mask:0xf
  v_add_f32_dpp v22, v22, v22 row_ror:4 row_mask:0xf bank_mask:0xf
  v_add_f32_dpp v23, v23, v23 row_ror:4 row_mask:0xf bank_mask:0xf
  v_add_f32_dpp v20, v20, v20 row_ror:2 row_mask:0xf bank_mask:0xf
  v_add_f32_dpp v21, v21, v21 row_ror:2 row_mask:0xf bank_mask:0xf
  v_add_f32_dpp v22, v22, v22 row_ror:2 row_mask:0xf bank_mask:0xf
  v_add_f32_dpp v23, v23, v23 row_ror:2 row_mask:0xf bank_mask:0xf
  v_add_f32_dpp v20, v20, v20 row_ror:1 row_mask:0xf bank_mask:0xf
  v_add_f32_dpp v21, v21, v21 row_ror:1 row_mask:0xf bank_mask:0xf
  v_add_f32_dpp v22, v22, v22 row_ror:1 row_mask:0xf bank_mask:0xf
  v_add_f32_dpp v23, v23, v23 row_ror:1 row_mask:0xf bank_mask:0xf
  s_mov_b32 exec_lo, 0x00010001
  s_mov_b32 exec_hi, 0x00010001
  ds_write_b128 v54, v[16:19] offset:20480
  ds_write_b128 v54, v[20:23] offset:20496
  s_mov_b64 exec, -1
  s_cmp_lg_u32 s77, 0
  s_cbranch_scc1 L_sw1
  s_waitcnt vmcnt(40)
  v_dot2_f32_bf16 v16, v96, v12, 0
  v_dot2_f32_bf16 v17, v100, v12, 0
  v_dot2_f32_bf16 v18, v104, v12, 0
  v_dot2_f32_bf16 v19, v108, v12, 0
  v_dot2_f32_bf16 v16, v97, v13, v16
  v_dot2_f32_bf16 v17, v101, v13, v17
  v_dot2_f32_bf16 v18, v105, v13, v18
  v_dot2_f32_bf16 v19, v109, v13, v19
  v_dot2_f32_bf16 v16, v98, v14, v16
  v_dot2_f32_bf16 v17, v102, v14, v17
  v_dot2_f32_bf16 v18, v106, v14, v18
  v_dot2_f32_bf16 v19, v110, v14, v19
  v_dot2_f32_bf16 v16, v99, v15, v16
  v_dot2_f32_bf16 v17, v103, v15, v17
  v_dot2_f32_bf16 v18, v107, v15, v18
  v_dot2_f32_bf16 v19, v111, v15, v19
  s_waitcnt lgkmcnt(0)
  v_readfirstlane_b32 s66, v11
  s_mov_b64 exec, 1
  ds_add_rtn_u32 v11, v10, v9 offset:10304
  s_mov_b64 exec, -1
  s_lshl_b32 s65, s86, 7
  v_add_u32 v54, s65, v63
  s_cmp_lt_u32 s66, s93
  s_cselect_b32 s67, s96, s75
  s_add_u32 s67, s67, s66
  s_sub_u32 s65, s66, s64
  s_add_u32 s68, s65, s96
  s_cmp_lt_u32 s66, s64
  s_cselect_b32 s67, s67, s68
  s_cselect_b32 s86, s66, s65
  s_cselect_b32 s77, 0, 1
  s_cselect_b64 s[4:5], s[34:35], s[36:37]
  s_lshl_b32 s62, s67, 13
  s_add_u32 s62, s62, s95
  s_add_u32 s89, s62, 4096
  buffer_load_dwordx2 v[96:97], v62, s[4:7], s62 offen offset:0 nt
  buffer_load_dwordx2 v[98:99], v62, s[4:7], s62 offen offset:8 nt
  buffer_load_dwordx2 v[100:101], v62, s[4:7], s62 offen offset:1024 nt
  buffer_load_dwordx2 v[102:103], v62, s[4:7], s62 offen offset:1032 nt
  buffer_load_dwordx2 v[104:105], v62, s[4:7], s62 offen offset:2048 nt
  buffer_load_dwordx2 v[106:107], v62, s[4:7], s62 offen offset:2056 nt
  buffer_load_dwordx2 v[108:109], v62, s[4:7], s62 offen offset:3072 nt
  buffer_load_dwordx2 v[110:111], v62, s[4:7], s62 offen offset:3080 nt
  v_add_f32_dpp v16, v16, v16 row_ror:8 row_mask:0xf bank_mask:0xf
  v_add_f32_dpp v17, v17, v17 row_ror:8 row_mask:0xf bank_mask:0xf
  v_add_f32_dpp v18, v18, v18 row_ror:8 row_mask:0xf bank_mask:0xf
  v_add_f32_dpp v19, v19, v19 row_ror:8 row_mask:0xf bank_mask:0xf
  v_add_f32_dpp v16, v16, v16 row_ror:4 row_mask:0xf bank_mask:0xf
  v_add_f32_dpp v17, v17, v17 row_ror:4 row_mask:0xf bank_mask:0xf
  v_add_f32_dpp v18, v18, v18 row_ror:4 row_mask:0xf bank_mask:0xf
  v_add_f32_dpp v19, v19, v19 row_ror:4 row_mask:0xf bank_mask:0xf
  v_add_f32_dpp v16, v16, v16 row_ror:2 row_mask:0xf bank_mask:0xf
  v_add_f32_dpp v17, v17, v17 row_ror:2 row_mask:0xf bank_mask:0xf
  v_add_f32_dpp v18, v18, v18 row_ror:2 row_mask:0xf bank_mask:0xf
  v_add_f32_dpp v19, v19, v19 row_ror:2 row_mask:0xf bank_mask:0xf
  v_add_f32_dpp v16, v16, v16 row_ror:1 row_mask:0xf bank_mask:0xf
  v_add_f32_dpp v17, v17, v17 row_ror:1 row_mask:0xf bank_mask:0xf
  v_add_f32_dpp v18, v18, v18 row_ror:1 row_mask:0xf bank_mask:0xf
  v_add_f32_dpp v19, v19, v19 row_ror:1 row_mask:0xf bank_mask:0xf
  s_waitcnt vmcnt(44)
  v_dot2_f32_bf16 v20, v112, v12, 0
  v_dot2_f32_bf16 v21, v116, v12, 0
  v_dot2_f32_bf16 v22, v120, v12, 0
  v_dot2_f32_bf16 v23, v124, v12, 0
  v_dot2_f32_bf16 v20, v113, v13, v20
  v_dot2_f32_bf16 v21, v117, v13, v21
  v_dot2_f32_bf16 v22, v121, v13, v22
  v_dot2_f32_bf16 v23, v125, v13, v23
  v_dot2_f32_bf16 v20, v114, v14, v20
  v_dot2_f32_bf16 v21, v118, v14, v21
  v_dot2_f32_bf16 v22, v122, v14, v22
  v_dot2_f32_bf16 v23, v126, v14, v23
  v_dot2_f32_bf16 v20, v115, v15, v20
  v_dot2_f32_bf16 v21, v119, v15, v21
  v_dot2_f32_bf16 v22, v123, v15, v22
  v_dot2_f32_bf16 v23, v127, v15, v23
  buffer_load_dwordx4 v[112:115], v62, s[4:7], s89 offen offset:0 nt
  buffer_load_dwordx4 v[116:119], v62, s[4:7], s89 offen offset:1024 nt
  buffer_load_dwordx4 v[120:123], v62, s[4:7], s89 offen offset:2048 nt
  buffer_load_dwordx4 v[124:127], v62, s[4:7], s89 offen offset:3072 nt
  v_add_f32_dpp v20, v20, v20 row_ror:8 row_mask:0xf bank_mask:0xf
  v_add_f32_dpp v21, v21, v21 row_ror:8 row_mask:0xf bank_mask:0xf
  v_add_f32_dpp v22, v22, v22 row_ror:8 row_mask:0xf bank_mask:0xf
  v_add_f32_dpp v23, v23, v23 row_ror:8 row_mask:0xf bank_mask:0xf
  v_add_f32_dpp v20, v20, v20 row_ror:4 row_mask:0xf bank_mask:0xf
  v_add_f32_dpp v21, v21, v21 row_ror:4 row_mask:0xf bank_mask:0xf
  v_add_f32_dpp v22, v22, v22 row_ror:4 row_mask:0xf bank_mask:0xf
  v_add_f32_dpp v23, v23, v23 row_ror:4 row_mask:0xf bank_mask:0xf
  v_add_f32_dpp v20, v20, v20 row_ror:2 row_mask:0xf bank_mask:0xf
  v_add_f32_dpp v21, v21, v21 row_ror:2 row_mask:0xf bank_mask:0xf
  v_add_f32_dpp v22, v22, v22 row_ror:2 row_mask:0xf bank_mask:0xf
  v_add_f32_dpp v23, v23, v23 row_ror:2 row_mask:0xf bank_mask:0xf
  v_add_f32_dpp v20, v20, v20 row_ror:1 row_mask:0xf bank_mask:0xf
  v_add_f32_dpp v21, v21, v21 row_ror:1 row_mask:0xf bank_mask:0xf
  v_add_f32_dpp v22, v22, v22 row_ror:1 row_mask:0xf bank_mask:0xf
  v_add_f32_dpp v23, v23, v23 row_ror:1 row_mask:0xf bank_mask:0xf
  s_mov_b32 exec_lo, 0x00010001
  s_mov_b32 exec_hi, 0x00010001
  ds_write_b128 v54, v[16:19] offset:20480
  ds_write_b128 v54, v[20:23] offset:20496
  s_mov_b64 exec, -1
  s_cmp_lg_u32 s78, 0
  s_cbranch_scc1 L_sw2
  s_waitcnt vmcnt(40)
  v_dot2_f32_bf16 v16, v128, v12, 0
  v_dot2_f32_bf16 v17, v132, v12, 0
  v_dot2_f32_bf16 v18, v136, v12, 0
  v_dot2_f32_bf16 v19, v140, v12, 0
  v_dot2_f32_bf16 v16, v129, v13, v16
  v_dot2_f32_bf16 v17, v133, v13, v17
  v_dot2_f32_bf16 v18, v137, v13, v18
  v_dot2_f32_bf16 v19, v141, v13, v19
  v_dot2_f32_bf16 v16, v130, v14, v16
  v_dot2_f32_bf16 v17, v134, v14, v17
  v_dot2_f32_bf16 v18, v138, v14, v18
  v_dot2_f32_bf16 v19, v142, v14, v19
  v_dot2_f32_bf16 v16, v131, v15, v16
  v_dot2_f32_bf16 v17, v135, v15, v17
  v_dot2_f32_bf16 v18, v139, v15, v18
  v_dot2_f32_bf16 v19, v143, v15, v19
  s_waitcnt lgkmcnt(0)
  v_readfirstlane_b32 s66, v11
  s_mov_b64 exec, 1
  ds_add_rtn_u32 v11, v10, v9 offset:10304
  s_mov_b64 exec, -1
  s_lshl_b32 s65, s87, 7
  v_add_u32 v54, s65, v63
  s_cmp_lt_u32 s66, s93
  s_cselect_b32 s67, s96, s75
  s_add_u32 s67, s67, s66
  s_sub_u32 s65, s66, s64
  s_add_u32 s68, s65, s96
  s_cmp_lt_u32 s66, s64
  s_cselect_b32 s67, s67, s68
  s_cselect_b32 s87, s66, s65
  s_cselect_b32 s78, 0, 1
  s_cselect_b64 s[4:5], s[34:35], s[36:37]
  s_lshl_b32 s62, s67, 13
  s_add_u32 s62, s62, s95
  s_add_u32 s89, s62, 4096
  buffer_load_dwordx2 v[128:129], v62, s[4:7], s62 offen offset:0 nt
  buffer_load_dwordx2 v[130:131], v62, s[4:7], s62 offen offset:8 nt
  buffer_load_dwordx2 v[132:133], v62, s[4:7], s62 offen offset:1024 nt
  buffer_load_dwordx2 v[134:135], v62, s[4:7], s62 offen offset:1032 nt
  buffer_load_dwordx2 v[136:137], v62, s[4:7], s62 offen offset:2048 nt
  buffer_load_dwordx2 v[138:139], v62, s[4:7], s62 offen offset:2056 nt
  buffer_load_dwordx2 v[140:141], v62, s[4:7], s62 offen offset:3072 nt
  buffer_load_dwordx2 v[142:143], v62, s[4:7], s62 offen offset:3080 nt
  v_add_f32_dpp v16, v16, v16 row_ror:8 row_mask:0xf bank_mask:0xf
  v_add_f32_dpp v17, v17, v17 row_ror:8 row_mask:0xf bank_mask:0xf
  v_add_f32_dpp v18, v18, v18 row_ror:8 row_mask:0xf bank_mask:0xf
  v_add_f32_dpp v19, v19, v19 row_ror:8 row_mask:0xf bank_mask:0xf
  v_add_f32_dpp v16, v16, v16 row_ror:4 row_mask:0xf bank_mask:0xf
  v_add_f32_dpp v17, v17, v17 row_ror:4 row_mask:0xf bank_mask:0xf
  v_add_f32_dpp v18, v18, v18 row_ror:4 row_mask:0xf bank_mask:0xf
  v_add_f32_dpp v19, v19, v19 row_ror:4 row_mask:0xf bank_mask:0xf
  v_add_f32_dpp v16, v16, v16 row_ror:2 row_mask:0xf bank_mask:0xf
  v_add_f32_dpp v17, v17, v17 row_ror:2 row_mask:0xf bank_mask:0xf
  v_add_f32_dpp v18, v18, v18 row_ror:2 row_mask:0xf bank_mask:0xf
  v_add_f32_dpp v19, v19, v19 row_ror:2 row_mask:0xf bank_mask:0xf
  v_add_f32_dpp v16, v16, v16 row_ror:1 row_mask:0xf bank_mask:0xf
  v_add_f32_dpp v17, v17, v17 row_ror:1 row_mask:0xf bank_mask:0xf
  v_add_f32_dpp v18, v18, v18 row_ror:1 row_mask:0xf bank_mask:0xf
  v_add_f32_dpp v19, v19, v19 row_ror:1 row_mask:0xf bank_mask:0xf
  s_waitcnt vmcnt(44)
  v_dot2_f32_bf16 v20, v144, v12, 0
  v_dot2_f32_bf16 v21, v148, v12, 0
  v_dot2_f32_bf16 v22, v152, v12, 0
  v_dot2_f32_bf16 v23, v156, v12, 0
  v_dot2_f32_bf16 v20, v145, v13, v20
  v_dot2_f32_bf16 v21, v149, v13, v21
  v_dot2_f32_bf16 v22, v153, v13, v22
  v_dot2_f32_bf16 v23, v157, v13, v23
  v_dot2_f32_bf16 v20, v146, v14, v20
  v_dot2_f32_bf16 v21, v150, v14, v21
  v_dot2_f32_bf16 v22, v154, v14, v22
  v_dot2_f32_bf16 v23, v158, v14, v23
  v_dot2_f32_bf16 v20, v147, v15, v20
  v_dot2_f32_bf16 v21, v151, v15, v21
  v_dot2_f32_bf16 v22, v155, v15, v22
  v_dot2_f32_bf16 v23, v159, v15, v23
  buffer_load_dwordx4 v[144:147], v62, s[4:7], s89 offen offset:0 nt
  buffer_load_dwordx4 v[148:151], v62, s[4:7], s89 offen offset:1024 nt
  buffer_load_dwordx4 v[152:155], v62, s[4:7], s89 offen offset:2048 nt
  buffer_load_dwordx4 v[156:159], v62, s[4:7], s89 offen offset:3072 nt
  v_add_f32_dpp v20, v20, v20 row_ror:8 row_mask:0xf bank_mask:0xf
  v_add_f32_dpp v21, v21, v21 row_ror:8 row_mask:0xf bank_mask:0xf
  v_add_f32_dpp v22, v22, v22 row_ror:8 row_mask:0xf bank_mask:0xf
  v_add_f32_dpp v23, v23, v23 row_ror:8 row_mask:0xf bank_mask:0xf
  v_add_f32_dpp v20, v20, v20 row_ror:4 row_mask:0xf bank_mask:0xf
  v_add_f32_dpp v21, v21, v21 row_ror:4 row_mask:0xf bank_mask:0xf
  v_add_f32_dpp v22, v22, v22 row_ror:4 row_mask:0xf bank_mask:0xf
  v_add_f32_dpp v23, v23, v23 row_ror:4 row_mask:0xf bank_mask:0xf
  v_add_f32_dpp v20, v20, v20 row_ror:2 row_mask:0xf bank_mask:0xf
  v_add_f32_dpp v21, v21, v21 row_ror:2 row_mask:0xf bank_mask:0xf
  v_add_f32_dpp v22, v22, v22 row_ror:2 row_mask:0xf bank_mask:0xf
  v_add_f32_dpp v23, v23, v23 row_ror:2 row_mask:0xf bank_mask:0xf
  v_add_f32_dpp v20, v20, v20 row_ror:1 row_mask:0xf bank_mask:0xf
  v_add_f32_dpp v21, v21, v21 row_ror:1 row_mask:0xf bank_mask:0xf
  v_add_f32_dpp v22, v22, v22 row_ror:1 row_mask:0xf bank_mask:0xf
  v_add_f32_dpp v23, v23, v23 row_ror:1 row_mask:0xf bank_mask:0xf
  s_mov_b32 exec_lo, 0x00010001
  s_mov_b32 exec_hi, 0x00010001
  ds_write_b128 v54, v[16:19] offset:20480
  ds_write_b128 v54, v[20:23] offset:20496
  s_mov_b64 exec, -1
  s_cmp_lg_u32 s79, 0
  s_cbranch_scc1 L_sw3
  s_waitcnt vmcnt(40)
  v_dot2_f32_bf16 v16, v160, v12, 0
  v_dot2_f32_bf16 v17, v164, v12, 0
  v_dot2_f32_bf16 v18, v168, v12, 0
  v_dot2_f32_bf16 v19, v172, v12, 0
  v_dot2_f32_bf16 v16, v161, v13, v16
  v_dot2_f32_bf16 v17, v165, v13, v17
  v_dot2_f32_bf16 v18, v169, v13, v18
  v_dot2_f32_bf16 v19, v173, v13, v19
  v_dot2_f32_bf16 v16, v162, v14, v16
  v_dot2_f32_bf16 v17, v166, v14, v17
  v_dot2_f32_bf16 v18, v170, v14, v18
  v_dot2_f32_bf16 v19, v174, v14, v19
  v_dot2_f32_bf16 v16, v163, v15, v16
  v_dot2_f32_bf16 v17, v167, v15, v17
  v_dot2_f32_bf16 v18, v171, v15, v18
  v_dot2_f32_bf16 v19, v175, v15, v19
  s_waitcnt lgkmcnt(0)
  v_readfirstlane_b32 s66, v11
  s_mov_b64 exec, 1
  ds_add_rtn_u32 v11, v10, v9 offset:10304
  s_mov_b64 exec, -1
  s_lshl_b32 s65, s88, 7
  v_add_u32 v54, s65, v63
  s_cmp_lt_u32 s66, s93
  s_cselect_b32 s67, s96, s75
  s_add_u32 s67, s67, s66
  s_sub_u32 s65, s66, s64
  s_add_u32 s68, s65, s96
  s_cmp_lt_u32 s66, s64
  s_cselect_b32 s67, s67, s68
  s_cselect_b32 s88, s66, s65
  s_cselect_b32 s79, 0, 1
  s_cselect_b64 s[4:5], s[34:35], s[36:37]
  s_lshl_b32 s62, s67, 13
  s_add_u32 s62, s62, s95
  s_add_u32 s89, s62, 4096
  buffer_load_dwordx2 v[160:161], v62, s[4:7], s62 offen offset:0 nt
  buffer_load_dwordx2 v[162:163], v62, s[4:7], s62 offen offset:8 nt
  buffer_load_dwordx2 v[164:165], v62, s[4:7], s62 offen offset:1024 nt
  buffer_load_dwordx2 v[166:167], v62, s[4:7], s62 offen offset:1032 nt
  buffer_load_dwordx2 v[168:169], v62, s[4:7], s62 offen offset:2048 nt
  buffer_load_dwordx2 v[170:171], v62, s[4:7], s62 offen offset:2056 nt
  buffer_load_dwordx2 v[172:173], v62, s[4:7], s62 offen offset:3072 nt
  buffer_load_dwordx2 v[174:175], v62, s[4:7], s62 offen offset:3080 nt
  v_add_f32_dpp v16, v16, v16 row_ror:8 row_mask:0xf bank_mask:0xf
  v_add_f32_dpp v17, v17, v17 row_ror:8 row_mask:0xf bank_mask:0xf
  v_add_f32_dpp v18, v18, v18 row_ror:8 row_mask:0xf bank_mask:0xf
  v_add_f32_dpp v19, v19, v19 row_ror:8 row_mask:0xf bank_mask:0xf
  v_add_f32_dpp v16, v16, v16 row_ror:4 row_mask:0xf bank_mask:0xf
  v_add_f32_dpp v17, v17, v17 row_ror:4 row_mask:0xf bank_mask:0xf
  v_add_f32_dpp v18, v18, v18 row_ror:4 row_mask:0xf bank_mask:0xf
  v_add_f32_dpp v19, v19, v19 row_ror:4 row_mask:0xf bank_mask:0xf
  v_add_f32_dpp v16, v16, v16 row_ror:2 row_mask:0xf bank_mask:0xf
  v_add_f32_dpp v17, v17, v17 row_ror:2 row_mask:0xf bank_mask:0xf
  v_add_f32_dpp v18, v18, v18 row_ror:2 row_mask:0xf bank_mask:0xf
  v_add_f32_dpp v19, v19, v19 row_ror:2 row_mask:0xf bank_mask:0xf
  v_add_f32_dpp v16, v16, v16 row_ror:1 row_mask:0xf bank_mask:0xf
  v_add_f32_dpp v17, v17, v17 row_ror:1 row_mask:0xf bank_mask:0xf
  v_add_f32_dpp v18, v18, v18 row_ror:1 row_mask:0xf bank_mask:0xf
  v_add_f32_dpp v19, v19, v19 row_ror:1 row_mask:0xf bank_mask:0xf
  s_waitcnt vmcnt(44)
  v_dot2_f32_bf16 v20, v176, v12, 0
  v_dot2_f32_bf16 v21, v180, v12, 0
  v_dot2_f32_bf16 v22, v184, v12, 0
  v_dot2_f32_bf16 v23, v188, v12, 0
  v_dot2_f32_bf16 v20, v177, v13, v20
  v_dot2_f32_bf16 v21, v181, v13, v21
  v_dot2_f32_bf16 v22, v185, v13, v22
  v_dot2_f32_bf16 v23, v189, v13, v23
  v_dot2_f32_bf16 v20, v178, v14, v20
  v_dot2_f32_bf16 v21, v182, v14, v21
  v_dot2_f32_bf16 v22, v186, v14, v22
  v_dot2_f32_bf16 v23, v190, v14, v23
  v_dot2_f32_bf16 v20, v179, v15, v20
  v_dot2_f32_bf16 v21, v183, v15, v21
  v_dot2_f32_bf16 v22, v187, v15, v22
  v_dot2_f32_bf16 v23, v191, v15, v23
  buffer_load_dwordx4 v[176:179], v62, s[4:7], s89 offen offset:0 nt
  buffer_load_dwordx4 v[180:183], v62, s[4:7], s89 offen offset:1024 nt
  buffer_load_dwordx4 v[184:187], v62, s[4:7], s89 offen offset:2048 nt
  buffer_load_dwordx4 v[188:191], v62, s[4:7], s89 offen offset:3072 nt
  v_add_f32_dpp v20, v20, v20 row_ror:8 row_mask:0xf bank_mask:0xf
  v_add_f32_dpp v21, v21, v21 row_ror:8 row_mask:0xf bank_mask:0xf
  v_add_f32_dpp v22, v22, v22 row_ror:8 row_mask:0xf bank_mask:0xf
  v_add_f32_dpp v23, v23, v23 row_ror:8 row_mask:0xf bank_mask:0xf
  v_add_f32_dpp v20, v20, v20 row_ror:4 row_mask:0xf bank_mask:0xf
  v_add_f32_dpp v21, v21, v21 row_ror:4 row_mask:0xf bank_mask:0xf
  v_add_f32_dpp v22, v22, v22 row_ror:4 row_mask:0xf bank_mask:0xf
  v_add_f32_dpp v23, v23, v23 row_ror:4 row_mask:0xf bank_mask:0xf
  v_add_f32_dpp v20, v20, v20 row_ror:2 row_mask:0xf bank_mask:0xf
  v_add_f32_dpp v21, v21, v21 row_ror:2 row_mask:0xf bank_mask:0xf
  v_add_f32_dpp v22, v22, v22 row_ror:2 row_mask:0xf bank_mask:0xf
  v_add_f32_dpp v23, v23, v23 row_ror:2 row_mask:0xf bank_mask:0xf
  v_add_f32_dpp v20, v20, v20 row_ror:1 row_mask:0xf bank_mask:0xf
  v_add_f32_dpp v21, v21, v21 row_ror:1 row_mask:0xf bank_mask:0xf
  v_add_f32_dpp v22, v22, v22 row_ror:1 row_mask:0xf bank_mask:0xf
  v_add_f32_dpp v23, v23, v23 row_ror:1 row_mask:0xf bank_mask:0xf
  s_mov_b32 exec_lo, 0x00010001
  s_mov_b32 exec_hi, 0x00010001
  ds_write_b128 v54, v[16:19] offset:20480
  ds_write_b128 v54, v[20:23] offset:20496
  s_mov_b64 exec, -1
  s_branch L_kloop
L_sw0:
  s_waitcnt lgkmcnt(0)
  s_barrier
  s_branch L_v0
L_sw1:
  s_waitcnt lgkmcnt(0)
  s_barrier
  s_branch L_v1
L_sw2:
  s_waitcnt lgkmcnt(0)
  s_barrier
  s_branch L_v2
L_sw3:
  s_waitcnt lgkmcnt(0)
  s_barrier
  s_branch L_v3
L_loop:
L_v0:
  s_lshl_b32 s65, s85, 7
  v_add_u32 v54, s65, v63
  ds_read_b128 v[16:19], v54 offset:20480
  ds_read_b128 v[20:23], v54 offset:20496
  s_waitcnt lgkmcnt(0)
  v_readfirstlane_b32 s66, v11
  s_nop 3
  s_sub_u32 s65, s66, s64
  s_cmp_lt_u32 s65, s93
  s_cbranch_scc0 L_m0
  s_mov_b64 exec, 1
  ds_add_rtn_u32 v11, v10, v9 offset:10304
  s_mov_b64 exec, -1
  s_sub_u32 s66, s66, s64
  s_add_u32 s67, s66, s96
  s_mov_b32 s85, s66
  s_lshl_b32 s62, s67, 13
  s_add_u32 s62, s62, s95
  s_add_u32 s89, s62, 4096
  v_max3_f32 v50, v16, v17, v18
  v_max3_f32 v51, v19, v20, v21
  v_max3_f32 v50, v22, v23, v50
  v_max_f32 v50, v50, v51
  v_mov_b32 v51, v50
  s_nop 1
  v_permlane16_swap_b32 v50, v51
  v_max_f32 v50, v50, v51
  v_mov_b32 v51, v50
  s_nop 1
  v_permlane32_swap_b32 v50, v51
  v_max3_f32 v50, v50, v51, v48
  v_mul_f32 v51, s58, v50
  v_fma_f32 v52, v48, s58, -v51
  v_fma_f32 v32, v16, s58, -v51
  v_fma_f32 v33, v17, s58, -v51
  v_fma_f32 v34, v18, s58, -v51
  v_fma_f32 v35, v19, s58, -v51
  v_fma_f32 v36, v20, s58, -v51
  v_fma_f32 v37, v21, s58, -v51
  v_fma_f32 v38, v22, s58, -v51
  v_fma_f32 v39, v23, s58, -v51
  v_exp_f32 v52, v52
  v_exp_f32 v32, v32
  v_exp_f32 v33, v33
  v_exp_f32 v34, v34
  v_exp_f32 v35, v35
  v_exp_f32 v36, v36
  v_exp_f32 v37, v37
  v_exp_f32 v38, v38
  v_exp_f32 v39, v39
  v_mov_b32 v48, v50
  v_fma_f32 v49, v49, v52, v32
  v_add_f32 v51, v33, v34
  v_add_f32 v50, v35, v36
  v_mul_f32 v28, v28, v52
  v_mul_f32 v29, v29, v52
  v_mul_f32 v30, v30, v52
  v_mul_f32 v31, v31, v52
  v_add_f32 v51, v51, v37
  v_add_f32 v50, v50, v38
  v_add_f32 v49, v49, v39
  v_add_f32 v51, v51, v50
  v_add_f32 v49, v49, v51
  s_waitcnt vmcnt(40)
  v_cvt_pk_bf16_f32 v50, v32, v32
  v_and_b32 v40, v50, v5
  v_and_b32 v41, v50, v6
  v_and_b32 v42, v50, v7
  v_and_b32 v43, v50, v8
  s_nop 1
  v_mfma_f32_16x16x32_bf16 v[28:31], v[64:67], v[40:43], v[28:31]
  v_cvt_pk_bf16_f32 v50, v33, v33
  v_and_b32 v44, v50, v5
  v_and_b32 v45, v50, v6
  v_and_b32 v46, v50, v7
  v_and_b32 v47, v50, v8
  s_nop 1
  v_mfma_f32_16x16x32_bf16 v[28:31], v[68:71], v[44:47], v[28:31]
  v_cvt_pk_bf16_f32 v50, v34, v34
  v_and_b32 v40, v50, v5
  v_and_b32 v41, v50, v6
  v_and_b32 v42, v50, v7
  v_and_b32 v43, v50, v8
  s_nop 1
  v_mfma_f32_16x16x32_bf16 v[28:31], v[72:75], v[40:43], v[28:31]
  v_cvt_pk_bf16_f32 v50, v35, v35
  v_and_b32 v44, v50, v5
  v_and_b32 v45, v50, v6
  v_and_b32 v46, v50, v7
  v_and_b32 v47, v50, v8
  s_nop 1
  v_mfma_f32_16x16x32_bf16 v[28:31], v[76:79], v[44:47], v[28:31]
  buffer_load_dwordx2 v[64:65], v62, s[4:7], s62 offen offset:0 nt
  buffer_load_dwordx2 v[66:67], v62, s[4:7], s62 offen offset:8 nt
  buffer_load_dwordx2 v[68:69], v62, s[4:7], s62 offen offset:1024 nt
  buffer_load_dwordx2 v[70:71], v62, s[4:7], s62 offen offset:1032 nt
  buffer_load_dwordx2 v[72:73], v62, s[4:7], s62 offen offset:2048 nt
  buffer_load_dwordx2 v[74:75], v62, s[4:7], s62 offen offset:2056 nt
  buffer_load_dwordx2 v[76:77], v62, s[4:7], s62 offen offset:3072 nt
  buffer_load_dwordx2 v[78:79], v62, s[4:7], s62 offen offset:3080 nt
  s_waitcnt vmcnt(44)
  v_cvt_pk_bf16_f32 v50, v36, v36
  v_and_b32 v40, v50, v5
  v_and_b32 v41, v50, v6
  v_and_b32 v42, v50, v7
  v_and_b32 v43, v50, v8
  s_nop 1
  v_mfma_f32_16x16x32_bf16 v[28:31], v[80:83], v[40:43], v[28:31]
  v_cvt_pk_bf16_f32 v50, v37, v37
  v_and_b32 v44, v50, v5
  v_and_b32 v45, v50, v6
  v_and_b32 v46, v50, v7
  v_and_b32 v47, v50, v8
  s_nop 1
  v_mfma_f32_16x16x32_bf16 v[28:31], v[84:87], v[44:47], v[28:31]
  v_cvt_pk_bf16_f32 v50, v38, v38
  v_and_b32 v40, v50, v5
  v_and_b32 v41, v50, v6
  v_and_b32 v42, v50, v7
  v_and_b32 v43, v50, v8
  s_nop 1
  v_mfma_f32_16x16x32_bf16 v[28:31], v[88:91], v[40:43], v[28:31]
  v_cvt_pk_bf16_f32 v50, v39, v39
  v_and_b32 v44, v50, v5
  v_and_b32 v45, v50, v6
  v_and_b32 v46, v50, v7
  v_and_b32 v47, v50, v8
  s_nop 1
  v_mfma_f32_16x16x32_bf16 v[28:31], v[92:95], v[44:47], v[28:31]
  buffer_load_dwordx4 v[80:83], v62, s[4:7], s89 offen offset:0 nt
  buffer_load_dwordx4 v[84:87], v62, s[4:7], s89 offen offset:1024 nt
  buffer_load_dwordx4 v[88:91], v62, s[4:7], s89 offen offset:2048 nt
  buffer_load_dwordx4 v[92:95], v62, s[4:7], s89 offen offset:3072 nt
L_v1:
  s_lshl_b32 s65, s86, 7
  v_add_u32 v54, s65, v63
  ds_read_b128 v[16:19], v54 offset:20480
  ds_read_b128 v[20:23], v54 offset:20496
  s_waitcnt lgkmcnt(0)
  v_readfirstlane_b32 s66, v11
  s_nop 3
  s_sub_u32 s65, s66, s64
  s_cmp_lt_u32 s65, s93
  s_cbranch_scc0 L_m1
  s_mov_b64 exec, 1
  ds_add_rtn_u32 v11, v10, v9 offset:10304
  s_mov_b64 exec, -1
  s_sub_u32 s66, s66, s64
  s_add_u32 s67, s66, s96
  s_mov_b32 s86, s66
  s_lshl_b32 s62, s67, 13
  s_add_u32 s62, s62, s95
  s_add_u32 s89, s62, 4096
  v_max3_f32 v50, v16, v17, v18
  v_max3_f32 v51, v19, v20, v21
  v_max3_f32 v50, v22, v23, v50
  v_max_f32 v50, v50, v51
  v_mov_b32 v51, v50
  s_nop 1
  v_permlane16_swap_b32 v50, v51
  v_max_f32 v50, v50, v51
  v_mov_b32 v51, v50
  s_nop 1
  v_permlane32_swap_b32 v50, v51
  v_max3_f32 v50, v50, v51, v48
  v_mul_f32 v51, s58, v50
  v_fma_f32 v52, v48, s58, -v51
  v_fma_f32 v32, v16, s58, -v51
  v_fma_f32 v33, v17, s58, -v51
  v_fma_f32 v34, v18, s58, -v51
  v_fma_f32 v35, v19, s58, -v51
  v_fma_f32 v36, v20, s58, -v51
  v_fma_f32 v37, v21, s58, -v51
  v_fma_f32 v38, v22, s58, -v51
  v_fma_f32 v39, v23, s58, -v51
  v_exp_f32 v52, v52
  v_exp_f32 v32, v32
  v_exp_f32 v33, v33
  v_exp_f32 v34, v34
  v_exp_f32 v35, v35
  v_exp_f32 v36, v36
  v_exp_f32 v37, v37
  v_exp_f32 v38, v38
  v_exp_f32 v39, v39
  v_mov_b32 v48, v50
  v_fma_f32 v49, v49, v52, v32
  v_add_f32 v51, v33, v34
  v_add_f32 v50, v35, v36
  v_mul_f32 v28, v28, v52
  v_mul_f32 v29, v29, v52
  v_mul_f32 v30, v30, v52
  v_mul_f32 v31, v31, v52
  v_add_f32 v51, v51, v37
  v_add_f32 v50, v50, v38
  v_add_f32 v49, v49, v39
  v_add_f32 v51, v51, v50
  v_add_f32 v49, v49, v51
  s_waitcnt vmcnt(40)
  v_cvt_pk_bf16_f32 v50, v32, v32
  v_and_b32 v40, v50, v5
  v_and_b32 v41, v50, v6
  v_and_b32 v42, v50, v7
  v_and_b32 v43, v50, v8
  s_nop 1
  v_mfma_f32_16x16x32_bf16 v[28:31], v[96:99], v[40:43], v[28:31]
  v_cvt_pk_bf16_f32 v50, v33, v33
  v_and_b32 v44, v50, v5
  v_and_b32 v45, v50, v6
  v_and_b32 v46, v50, v7
  v_and_b32 v47, v50, v8
  s_nop 1
  v_mfma_f32_16x16x32_bf16 v[28:31], v[100:103], v[44:47], v[28:31]
  v_cvt_pk_bf16_f32 v50, v34, v34
  v_and_b32 v40, v50, v5
  v_and_b32 v41, v50, v6
  v_and_b32 v42, v50, v7
  v_and_b32 v43, v50, v8
  s_nop 1
  v_mfma_f32_16x16x32_bf16 v[28:31], v[104:107], v[40:43], v[28:31]
  v_cvt_pk_bf16_f32 v50, v35, v35
  v_and_b32 v44, v50, v5
  v_and_b32 v45, v50, v6
  v_and_b32 v46, v50, v7
  v_and_b32 v47, v50, v8
  s_nop 1
  v_mfma_f32_16x16x32_bf16 v[28:31], v[108:111], v[44:47], v[28:31]
  buffer_load_dwordx2 v[96:97], v62, s[4:7], s62 offen offset:0 nt
  buffer_load_dwordx2 v[98:99], v62, s[4:7], s62 offen offset:8 nt
  buffer_load_dwordx2 v[100:101], v62, s[4:7], s62 offen offset:1024 nt
  buffer_load_dwordx2 v[102:103], v62, s[4:7], s62 offen offset:1032 nt
  buffer_load_dwordx2 v[104:105], v62, s[4:7], s62 offen offset:2048 nt
  buffer_load_dwordx2 v[106:107], v62, s[4:7], s62 offen offset:2056 nt
  buffer_load_dwordx2 v[108:109], v62, s[4:7], s62 offen offset:3072 nt
  buffer_load_dwordx2 v[110:111], v62, s[4:7], s62 offen offset:3080 nt
  s_waitcnt vmcnt(44)
  v_cvt_pk_bf16_f32 v50, v36, v36
  v_and_b32 v40, v50, v5
  v_and_b32 v41, v50, v6
  v_and_b32 v42, v50, v7
  v_and_b32 v43, v50, v8
  s_nop 1
  v_mfma_f32_16x16x32_bf16 v[28:31], v[112:115], v[40:43], v[28:31]
  v_cvt_pk_bf16_f32 v50, v37, v37
  v_and_b32 v44, v50, v5
  v_and_b32 v45, v50, v6
  v_and_b32 v46, v50, v7
  v_and_b32 v47, v50, v8
  s_nop 1
  v_mfma_f32_16x16x32_bf16 v[28:31], v[116:119], v[44:47], v[28:31]
  v_cvt_pk_bf16_f32 v50, v38, v38
  v_and_b32 v40, v50, v5
  v_and_b32 v41, v50, v6
  v_and_b32 v42, v50, v7
  v_and_b32 v43, v50, v8
  s_nop 1
  v_mfma_f32_16x16x32_bf16 v[28:31], v[120:123], v[40:43], v[28:31]
  v_cvt_pk_bf16_f32 v50, v39, v39
  v_and_b32 v44, v50, v5
  v_and_b32 v45, v50, v6
  v_and_b32 v46, v50, v7
  v_and_b32 v47, v50, v8
  s_nop 1
  v_mfma_f32_16x16x32_bf16 v[28:31], v[124:127], v[44:47], v[28:31]
  buffer_load_dwordx4 v[112:115], v62, s[4:7], s89 offen offset:0 nt
  buffer_load_dwordx4 v[116:119], v62, s[4:7], s89 offen offset:1024 nt
  buffer_load_dwordx4 v[120:123], v62, s[4:7], s89 offen offset:2048 nt
  buffer_load_dwordx4 v[124:127], v62, s[4:7], s89 offen offset:3072 nt
L_v2:
  s_lshl_b32 s65, s87, 7
  v_add_u32 v54, s65, v63
  ds_read_b128 v[16:19], v54 offset:20480
  ds_read_b128 v[20:23], v54 offset:20496
  s_waitcnt lgkmcnt(0)
  v_readfirstlane_b32 s66, v11
  s_nop 3
  s_sub_u32 s65, s66, s64
  s_cmp_lt_u32 s65, s93
  s_cbranch_scc0 L_m2
  s_mov_b64 exec, 1
  ds_add_rtn_u32 v11, v10, v9 offset:10304
  s_mov_b64 exec, -1
  s_sub_u32 s66, s66, s64
  s_add_u32 s67, s66, s96
  s_mov_b32 s87, s66
  s_lshl_b32 s62, s67, 13
  s_add_u32 s62, s62, s95
  s_add_u32 s89, s62, 4096
  v_max3_f32 v50, v16, v17, v18
  v_max3_f32 v51, v19, v20, v21
  v_max3_f32 v50, v22, v23, v50
  v_max_f32 v50, v50, v51
  v_mov_b32 v51, v50
  s_nop 1
  v_permlane16_swap_b32 v50, v51
  v_max_f32 v50, v50, v51
  v_mov_b32 v51, v50
  s_nop 1
  v_permlane32_swap_b32 v50, v51
  v_max3_f32 v50, v50, v51, v48
  v_mul_f32 v51, s58, v50
  v_fma_f32 v52, v48, s58, -v51
  v_fma_f32 v32, v16, s58, -v51
  v_fma_f32 v33, v17, s58, -v51
  v_fma_f32 v34, v18, s58, -v51
  v_fma_f32 v35, v19, s58, -v51
  v_fma_f32 v36, v20, s58, -v51
  v_fma_f32 v37, v21, s58, -v51
  v_fma_f32 v38, v22, s58, -v51
  v_fma_f32 v39, v23, s58, -v51
  v_exp_f32 v52, v52
  v_exp_f32 v32, v32
  v_exp_f32 v33, v33
  v_exp_f32 v34, v34
  v_exp_f32 v35, v35
  v_exp_f32 v36, v36
  v_exp_f32 v37, v37
  v_exp_f32 v38, v38
  v_exp_f32 v39, v39
  v_mov_b32 v48, v50
  v_fma_f32 v49, v49, v52, v32
  v_add_f32 v51, v33, v34
  v_add_f32 v50, v35, v36
  v_mul_f32 v28, v28, v52
  v_mul_f32 v29, v29, v52
  v_mul_f32 v30, v30, v52
  v_mul_f32 v31, v31, v52
  v_add_f32 v51, v51, v37
  v_add_f32 v50, v50, v38
  v_add_f32 v49, v49, v39
  v_add_f32 v51, v51, v50
  v_add_f32 v49, v49, v51
  s_waitcnt vmcnt(40)
  v_cvt_pk_bf16_f32 v50, v32, v32
  v_and_b32 v40, v50, v5
  v_and_b32 v41, v50, v6
  v_and_b32 v42, v50, v7
  v_and_b32 v43, v50, v8
  s_nop 1
  v_mfma_f32_16x16x32_bf16 v[28:31], v[128:131], v[40:43], v[28:31]
  v_cvt_pk_bf16_f32 v50, v33, v33
  v_and_b32 v44, v50, v5
  v_and_b32 v45, v50, v6
  v_and_b32 v46, v50, v7
  v_and_b32 v47, v50, v8
  s_nop 1
  v_mfma_f32_16x16x32_bf16 v[28:31], v[132:135], v[44:47], v[28:31]
  v_cvt_pk_bf16_f32 v50, v34, v34
  v_and_b32 v40, v50, v5
  v_and_b32 v41, v50, v6
  v_and_b32 v42, v50, v7
  v_and_b32 v43, v50, v8
  s_nop 1
  v_mfma_f32_16x16x32_bf16 v[28:31], v[136:139], v[40:43], v[28:31]
  v_cvt_pk_bf16_f32 v50, v35, v35
  v_and_b32 v44, v50, v5
  v_and_b32 v45, v50, v6
  v_and_b32 v46, v50, v7
  v_and_b32 v47, v50, v8
  s_nop 1
  v_mfma_f32_16x16x32_bf16 v[28:31], v[140:143], v[44:47], v[28:31]
  buffer_load_dwordx2 v[128:129], v62, s[4:7], s62 offen offset:0 nt
  buffer_load_dwordx2 v[130:131], v62, s[4:7], s62 offen offset:8 nt
  buffer_load_dwordx2 v[132:133], v62, s[4:7], s62 offen offset:1024 nt
  buffer_load_dwordx2 v[134:135], v62, s[4:7], s62 offen offset:1032 nt
  buffer_load_dwordx2 v[136:137], v62, s[4:7], s62 offen offset:2048 nt
  buffer_load_dwordx2 v[138:139], v62, s[4:7], s62 offen offset:2056 nt
  buffer_load_dwordx2 v[140:141], v62, s[4:7], s62 offen offset:3072 nt
  buffer_load_dwordx2 v[142:143], v62, s[4:7], s62 offen offset:3080 nt
  s_waitcnt vmcnt(44)
  v_cvt_pk_bf16_f32 v50, v36, v36
  v_and_b32 v40, v50, v5
  v_and_b32 v41, v50, v6
  v_and_b32 v42, v50, v7
  v_and_b32 v43, v50, v8
  s_nop 1
  v_mfma_f32_16x16x32_bf16 v[28:31], v[144:147], v[40:43], v[28:31]
  v_cvt_pk_bf16_f32 v50, v37, v37
  v_and_b32 v44, v50, v5
  v_and_b32 v45, v50, v6
  v_and_b32 v46, v50, v7
  v_and_b32 v47, v50, v8
  s_nop 1
  v_mfma_f32_16x16x32_bf16 v[28:31], v[148:151], v[44:47], v[28:31]
  v_cvt_pk_bf16_f32 v50, v38, v38
  v_and_b32 v40, v50, v5
  v_and_b32 v41, v50, v6
  v_and_b32 v42, v50, v7
  v_and_b32 v43, v50, v8
  s_nop 1
  v_mfma_f32_16x16x32_bf16 v[28:31], v[152:155], v[40:43], v[28:31]
  v_cvt_pk_bf16_f32 v50, v39, v39
  v_and_b32 v44, v50, v5
  v_and_b32 v45, v50, v6
  v_and_b32 v46, v50, v7
  v_and_b32 v47, v50, v8
  s_nop 1
  v_mfma_f32_16x16x32_bf16 v[28:31], v[156:159], v[44:47], v[28:31]
  buffer_load_dwordx4 v[144:147], v62, s[4:7], s89 offen offset:0 nt
  buffer_load_dwordx4 v[148:151], v62, s[4:7], s89 offen offset:1024 nt
  buffer_load_dwordx4 v[152:155], v62, s[4:7], s89 offen offset:2048 nt
  buffer_load_dwordx4 v[156:159], v62, s[4:7], s89 offen offset:3072 nt
L_v3:
  s_lshl_b32 s65, s88, 7
  v_add_u32 v54, s65, v63
  ds_read_b128 v[16:19], v54 offset:20480
  ds_read_b128 v[20:23], v54 offset:20496
  s_waitcnt lgkmcnt(0)
  v_readfirstlane_b32 s66, v11
  s_nop 3
  s_sub_u32 s65, s66, s64
  s_cmp_lt_u32 s65, s93
  s_cbranch_scc0 L_m3
  s_mov_b64 exec, 1
  ds_add_rtn_u32 v11, v10, v9 offset:10304
  s_mov_b64 exec, -1
  s_sub_u32 s66, s66, s64
  s_add_u32 s67, s66, s96
  s_mov_b32 s88, s66
  s_lshl_b32 s62, s67, 13
  s_add_u32 s62, s62, s95
  s_add_u32 s89, s62, 4096
  v_max3_f32 v50, v16, v17, v18
  v_max3_f32 v51, v19, v20, v21
  v_max3_f32 v50, v22, v23, v50
  v_max_f32 v50, v50, v51
  v_mov_b32 v51, v50
  s_nop 1
  v_permlane16_swap_b32 v50, v51
  v_max_f32 v50, v50, v51
  v_mov_b32 v51, v50
  s_nop 1
  v_permlane32_swap_b32 v50, v51
  v_max3_f32 v50, v50, v51, v48
  v_mul_f32 v51, s58, v50
  v_fma_f32 v52, v48, s58, -v51
  v_fma_f32 v32, v16, s58, -v51
  v_fma_f32 v33, v17, s58, -v51
  v_fma_f32 v34, v18, s58, -v51
  v_fma_f32 v35, v19, s58, -v51
  v_fma_f32 v36, v20, s58, -v51
  v_fma_f32 v37, v21, s58, -v51
  v_fma_f32 v38, v22, s58, -v51
  v_fma_f32 v39, v23, s58, -v51
  v_exp_f32 v52, v52
  v_exp_f32 v32, v32
  v_exp_f32 v33, v33
  v_exp_f32 v34, v34
  v_exp_f32 v35, v35
  v_exp_f32 v36, v36
  v_exp_f32 v37, v37
  v_exp_f32 v38, v38
  v_exp_f32 v39, v39
  v_mov_b32 v48, v50
  v_fma_f32 v49, v49, v52, v32
  v_add_f32 v51, v33, v34
  v_add_f32 v50, v35, v36
  v_mul_f32 v28, v28, v52
  v_mul_f32 v29, v29, v52
  v_mul_f32 v30, v30, v52
  v_mul_f32 v31, v31, v52
  v_add_f32 v51, v51, v37
  v_add_f32 v50, v50, v38
  v_add_f32 v49, v49, v39
  v_add_f32 v51, v51, v50
  v_add_f32 v49, v49, v51
  s_waitcnt vmcnt(40)
  v_cvt_pk_bf16_f32 v50, v32, v32
  v_and_b32 v40, v50, v5
  v_and_b32 v41, v50, v6
  v_and_b32 v42, v50, v7
  v_and_b32 v43, v50, v8
  s_nop 1
  v_mfma_f32_16x16x32_bf16 v[28:31], v[160:163], v[40:43], v[28:31]
  v_cvt_pk_bf16_f32 v50, v33, v33
  v_and_b32 v44, v50, v5
  v_and_b32 v45, v50, v6
  v_and_b32 v46, v50, v7
  v_and_b32 v47, v50, v8
  s_nop 1
  v_mfma_f32_16x16x32_bf16 v[28:31], v[164:167], v[44:47], v[28:31]
  v_cvt_pk_bf16_f32 v50, v34, v34
  v_and_b32 v40, v50, v5
  v_and_b32 v41, v50, v6
  v_and_b32 v42, v50, v7
  v_and_b32 v43, v50, v8
  s_nop 1
  v_mfma_f32_16x16x32_bf16 v[28:31], v[168:171], v[40:43], v[28:31]
  v_cvt_pk_bf16_f32 v50, v35, v35
  v_and_b32 v44, v50, v5
  v_and_b32 v45, v50, v6
  v_and_b32 v46, v50, v7
  v_and_b32 v47, v50, v8
  s_nop 1
  v_mfma_f32_16x16x32_bf16 v[28:31], v[172:175], v[44:47], v[28:31]
  buffer_load_dwordx2 v[160:161], v62, s[4:7], s62 offen offset:0 nt
  buffer_load_dwordx2 v[162:163], v62, s[4:7], s62 offen offset:8 nt
  buffer_load_dwordx2 v[164:165], v62, s[4:7], s62 offen offset:1024 nt
  buffer_load_dwordx2 v[166:167], v62, s[4:7], s62 offen offset:1032 nt
  buffer_load_dwordx2 v[168:169], v62, s[4:7], s62 offen offset:2048 nt
  buffer_load_dwordx2 v[170:171], v62, s[4:7], s62 offen offset:2056 nt
  buffer_load_dwordx2 v[172:173], v62, s[4:7], s62 offen offset:3072 nt
  buffer_load_dwordx2 v[174:175], v62, s[4:7], s62 offen offset:3080 nt
  s_waitcnt vmcnt(44)
  v_cvt_pk_bf16_f32 v50, v36, v36
  v_and_b32 v40, v50, v5
  v_and_b32 v41, v50, v6
  v_and_b32 v42, v50, v7
  v_and_b32 v43, v50, v8
  s_nop 1
  v_mfma_f32_16x16x32_bf16 v[28:31], v[176:179], v[40:43], v[28:31]
  v_cvt_pk_bf16_f32 v50, v37, v37
  v_and_b32 v44, v50, v5
  v_and_b32 v45, v50, v6
  v_and_b32 v46, v50, v7
  v_and_b32 v47, v50, v8
  s_nop 1
  v_mfma_f32_16x16x32_bf16 v[28:31], v[180:183], v[44:47], v[28:31]
  v_cvt_pk_bf16_f32 v50, v38, v38
  v_and_b32 v40, v50, v5
  v_and_b32 v41, v50, v6
  v_and_b32 v42, v50, v7
  v_and_b32 v43, v50, v8
  s_nop 1
  v_mfma_f32_16x16x32_bf16 v[28:31], v[184:187], v[40:43], v[28:31]
  v_cvt_pk_bf16_f32 v50, v39, v39
  v_and_b32 v44, v50, v5
  v_and_b32 v45, v50, v6
  v_and_b32 v46, v50, v7
  v_and_b32 v47, v50, v8
  s_nop 1
  v_mfma_f32_16x16x32_bf16 v[28:31], v[188:191], v[44:47], v[28:31]
  buffer_load_dwordx4 v[176:179], v62, s[4:7], s89 offen offset:0 nt
  buffer_load_dwordx4 v[180:183], v62, s[4:7], s89 offen offset:1024 nt
  buffer_load_dwordx4 v[184:187], v62, s[4:7], s89 offen offset:2048 nt
  buffer_load_dwordx4 v[188:191], v62, s[4:7], s89 offen offset:3072 nt
  s_branch L_loop
L_mloop:
L_m0:
  s_waitcnt lgkmcnt(0)
  v_readfirstlane_b32 s66, v11
  s_mov_b64 exec, 1
  ds_add_rtn_u32 v11, v10, v9 offset:10304
  s_mov_b64 exec, -1
  s_cmp_lg_u32 s82, -1
  s_cbranch_scc1 L_have_1
  s_mov_b32 s74, 4194304
L_sp_2:
  ds_read_b64 v[52:53], v10 offset:10320
  s_waitcnt lgkmcnt(0)
  v_readfirstlane_b32 s82, v52
  v_readfirstlane_b32 s83, v53
  s_nop 3
  s_cmp_lg_u32 s82, -1
  s_cbranch_scc1 L_have_1
  s_sleep 2
  s_sub_u32 s74, s74, 1
  s_cmp_lg_u32 s74, 0
  s_cbranch_scc1 L_sp_2
  s_mov_b32 s82, 0
  s_mov_b32 s83, 0
L_have_1:
  s_sub_u32 s65, s66, s64
  s_sub_u32 s65, s65, s93
  s_cmp_lt_u32 s65, s83
  s_cbranch_scc0 L_drain0
  s_add_u32 s67, s65, s82
  s_and_b32 s67, s67, 2047
  s_lshl_b32 s62, s67, 12
  s_add_u32 s62, s62, s95
  s_cmp_eq_u32 s76, 3
  s_cbranch_scc1 L_ism_3
  s_lshl_b32 s65, s85, 7
  v_add_u32 v54, s65, v63
  ds_read_b128 v[16:19], v54 offset:20480
  ds_read_b128 v[20:23], v54 offset:20496
  s_waitcnt lgkmcnt(0)
  v_max3_f32 v50, v16, v17, v18
  v_max3_f32 v51, v19, v20, v21
  v_max3_f32 v50, v22, v23, v50
  v_max_f32 v50, v50, v51
  v_mov_b32 v51, v50
  s_nop 1
  v_permlane16_swap_b32 v50, v51
  v_max_f32 v50, v50, v51
  v_mov_b32 v51, v50
  s_nop 1
  v_permlane32_swap_b32 v50, v51
  v_max3_f32 v50, v50, v51, v48
  v_mul_f32 v51, s58, v50
  v_fma_f32 v52, v48, s58, -v51
  v_fma_f32 v32, v16, s58, -v51
  v_fma_f32 v33, v17, s58, -v51
  v_fma_f32 v34, v18, s58, -v51
  v_fma_f32 v35, v19, s58, -v51
  v_fma_f32 v36, v20, s58, -v51
  v_fma_f32 v37, v21, s58, -v51
  v_fma_f32 v38, v22, s58, -v51
  v_fma_f32 v39, v23, s58, -v51
  v_exp_f32 v52, v52
  v_exp_f32 v32, v32
  v_exp_f32 v33, v33
  v_exp_f32 v34, v34
  v_exp_f32 v35, v35
  v_exp_f32 v36, v36
  v_exp_f32 v37, v37
  v_exp_f32 v38, v38
  v_exp_f32 v39, v39
  v_mov_b32 v48, v50
  v_fma_f32 v49, v49, v52, v32
  v_add_f32 v51, v33, v34
  v_add_f32 v50, v35, v36
  v_mul_f32 v28, v28, v52
  v_mul_f32 v29, v29, v52
  v_mul_f32 v30, v30, v52
  v_mul_f32 v31, v31, v52
  v_add_f32 v51, v51, v37
  v_add_f32 v50, v50, v38
  v_add_f32 v49, v49, v39
  v_add_f32 v51, v51, v50
  v_add_f32 v49, v49, v51
  s_waitcnt vmcnt(28)
  v_cvt_pk_bf16_f32 v50, v32, v32
  v_and_b32 v40, v50, v5
  v_and_b32 v41, v50, v6
  v_and_b32 v42, v50, v7
  v_and_b32 v43, v50, v8
  s_nop 1
  v_mfma_f32_16x16x32_bf16 v[28:31], v[64:67], v[40:43], v[28:31]
  v_cvt_pk_bf16_f32 v50, v33, v33
  v_and_b32 v44, v50, v5
  v_and_b32 v45, v50, v6
  v_and_b32 v46, v50, v7
  v_and_b32 v47, v50, v8
  s_nop 1
  v_mfma_f32_16x16x32_bf16 v[28:31], v[68:71], v[44:47], v[28:31]
  v_cvt_pk_bf16_f32 v50, v34, v34
  v_and_b32 v40, v50, v5
  v_and_b32 v41, v50, v6
  v_and_b32 v42, v50, v7
  v_and_b32 v43, v50, v8
  s_nop 1
  v_mfma_f32_16x16x32_bf16 v[28:31], v[72:75], v[40:43], v[28:31]
  v_cvt_pk_bf16_f32 v50, v35, v35
  v_and_b32 v44, v50, v5
  v_and_b32 v45, v50, v6
  v_and_b32 v46, v50, v7
  v_and_b32 v47, v50, v8
  s_nop 1
  v_mfma_f32_16x16x32_bf16 v[28:31], v[76:79], v[44:47], v[28:31]
  buffer_load_dwordx4 v[64:67], v3, s[20:23], s62 offen offset:0 nt
  buffer_load_dwordx4 v[68:71], v3, s[20:23], s62 offen offset:64 nt
  buffer_load_dwordx4 v[72:75], v3, s[20:23], s62 offen offset:128 nt
  buffer_load_dwordx4 v[76:79], v3, s[20:23], s62 offen offset:192 nt
  s_waitcnt vmcnt(28)
  v_cvt_pk_bf16_f32 v50, v36, v36
  v_and_b32 v40, v50, v5
  v_and_b32 v41, v50, v6
  v_and_b32 v42, v50, v7
  v_and_b32 v43, v50, v8
  s_nop 1
  v_mfma_f32_16x16x32_bf16 v[28:31], v[80:83], v[40:43], v[28:31]
  v_cvt_pk_bf16_f32 v50, v37, v37
  v_and_b32 v44, v50, v5
  v_and_b32 v45, v50, v6
  v_and_b32 v46, v50, v7
  v_and_b32 v47, v50, v8
  s_nop 1
  v_mfma_f32_16x16x32_bf16 v[28:31], v[84:87], v[44:47], v[28:31]
  v_cvt_pk_bf16_f32 v50, v38, v38
  v_and_b32 v40, v50, v5
  v_and_b32 v41, v50, v6
  v_and_b32 v42, v50, v7
  v_and_b32 v43, v50, v8
  s_nop 1
  v_mfma_f32_16x16x32_bf16 v[28:31], v[88:91], v[40:43], v[28:31]
  v_cvt_pk_bf16_f32 v50, v39, v39
  v_and_b32 v44, v50, v5
  v_and_b32 v45, v50, v6
  v_and_b32 v46, v50, v7
  v_and_b32 v47, v50, v8
  s_nop 1
  v_mfma_f32_16x16x32_bf16 v[28:31], v[92:95], v[44:47], v[28:31]
  buffer_load_dwordx4 v[80:83], v4, s[8:11], s62 offen offset:0 nt
  buffer_load_dwordx4 v[84:87], v4, s[8:11], s62 offen offset:256 nt
  buffer_load_dwordx4 v[88:91], v4, s[8:11], s62 offen offset:512 nt
  buffer_load_dwordx4 v[92:95], v4, s[8:11], s62 offen offset:768 nt
  s_branch L_ei_4
L_ism_3:
  s_waitcnt vmcnt(28)
  v_mfma_f32_16x16x32_bf16 v[32:35], v[64:67], v[224:227], 0
  v_mfma_f32_16x16x32_bf16 v[32:35], v[68:71], v[228:231], v[32:35]
  v_mfma_f32_16x16x32_bf16 v[32:35], v[72:75], v[232:235], v[32:35]
  v_mfma_f32_16x16x32_bf16 v[32:35], v[76:79], v[236:239], v[32:35]
  buffer_load_dwordx4 v[64:67], v3, s[20:23], s62 offen offset:0 nt
  buffer_load_dwordx4 v[68:71], v3, s[20:23], s62 offen offset:64 nt
  buffer_load_dwordx4 v[72:75], v3, s[20:23], s62 offen offset:128 nt
  buffer_load_dwordx4 v[76:79], v3, s[20:23], s62 offen offset:192 nt
  s_nop 7
  v_max_f32 v50, v32, v33
  v_max3_f32 v50, v34, v35, v50
  v_mov_b32 v51, v50
  s_nop 1
  v_permlane16_swap_b32 v50, v51
  v_max_f32 v50, v50, v51
  v_mov_b32 v51, v50
  s_nop 1
  v_permlane32_swap_b32 v50, v51
  v_max3_f32 v50, v50, v51, v48
  v_mul_f32 v51, s58, v50
  v_fma_f32 v52, v48, s58, -v51
  v_fma_f32 v36, v32, s58, -v51
  v_fma_f32 v37, v33, s58, -v51
  v_fma_f32 v38, v34, s58, -v51
  v_fma_f32 v39, v35, s58, -v51
  v_exp_f32 v52, v52
  v_exp_f32 v36, v36
  v_exp_f32 v37, v37
  v_exp_f32 v38, v38
  v_exp_f32 v39, v39
  v_mov_b32 v48, v50
  v_fma_f32 v49, v49, v52, v36
  v_add_f32 v51, v37, v38
  v_mul_f32 v28, v28, v52
  v_mul_f32 v29, v29, v52
  v_mul_f32 v30, v30, v52
  v_mul_f32 v31, v31, v52
  v_add_f32 v49, v49, v39
  v_add_f32 v49, v49, v51
  s_waitcnt vmcnt(28)
  v_cvt_pk_bf16_f32 v50, v36, v36
  v_and_b32 v40, v50, v5
  v_and_b32 v41, v50, v6
  v_and_b32 v42, v50, v7
  v_and_b32 v43, v50, v8
  s_nop 1
  v_mfma_f32_16x16x32_bf16 v[28:31], v[80:83], v[40:43], v[28:31]
  v_cvt_pk_bf16_f32 v50, v37, v37
  v_and_b32 v44, v50, v5
  v_and_b32 v45, v50, v6
  v_and_b32 v46, v50, v7
  v_and_b32 v47, v50, v8
  s_nop 1
  v_mfma_f32_16x16x32_bf16 v[28:31], v[84:87], v[44:47], v[28:31]
  v_cvt_pk_bf16_f32 v50, v38, v38
  v_and_b32 v40, v50, v5
  v_and_b32 v41, v50, v6
  v_and_b32 v42, v50, v7
  v_and_b32 v43, v50, v8
  s_nop 1
  v_mfma_f32_16x16x32_bf16 v[28:31], v[88:91], v[40:43], v[28:31]
  v_cvt_pk_bf16_f32 v50, v39, v39
  v_and_b32 v44, v50, v5
  v_and_b32 v45, v50, v6
  v_and_b32 v46, v50, v7
  v_and_b32 v47, v50, v8
  s_nop 1
  v_mfma_f32_16x16x32_bf16 v[28:31], v[92:95], v[44:47], v[28:31]
  buffer_load_dwordx4 v[80:83], v4, s[8:11], s62 offen offset:0 nt
  buffer_load_dwordx4 v[84:87], v4, s[8:11], s62 offen offset:256 nt
  buffer_load_dwordx4 v[88:91], v4, s[8:11], s62 offen offset:512 nt
  buffer_load_dwordx4 v[92:95], v4, s[8:11], s62 offen offset:768 nt
L_ei_4:
  s_mov_b32 s76, 3
L_m1:
  s_waitcnt lgkmcnt(0)
  v_readfirstlane_b32 s66, v11
  s_mov_b64 exec, 1
  ds_add_rtn_u32 v11, v10, v9 offset:10304
  s_mov_b64 exec, -1
  s_cmp_lg_u32 s82, -1
  s_cbranch_scc1 L_have_5
  s_mov_b32 s74, 4194304
L_sp_6:
  ds_read_b64 v[52:53], v10 offset:10320
  s_waitcnt lgkmcnt(0)
  v_readfirstlane_b32 s82, v52
  v_readfirstlane_b32 s83, v53
  s_nop 3
  s_cmp_lg_u32 s82, -1
  s_cbranch_scc1 L_have_5
  s_sleep 2
  s_sub_u32 s74, s74, 1
  s_cmp_lg_u32 s74, 0
  s_cbranch_scc1 L_sp_6
  s_mov_b32 s82, 0
  s_mov_b32 s83, 0
L_have_5:
  s_sub_u32 s65, s66, s64
  s_sub_u32 s65, s65, s93
  s_cmp_lt_u32 s65, s83
  s_cbranch_scc0 L_drain1
  s_add_u32 s67, s65, s82
  s_and_b32 s67, s67, 2047
  s_lshl_b32 s62, s67, 12
  s_add_u32 s62, s62, s95
  s_cmp_eq_u32 s77, 3
  s_cbranch_scc1 L_ism_7
  s_lshl_b32 s65, s86, 7
  v_add_u32 v54, s65, v63
  ds_read_b128 v[16:19], v54 offset:20480
  ds_read_b128 v[20:23], v54 offset:20496
  s_waitcnt lgkmcnt(0)
  v_max3_f32 v50, v16, v17, v18
  v_max3_f32 v51, v19, v20, v21
  v_max3_f32 v50, v22, v23, v50
  v_max_f32 v50, v50, v51
  v_mov_b32 v51, v50
  s_nop 1
  v_permlane16_swap_b32 v50, v51
  v_max_f32 v50, v50, v51
  v_mov_b32 v51, v50
  s_nop 1
  v_permlane32_swap_b32 v50, v51
  v_max3_f32 v50, v50, v51, v48
  v_mul_f32 v51, s58, v50
  v_fma_f32 v52, v48, s58, -v51
  v_fma_f32 v32, v16, s58, -v51
  v_fma_f32 v33, v17, s58, -v51
  v_fma_f32 v34, v18, s58, -v51
  v_fma_f32 v35, v19, s58, -v51
  v_fma_f32 v36, v20, s58, -v51
  v_fma_f32 v37, v21, s58, -v51
  v_fma_f32 v38, v22, s58, -v51
  v_fma_f32 v39, v23, s58, -v51
  v_exp_f32 v52, v52
  v_exp_f32 v32, v32
  v_exp_f32 v33, v33
  v_exp_f32 v34, v34
  v_exp_f32 v35, v35
  v_exp_f32 v36, v36
  v_exp_f32 v37, v37
  v_exp_f32 v38, v38
  v_exp_f32 v39, v39
  v_mov_b32 v48, v50
  v_fma_f32 v49, v49, v52, v32
  v_add_f32 v51, v33, v34
  v_add_f32 v50, v35, v36
  v_mul_f32 v28, v28, v52
  v_mul_f32 v29, v29, v52
  v_mul_f32 v30, v30, v52
  v_mul_f32 v31, v31, v52
  v_add_f32 v51, v51, v37
  v_add_f32 v50, v50, v38
  v_add_f32 v49, v49, v39
  v_add_f32 v51, v51, v50
  v_add_f32 v49, v49, v51
  s_waitcnt vmcnt(28)
  v_cvt_pk_bf16_f32 v50, v32, v32
  v_and_b32 v40, v50, v5
  v_and_b32 v41, v50, v6
  v_and_b32 v42, v50, v7
  v_and_b32 v43, v50, v8
  s_nop 1
  v_mfma_f32_16x16x32_bf16 v[28:31], v[96:99], v[40:43], v[28:31]
  v_cvt_pk_bf16_f32 v50, v33, v33
  v_and_b32 v44, v50, v5
  v_and_b32 v45, v50, v6
  v_and_b32 v46, v50, v7
  v_and_b32 v47, v50, v8
  s_nop 1
  v_mfma_f32_16x16x32_bf16 v[28:31], v[100:103], v[44:47], v[28:31]
  v_cvt_pk_bf16_f32 v50, v34, v34
  v_and_b32 v40, v50, v5
  v_and_b32 v41, v50, v6
  v_and_b32 v42, v50, v7
  v_and_b32 v43, v50, v8
  s_nop 1
  v_mfma_f32_16x16x32_bf16 v[28:31], v[104:107], v[40:43], v[28:31]
  v_cvt_pk_bf16_f32 v50, v35, v35
  v_and_b32 v44, v50, v5
  v_and_b32 v45, v50, v6
  v_and_b32 v46, v50, v7
  v_and_b32 v47, v50, v8
  s_nop 1
  v_mfma_f32_16x16x32_bf16 v[28:31], v[108:111], v[44:47], v[28:31]
  buffer_load_dwordx4 v[96:99], v3, s[20:23], s62 offen offset:0 nt
  buffer_load_dwordx4 v[100:103], v3, s[20:23], s62 offen offset:64 nt
  buffer_load_dwordx4 v[104:107], v3, s[20:23], s62 offen offset:128 nt
  buffer_load_dwordx4 v[108:111], v3, s[20:23], s62 offen offset:192 nt
  s_waitcnt vmcnt(28)
  v_cvt_pk_bf16_f32 v50, v36, v36
  v_and_b32 v40, v50, v5
  v_and_b32 v41, v50, v6
  v_and_b32 v42, v50, v7
  v_and_b32 v43, v50, v8
  s_nop 1
  v_mfma_f32_16x16x32_bf16 v[28:31], v[112:115], v[40:43], v[28:31]
  v_cvt_pk_bf16_f32 v50, v37, v37
  v_and_b32 v44, v50, v5
  v_and_b32 v45, v50, v6
  v_and_b32 v46, v50, v7
  v_and_b32 v47, v50, v8
  s_nop 1
  v_mfma_f32_16x16x32_bf16 v[28:31], v[116:119], v[44:47], v[28:31]
  v_cvt_pk_bf16_f32 v50, v38, v38
  v_and_b32 v40, v50, v5
  v_and_b32 v41, v50, v6
  v_and_b32 v42, v50, v7
  v_and_b32 v43, v50, v8
  s_nop 1
  v_mfma_f32_16x16x32_bf16 v[28:31], v[120:123], v[40:43], v[28:31]
  v_cvt_pk_bf16_f32 v50, v39, v39
  v_and_b32 v44, v50, v5
  v_and_b32 v45, v50, v6
  v_and_b32 v46, v50, v7
  v_and_b32 v47, v50, v8
  s_nop 1
  v_mfma_f32_16x16x32_bf16 v[28:31], v[124:127], v[44:47], v[28:31]
  buffer_load_dwordx4 v[112:115], v4, s[8:11], s62 offen offset:0 nt
  buffer_load_dwordx4 v[116:119], v4, s[8:11], s62 offen offset:256 nt
  buffer_load_dwordx4 v[120:123], v4, s[8:11], s62 offen offset:512 nt
  buffer_load_dwordx4 v[124:127], v4, s[8:11], s62 offen offset:768 nt
  s_branch L_ei_8
L_ism_7:
  s_waitcnt vmcnt(28)
  v_mfma_f32_16x16x32_bf16 v[32:35], v[96:99], v[224:227], 0
  v_mfma_f32_16x16x32_bf16 v[32:35], v[100:103], v[228:231], v[32:35]
  v_mfma_f32_16x16x32_bf16 v[32:35], v[104:107], v[232:235], v[32:35]
  v_mfma_f32_16x16x32_bf16 v[32:35], v[108:111], v[236:239], v[32:35]
  buffer_load_dwordx4 v[96:99], v3, s[20:23], s62 offen offset:0 nt
  buffer_load_dwordx4 v[100:103], v3, s[20:23], s62 offen offset:64 nt
  buffer_load_dwordx4 v[104:107], v3, s[20:23], s62 offen offset:128 nt
  buffer_load_dwordx4 v[108:111], v3, s[20:23], s62 offen offset:192 nt
  s_nop 7
  v_max_f32 v50, v32, v33
  v_max3_f32 v50, v34, v35, v50
  v_mov_b32 v51, v50
  s_nop 1
  v_permlane16_swap_b32 v50, v51
  v_max_f32 v50, v50, v51
  v_mov_b32 v51, v50
  s_nop 1
  v_permlane32_swap_b32 v50, v51
  v_max3_f32 v50, v50, v51, v48
  v_mul_f32 v51, s58, v50
  v_fma_f32 v52, v48, s58, -v51
  v_fma_f32 v36, v32, s58, -v51
  v_fma_f32 v37, v33, s58, -v51
  v_fma_f32 v38, v34, s58, -v51
  v_fma_f32 v39, v35, s58, -v51
  v_exp_f32 v52, v52
  v_exp_f32 v36, v36
  v_exp_f32 v37, v37
  v_exp_f32 v38, v38
  v_exp_f32 v39, v39
  v_mov_b32 v48, v50
  v_fma_f32 v49, v49, v52, v36
  v_add_f32 v51, v37, v38
  v_mul_f32 v28, v28, v52
  v_mul_f32 v29, v29, v52
  v_mul_f32 v30, v30, v52
  v_mul_f32 v31, v31, v52
  v_add_f32 v49, v49, v39
  v_add_f32 v49, v49, v51
  s_waitcnt vmcnt(28)
  v_cvt_pk_bf16_f32 v50, v36, v36
  v_and_b32 v40, v50, v5
  v_and_b32 v41, v50, v6
  v_and_b32 v42, v50, v7
  v_and_b32 v43, v50, v8
  s_nop 1
  v_mfma_f32_16x16x32_bf16 v[28:31], v[112:115], v[40:43], v[28:31]
  v_cvt_pk_bf16_f32 v50, v37, v37
  v_and_b32 v44, v50, v5
  v_and_b32 v45, v50, v6
  v_and_b32 v46, v50, v7
  v_and_b32 v47, v50, v8
  s_nop 1
  v_mfma_f32_16x16x32_bf16 v[28:31], v[116:119], v[44:47], v[28:31]
  v_cvt_pk_bf16_f32 v50, v38, v38
  v_and_b32 v40, v50, v5
  v_and_b32 v41, v50, v6
  v_and_b32 v42, v50, v7
  v_and_b32 v43, v50, v8
  s_nop 1
  v_mfma_f32_16x16x32_bf16 v[28:31], v[120:123], v[40:43], v[28:31]
  v_cvt_pk_bf16_f32 v50, v39, v39
  v_and_b32 v44, v50, v5
  v_and_b32 v45, v50, v6
  v_and_b32 v46, v50, v7
  v_and_b32 v47, v50, v8
  s_nop 1
  v_mfma_f32_16x16x32_bf16 v[28:31], v[124:127], v[44:47], v[28:31]
  buffer_load_dwordx4 v[112:115], v4, s[8:11], s62 offen offset:0 nt
  buffer_load_dwordx4 v[116:119], v4, s[8:11], s62 offen offset:256 nt
  buffer_load_dwordx4 v[120:123], v4, s[8:11], s62 offen offset:512 nt
  buffer_load_dwordx4 v[124:127], v4, s[8:11], s62 offen offset:768 nt
L_ei_8:
  s_mov_b32 s77, 3
L_m2:
  s_waitcnt lgkmcnt(0)
  v_readfirstlane_b32 s66, v11
  s_mov_b64 exec, 1
  ds_add_rtn_u32 v11, v10, v9 offset:10304
  s_mov_b64 exec, -1
  s_cmp_lg_u32 s82, -1
  s_cbranch_scc1 L_have_9
  s_mov_b32 s74, 4194304
L_sp_10:
  ds_read_b64 v[52:53], v10 offset:10320
  s_waitcnt lgkmcnt(0)
  v_readfirstlane_b32 s82, v52
  v_readfirstlane_b32 s83, v53
  s_nop 3
  s_cmp_lg_u32 s82, -1
  s_cbranch_scc1 L_have_9
  s_sleep 2
  s_sub_u32 s74, s74, 1
  s_cmp_lg_u32 s74, 0
  s_cbranch_scc1 L_sp_10
  s_mov_b32 s82, 0
  s_mov_b32 s83, 0
L_have_9:
  s_sub_u32 s65, s66, s64
  s_sub_u32 s65, s65, s93
  s_cmp_lt_u32 s65, s83
  s_cbranch_scc0 L_drain2
  s_add_u32 s67, s65, s82
  s_and_b32 s67, s67, 2047
  s_lshl_b32 s62, s67, 12
  s_add_u32 s62, s62, s95
  s_cmp_eq_u32 s78, 3
  s_cbranch_scc1 L_ism_11
  s_lshl_b32 s65, s87, 7
  v_add_u32 v54, s65, v63
  ds_read_b128 v[16:19], v54 offset:20480
  ds_read_b128 v[20:23], v54 offset:20496
  s_waitcnt lgkmcnt(0)
  v_max3_f32 v50, v16, v17, v18
  v_max3_f32 v51, v19, v20, v21
  v_max3_f32 v50, v22, v23, v50
  v_max_f32 v50, v50, v51
  v_mov_b32 v51, v50
  s_nop 1
  v_permlane16_swap_b32 v50, v51
  v_max_f32 v50, v50, v51
  v_mov_b32 v51, v50
  s_nop 1
  v_permlane32_swap_b32 v50, v51
  v_max3_f32 v50, v50, v51, v48
  v_mul_f32 v51, s58, v50
  v_fma_f32 v52, v48, s58, -v51
  v_fma_f32 v32, v16, s58, -v51
  v_fma_f32 v33, v17, s58, -v51
  v_fma_f32 v34, v18, s58, -v51
  v_fma_f32 v35, v19, s58, -v51
  v_fma_f32 v36, v20, s58, -v51
  v_fma_f32 v37, v21, s58, -v51
  v_fma_f32 v38, v22, s58, -v51
  v_fma_f32 v39, v23, s58, -v51
  v_exp_f32 v52, v52
  v_exp_f32 v32, v32
  v_exp_f32 v33, v33
  v_exp_f32 v34, v34
  v_exp_f32 v35, v35
  v_exp_f32 v36, v36
  v_exp_f32 v37, v37
  v_exp_f32 v38, v38
  v_exp_f32 v39, v39
  v_mov_b32 v48, v50
  v_fma_f32 v49, v49, v52, v32
  v_add_f32 v51, v33, v34
  v_add_f32 v50, v35, v36
  v_mul_f32 v28, v28, v52
  v_mul_f32 v29, v29, v52
  v_mul_f32 v30, v30, v52
  v_mul_f32 v31, v31, v52
  v_add_f32 v51, v51, v37
  v_add_f32 v50, v50, v38
  v_add_f32 v49, v49, v39
  v_add_f32 v51, v51, v50
  v_add_f32 v49, v49, v51
  s_waitcnt vmcnt(28)
  v_cvt_pk_bf16_f32 v50, v32, v32
  v_and_b32 v40, v50, v5
  v_and_b32 v41, v50, v6
  v_and_b32 v42, v50, v7
  v_and_b32 v43, v50, v8
  s_nop 1
  v_mfma_f32_16x16x32_bf16 v[28:31], v[128:131], v[40:43], v[28:31]
  v_cvt_pk_bf16_f32 v50, v33, v33
  v_and_b32 v44, v50, v5
  v_and_b32 v45, v50, v6
  v_and_b32 v46, v50, v7
  v_and_b32 v47, v50, v8
  s_nop 1
  v_mfma_f32_16x16x32_bf16 v[28:31], v[132:135], v[44:47], v[28:31]
  v_cvt_pk_bf16_f32 v50, v34, v34
  v_and_b32 v40, v50, v5
  v_and_b32 v41, v50, v6
  v_and_b32 v42, v50, v7
  v_and_b32 v43, v50, v8
  s_nop 1
  v_mfma_f32_16x16x32_bf16 v[28:31], v[136:139], v[40:43], v[28:31]
  v_cvt_pk_bf16_f32 v50, v35, v35
  v_and_b32 v44, v50, v5
  v_and_b32 v45, v50, v6
  v_and_b32 v46, v50, v7
  v_and_b32 v47, v50, v8
  s_nop 1
  v_mfma_f32_16x16x32_bf16 v[28:31], v[140:143], v[44:47], v[28:31]
  buffer_load_dwordx4 v[128:131], v3, s[20:23], s62 offen offset:0 nt
  buffer_load_dwordx4 v[132:135], v3, s[20:23], s62 offen offset:64 nt
  buffer_load_dwordx4 v[136:139], v3, s[20:23], s62 offen offset:128 nt
  buffer_load_dwordx4 v[140:143], v3, s[20:23], s62 offen offset:192 nt
  s_waitcnt vmcnt(28)
  v_cvt_pk_bf16_f32 v50, v36, v36
  v_and_b32 v40, v50, v5
  v_and_b32 v41, v50, v6
  v_and_b32 v42, v50, v7
  v_and_b32 v43, v50, v8
  s_nop 1
  v_mfma_f32_16x16x32_bf16 v[28:31], v[144:147], v[40:43], v[28:31]
  v_cvt_pk_bf16_f32 v50, v37, v37
  v_and_b32 v44, v50, v5
  v_and_b32 v45, v50, v6
  v_and_b32 v46, v50, v7
  v_and_b32 v47, v50, v8
  s_nop 1
  v_mfma_f32_16x16x32_bf16 v[28:31], v[148:151], v[44:47], v[28:31]
  v_cvt_pk_bf16_f32 v50, v38, v38
  v_and_b32 v40, v50, v5
  v_and_b32 v41, v50, v6
  v_and_b32 v42, v50, v7
  v_and_b32 v43, v50, v8
  s_nop 1
  v_mfma_f32_16x16x32_bf16 v[28:31], v[152:155], v[40:43], v[28:31]
  v_cvt_pk_bf16_f32 v50, v39, v39
  v_and_b32 v44, v50, v5
  v_and_b32 v45, v50, v6
  v_and_b32 v46, v50, v7
  v_and_b32 v47, v50, v8
  s_nop 1
  v_mfma_f32_16x16x32_bf16 v[28:31], v[156:159], v[44:47], v[28:31]
  buffer_load_dwordx4 v[144:147], v4, s[8:11], s62 offen offset:0 nt
  buffer_load_dwordx4 v[148:151], v4, s[8:11], s62 offen offset:256 nt
  buffer_load_dwordx4 v[152:155], v4, s[8:11], s62 offen offset:512 nt
  buffer_load_dwordx4 v[156:159], v4, s[8:11], s62 offen offset:768 nt
  s_branch L_ei_12
L_ism_11:
  s_waitcnt vmcnt(28)
  v_mfma_f32_16x16x32_bf16 v[32:35], v[128:131], v[224:227], 0
  v_mfma_f32_16x16x32_bf16 v[32:35], v[132:135], v[228:231], v[32:35]
  v_mfma_f32_16x16x32_bf16 v[32:35], v[136:139], v[232:235], v[32:35]
  v_mfma_f32_16x16x32_bf16 v[32:35], v[140:143], v[236:239], v[32:35]
  buffer_load_dwordx4 v[128:131], v3, s[20:23], s62 offen offset:0 nt
  buffer_load_dwordx4 v[132:135], v3, s[20:23], s62 offen offset:64 nt
  buffer_load_dwordx4 v[136:139], v3, s[20:23], s62 offen offset:128 nt
  buffer_load_dwordx4 v[140:143], v3, s[20:23], s62 offen offset:192 nt
  s_nop 7
  v_max_f32 v50, v32, v33
  v_max3_f32 v50, v34, v35, v50
  v_mov_b32 v51, v50
  s_nop 1
  v_permlane16_swap_b32 v50, v51
  v_max_f32 v50, v50, v51
  v_mov_b32 v51, v50
  s_nop 1
  v_permlane32_swap_b32 v50, v51
  v_max3_f32 v50, v50, v51, v48
  v_mul_f32 v51, s58, v50
  v_fma_f32 v52, v48, s58, -v51
  v_fma_f32 v36, v32, s58, -v51
  v_fma_f32 v37, v33, s58, -v51
  v_fma_f32 v38, v34, s58, -v51
  v_fma_f32 v39, v35, s58, -v51
  v_exp_f32 v52, v52
  v_exp_f32 v36, v36
  v_exp_f32 v37, v37
  v_exp_f32 v38, v38
  v_exp_f32 v39, v39
  v_mov_b32 v48, v50
  v_fma_f32 v49, v49, v52, v36
  v_add_f32 v51, v37, v38
  v_mul_f32 v28, v28, v52
  v_mul_f32 v29, v29, v52
  v_mul_f32 v30, v30, v52
  v_mul_f32 v31, v31, v52
  v_add_f32 v49, v49, v39
  v_add_f32 v49, v49, v51
  s_waitcnt vmcnt(28)
  v_cvt_pk_bf16_f32 v50, v36, v36
  v_and_b32 v40, v50, v5
  v_and_b32 v41, v50, v6
  v_and_b32 v42, v50, v7
  v_and_b32 v43, v50, v8
  s_nop 1
  v_mfma_f32_16x16x32_bf16 v[28:31], v[144:147], v[40:43], v[28:31]
  v_cvt_pk_bf16_f32 v50, v37, v37
  v_and_b32 v44, v50, v5
  v_and_b32 v45, v50, v6
  v_and_b32 v46, v50, v7
  v_and_b32 v47, v50, v8
  s_nop 1
  v_mfma_f32_16x16x32_bf16 v[28:31], v[148:151], v[44:47], v[28:31]
  v_cvt_pk_bf16_f32 v50, v38, v38
  v_and_b32 v40, v50, v5
  v_and_b32 v41, v50, v6
  v_and_b32 v42, v50, v7
  v_and_b32 v43, v50, v8
  s_nop 1
  v_mfma_f32_16x16x32_bf16 v[28:31], v[152:155], v[40:43], v[28:31]
  v_cvt_pk_bf16_f32 v50, v39, v39
  v_and_b32 v44, v50, v5
  v_and_b32 v45, v50, v6
  v_and_b32 v46, v50, v7
  v_and_b32 v47, v50, v8
  s_nop 1
  v_mfma_f32_16x16x32_bf16 v[28:31], v[156:159], v[44:47], v[28:31]
  buffer_load_dwordx4 v[144:147], v4, s[8:11], s62 offen offset:0 nt
  buffer_load_dwordx4 v[148:151], v4, s[8:11], s62 offen offset:256 nt
  buffer_load_dwordx4 v[152:155], v4, s[8:11], s62 offen offset:512 nt
  buffer_load_dwordx4 v[156:159], v4, s[8:11], s62 offen offset:768 nt
L_ei_12:
  s_mov_b32 s78, 3
L_m3:
  s_waitcnt lgkmcnt(0)
  v_readfirstlane_b32 s66, v11
  s_mov_b64 exec, 1
  ds_add_rtn_u32 v11, v10, v9 offset:10304
  s_mov_b64 exec, -1
  s_cmp_lg_u32 s82, -1
  s_cbranch_scc1 L_have_13
  s_mov_b32 s74, 4194304
L_sp_14:
  ds_read_b64 v[52:53], v10 offset:10320
  s_waitcnt lgkmcnt(0)
  v_readfirstlane_b32 s82, v52
  v_readfirstlane_b32 s83, v53
  s_nop 3
  s_cmp_lg_u32 s82, -1
  s_cbranch_scc1 L_have_13
  s_sleep 2
  s_sub_u32 s74, s74, 1
  s_cmp_lg_u32 s74, 0
  s_cbranch_scc1 L_sp_14
  s_mov_b32 s82, 0
  s_mov_b32 s83, 0
L_have_13:
  s_sub_u32 s65, s66, s64
  s_sub_u32 s65, s65, s93
  s_cmp_lt_u32 s65, s83
  s_cbranch_scc0 L_drain3
  s_add_u32 s67, s65, s82
  s_and_b32 s67, s67, 2047
  s_lshl_b32 s62, s67, 12
  s_add_u32 s62, s62, s95
  s_cmp_eq_u32 s79, 3
  s_cbranch_scc1 L_ism_15
  s_lshl_b32 s65, s88, 7
  v_add_u32 v54, s65, v63
  ds_read_b128 v[16:19], v54 offset:20480
  ds_read_b128 v[20:23], v54 offset:20496
  s_waitcnt lgkmcnt(0)
  v_max3_f32 v50, v16, v17, v18
  v_max3_f32 v51, v19, v20, v21
  v_max3_f32 v50, v22, v23, v50
  v_max_f32 v50, v50, v51
  v_mov_b32 v51, v50
  s_nop 1
  v_permlane16_swap_b32 v50, v51
  v_max_f32 v50, v50, v51
  v_mov_b32 v51, v50
  s_nop 1
  v_permlane32_swap_b32 v50, v51
  v_max3_f32 v50, v50, v51, v48
  v_mul_f32 v51, s58, v50
  v_fma_f32 v52, v48, s58, -v51
  v_fma_f32 v32, v16, s58, -v51
  v_fma_f32 v33, v17, s58, -v51
  v_fma_f32 v34, v18, s58, -v51
  v_fma_f32 v35, v19, s58, -v51
  v_fma_f32 v36, v20, s58, -v51
  v_fma_f32 v37, v21, s58, -v51
  v_fma_f32 v38, v22, s58, -v51
  v_fma_f32 v39, v23, s58, -v51
  v_exp_f32 v52, v52
  v_exp_f32 v32, v32
  v_exp_f32 v33, v33
  v_exp_f32 v34, v34
  v_exp_f32 v35, v35
  v_exp_f32 v36, v36
  v_exp_f32 v37, v37
  v_exp_f32 v38, v38
  v_exp_f32 v39, v39
  v_mov_b32 v48, v50
  v_fma_f32 v49, v49, v52, v32
  v_add_f32 v51, v33, v34
  v_add_f32 v50, v35, v36
  v_mul_f32 v28, v28, v52
  v_mul_f32 v29, v29, v52
  v_mul_f32 v30, v30, v52
  v_mul_f32 v31, v31, v52
  v_add_f32 v51, v51, v37
  v_add_f32 v50, v50, v38
  v_add_f32 v49, v49, v39
  v_add_f32 v51, v51, v50
  v_add_f32 v49, v49, v51
  s_waitcnt vmcnt(28)
  v_cvt_pk_bf16_f32 v50, v32, v32
  v_and_b32 v40, v50, v5
  v_and_b32 v41, v50, v6
  v_and_b32 v42, v50, v7
  v_and_b32 v43, v50, v8
  s_nop 1
  v_mfma_f32_16x16x32_bf16 v[28:31], v[160:163], v[40:43], v[28:31]
  v_cvt_pk_bf16_f32 v50, v33, v33
  v_and_b32 v44, v50, v5
  v_and_b32 v45, v50, v6
  v_and_b32 v46, v50, v7
  v_and_b32 v47, v50, v8
  s_nop 1
  v_mfma_f32_16x16x32_bf16 v[28:31], v[164:167], v[44:47], v[28:31]
  v_cvt_pk_bf16_f32 v50, v34, v34
  v_and_b32 v40, v50, v5
  v_and_b32 v41, v50, v6
  v_and_b32 v42, v50, v7
  v_and_b32 v43, v50, v8
  s_nop 1
  v_mfma_f32_16x16x32_bf16 v[28:31], v[168:171], v[40:43], v[28:31]
  v_cvt_pk_bf16_f32 v50, v35, v35
  v_and_b32 v44, v50, v5
  v_and_b32 v45, v50, v6
  v_and_b32 v46, v50, v7
  v_and_b32 v47, v50, v8
  s_nop 1
  v_mfma_f32_16x16x32_bf16 v[28:31], v[172:175], v[44:47], v[28:31]
  buffer_load_dwordx4 v[160:163], v3, s[20:23], s62 offen offset:0 nt
  buffer_load_dwordx4 v[164:167], v3, s[20:23], s62 offen offset:64 nt
  buffer_load_dwordx4 v[168:171], v3, s[20:23], s62 offen offset:128 nt
  buffer_load_dwordx4 v[172:175], v3, s[20:23], s62 offen offset:192 nt
  s_waitcnt vmcnt(28)
  v_cvt_pk_bf16_f32 v50, v36, v36
  v_and_b32 v40, v50, v5
  v_and_b32 v41, v50, v6
  v_and_b32 v42, v50, v7
  v_and_b32 v43, v50, v8
  s_nop 1
  v_mfma_f32_16x16x32_bf16 v[28:31], v[176:179], v[40:43], v[28:31]
  v_cvt_pk_bf16_f32 v50, v37, v37
  v_and_b32 v44, v50, v5
  v_and_b32 v45, v50, v6
  v_and_b32 v46, v50, v7
  v_and_b32 v47, v50, v8
  s_nop 1
  v_mfma_f32_16x16x32_bf16 v[28:31], v[180:183], v[44:47], v[28:31]
  v_cvt_pk_bf16_f32 v50, v38, v38
  v_and_b32 v40, v50, v5
  v_and_b32 v41, v50, v6
  v_and_b32 v42, v50, v7
  v_and_b32 v43, v50, v8
  s_nop 1
  v_mfma_f32_16x16x32_bf16 v[28:31], v[184:187], v[40:43], v[28:31]
  v_cvt_pk_bf16_f32 v50, v39, v39
  v_and_b32 v44, v50, v5
  v_and_b32 v45, v50, v6
  v_and_b32 v46, v50, v7
  v_and_b32 v47, v50, v8
  s_nop 1
  v_mfma_f32_16x16x32_bf16 v[28:31], v[188:191], v[44:47], v[28:31]
  buffer_load_dwordx4 v[176:179], v4, s[8:11], s62 offen offset:0 nt
  buffer_load_dwordx4 v[180:183], v4, s[8:11], s62 offen offset:256 nt
  buffer_load_dwordx4 v[184:187], v4, s[8:11], s62 offen offset:512 nt
  buffer_load_dwordx4 v[188:191], v4, s[8:11], s62 offen offset:768 nt
  s_branch L_ei_16
L_ism_15:
  s_waitcnt vmcnt(28)
  v_mfma_f32_16x16x32_bf16 v[32:35], v[160:163], v[224:227], 0
  v_mfma_f32_16x16x32_bf16 v[32:35], v[164:167], v[228:231], v[32:35]
  v_mfma_f32_16x16x32_bf16 v[32:35], v[168:171], v[232:235], v[32:35]
  v_mfma_f32_16x16x32_bf16 v[32:35], v[172:175], v[236:239], v[32:35]
  buffer_load_dwordx4 v[160:163], v3, s[20:23], s62 offen offset:0 nt
  buffer_load_dwordx4 v[164:167], v3, s[20:23], s62 offen offset:64 nt
  buffer_load_dwordx4 v[168:171], v3, s[20:23], s62 offen offset:128 nt
  buffer_load_dwordx4 v[172:175], v3, s[20:23], s62 offen offset:192 nt
  s_nop 7
  v_max_f32 v50, v32, v33
  v_max3_f32 v50, v34, v35, v50
  v_mov_b32 v51, v50
  s_nop 1
  v_permlane16_swap_b32 v50, v51
  v_max_f32 v50, v50, v51
  v_mov_b32 v51, v50
  s_nop 1
  v_permlane32_swap_b32 v50, v51
  v_max3_f32 v50, v50, v51, v48
  v_mul_f32 v51, s58, v50
  v_fma_f32 v52, v48, s58, -v51
  v_fma_f32 v36, v32, s58, -v51
  v_fma_f32 v37, v33, s58, -v51
  v_fma_f32 v38, v34, s58, -v51
  v_fma_f32 v39, v35, s58, -v51
  v_exp_f32 v52, v52
  v_exp_f32 v36, v36
  v_exp_f32 v37, v37
  v_exp_f32 v38, v38
  v_exp_f32 v39, v39
  v_mov_b32 v48, v50
  v_fma_f32 v49, v49, v52, v36
  v_add_f32 v51, v37, v38
  v_mul_f32 v28, v28, v52
  v_mul_f32 v29, v29, v52
  v_mul_f32 v30, v30, v52
  v_mul_f32 v31, v31, v52
  v_add_f32 v49, v49, v39
  v_add_f32 v49, v49, v51
  s_waitcnt vmcnt(28)
  v_cvt_pk_bf16_f32 v50, v36, v36
  v_and_b32 v40, v50, v5
  v_and_b32 v41, v50, v6
  v_and_b32 v42, v50, v7
  v_and_b32 v43, v50, v8
  s_nop 1
  v_mfma_f32_16x16x32_bf16 v[28:31], v[176:179], v[40:43], v[28:31]
  v_cvt_pk_bf16_f32 v50, v37, v37
  v_and_b32 v44, v50, v5
  v_and_b32 v45, v50, v6
  v_and_b32 v46, v50, v7
  v_and_b32 v47, v50, v8
  s_nop 1
  v_mfma_f32_16x16x32_bf16 v[28:31], v[180:183], v[44:47], v[28:31]
  v_cvt_pk_bf16_f32 v50, v38, v38
  v_and_b32 v40, v50, v5
  v_and_b32 v41, v50, v6
  v_and_b32 v42, v50, v7
  v_and_b32 v43, v50, v8
  s_nop 1
  v_mfma_f32_16x16x32_bf16 v[28:31], v[184:187], v[40:43], v[28:31]
  v_cvt_pk_bf16_f32 v50, v39, v39
  v_and_b32 v44, v50, v5
  v_and_b32 v45, v50, v6
  v_and_b32 v46, v50, v7
  v_and_b32 v47, v50, v8
  s_nop 1
  v_mfma_f32_16x16x32_bf16 v[28:31], v[188:191], v[44:47], v[28:31]
  buffer_load_dwordx4 v[176:179], v4, s[8:11], s62 offen offset:0 nt
  buffer_load_dwordx4 v[180:183], v4, s[8:11], s62 offen offset:256 nt
  buffer_load_dwordx4 v[184:187], v4, s[8:11], s62 offen offset:512 nt
  buffer_load_dwordx4 v[188:191], v4, s[8:11], s62 offen offset:768 nt
L_ei_16:
  s_mov_b32 s79, 3
  s_branch L_mloop
L_drain0:
  s_cmp_eq_u32 s76, 3
  s_cbranch_scc1 L_ism_17
  s_lshl_b32 s65, s85, 7
  v_add_u32 v54, s65, v63
  ds_read_b128 v[16:19], v54 offset:20480
  ds_read_b128 v[20:23], v54 offset:20496
  s_waitcnt lgkmcnt(0)
  v_max3_f32 v50, v16, v17, v18
  v_max3_f32 v51, v19, v20, v21
  v_max3_f32 v50, v22, v23, v50
  v_max_f32 v50, v50, v51
  v_mov_b32 v51, v50
  s_nop 1
  v_permlane16_swap_b32 v50, v51
  v_max_f32 v50, v50, v51
  v_mov_b32 v51, v50
  s_nop 1
  v_permlane32_swap_b32 v50, v51
  v_max3_f32 v50, v50, v51, v48
  v_mul_f32 v51, s58, v50
  v_fma_f32 v52, v48, s58, -v51
  v_fma_f32 v32, v16, s58, -v51
  v_fma_f32 v33, v17, s58, -v51
  v_fma_f32 v34, v18, s58, -v51
  v_fma_f32 v35, v19, s58, -v51
  v_fma_f32 v36, v20, s58, -v51
  v_fma_f32 v37, v21, s58, -v51
  v_fma_f32 v38, v22, s58, -v51
  v_fma_f32 v39, v23, s58, -v51
  v_exp_f32 v52, v52
  v_exp_f32 v32, v32
  v_exp_f32 v33, v33
  v_exp_f32 v34, v34
  v_exp_f32 v35, v35
  v_exp_f32 v36, v36
  v_exp_f32 v37, v37
  v_exp_f32 v38, v38
  v_exp_f32 v39, v39
  v_mov_b32 v48, v50
  v_fma_f32 v49, v49, v52, v32
  v_add_f32 v51, v33, v34
  v_add_f32 v50, v35, v36
  v_mul_f32 v28, v28, v52
  v_mul_f32 v29, v29, v52
  v_mul_f32 v30, v30, v52
  v_mul_f32 v31, v31, v52
  v_add_f32 v51, v51, v37
  v_add_f32 v50, v50, v38
  v_add_f32 v49, v49, v39
  v_add_f32 v51, v51, v50
  v_add_f32 v49, v49, v51
  s_waitcnt vmcnt(28)
  v_cvt_pk_bf16_f32 v50, v32, v32
  v_and_b32 v40, v50, v5
  v_and_b32 v41, v50, v6
  v_and_b32 v42, v50, v7
  v_and_b32 v43, v50, v8
  s_nop 1
  v_mfma_f32_16x16x32_bf16 v[28:31], v[64:67], v[40:43], v[28:31]
  v_cvt_pk_bf16_f32 v50, v33, v33
  v_and_b32 v44, v50, v5
  v_and_b32 v45, v50, v6
  v_and_b32 v46, v50, v7
  v_and_b32 v47, v50, v8
  s_nop 1
  v_mfma_f32_16x16x32_bf16 v[28:31], v[68:71], v[44:47], v[28:31]
  v_cvt_pk_bf16_f32 v50, v34, v34
  v_and_b32 v40, v50, v5
  v_and_b32 v41, v50, v6
  v_and_b32 v42, v50, v7
  v_and_b32 v43, v50, v8
  s_nop 1
  v_mfma_f32_16x16x32_bf16 v[28:31], v[72:75], v[40:43], v[28:31]
  v_cvt_pk_bf16_f32 v50, v35, v35
  v_and_b32 v44, v50, v5
  v_and_b32 v45, v50, v6
  v_and_b32 v46, v50, v7
  v_and_b32 v47, v50, v8
  s_nop 1
  v_mfma_f32_16x16x32_bf16 v[28:31], v[76:79], v[44:47], v[28:31]
  s_waitcnt vmcnt(24)
  v_cvt_pk_bf16_f32 v50, v36, v36
  v_and_b32 v40, v50, v5
  v_and_b32 v41, v50, v6
  v_and_b32 v42, v50, v7
  v_and_b32 v43, v50, v8
  s_nop 1
  v_mfma_f32_16x16x32_bf16 v[28:31], v[80:83], v[40:43], v[28:31]
  v_cvt_pk_bf16_f32 v50, v37, v37
  v_and_b32 v44, v50, v5
  v_and_b32 v45, v50, v6
  v_and_b32 v46, v50, v7
  v_and_b32 v47, v50, v8
  s_nop 1
  v_mfma_f32_16x16x32_bf16 v[28:31], v[84:87], v[44:47], v[28:31]
  v_cvt_pk_bf16_f32 v50, v38, v38
  v_and_b32 v40, v50, v5
  v_and_b32 v41, v50, v6
  v_and_b32 v42, v50, v7
  v_and_b32 v43, v50, v8
  s_nop 1
  v_mfma_f32_16x16x32_bf16 v[28:31], v[88:91], v[40:43], v[28:31]
  v_cvt_pk_bf16_f32 v50, v39, v39
  v_and_b32 v44, v50, v5
  v_and_b32 v45, v50, v6
  v_and_b32 v46, v50, v7
  v_and_b32 v47, v50, v8
  s_nop 1
  v_mfma_f32_16x16x32_bf16 v[28:31], v[92:95], v[44:47], v[28:31]
  s_branch L_ei_18
L_ism_17:
  s_waitcnt vmcnt(28)
  v_mfma_f32_16x16x32_bf16 v[32:35], v[64:67], v[224:227], 0
  v_mfma_f32_16x16x32_bf16 v[32:35], v[68:71], v[228:231], v[32:35]
  v_mfma_f32_16x16x32_bf16 v[32:35], v[72:75], v[232:235], v[32:35]
  v_mfma_f32_16x16x32_bf16 v[32:35], v[76:79], v[236:239], v[32:35]
  s_nop 7
  v_max_f32 v50, v32, v33
  v_max3_f32 v50, v34, v35, v50
  v_mov_b32 v51, v50
  s_nop 1
  v_permlane16_swap_b32 v50, v51
  v_max_f32 v50, v50, v51
  v_mov_b32 v51, v50
  s_nop 1
  v_permlane32_swap_b32 v50, v51
  v_max3_f32 v50, v50, v51, v48
  v_mul_f32 v51, s58, v50
  v_fma_f32 v52, v48, s58, -v51
  v_fma_f32 v36, v32, s58, -v51
  v_fma_f32 v37, v33, s58, -v51
  v_fma_f32 v38, v34, s58, -v51
  v_fma_f32 v39, v35, s58, -v51
  v_exp_f32 v52, v52
  v_exp_f32 v36, v36
  v_exp_f32 v37, v37
  v_exp_f32 v38, v38
  v_exp_f32 v39, v39
  v_mov_b32 v48, v50
  v_fma_f32 v49, v49, v52, v36
  v_add_f32 v51, v37, v38
  v_mul_f32 v28, v28, v52
  v_mul_f32 v29, v29, v52
  v_mul_f32 v30, v30, v52
  v_mul_f32 v31, v31, v52
  v_add_f32 v49, v49, v39
  v_add_f32 v49, v49, v51
  s_waitcnt vmcnt(24)
  v_cvt_pk_bf16_f32 v50, v36, v36
  v_and_b32 v40, v50, v5
  v_and_b32 v41, v50, v6
  v_and_b32 v42, v50, v7
  v_and_b32 v43, v50, v8
  s_nop 1
  v_mfma_f32_16x16x32_bf16 v[28:31], v[80:83], v[40:43], v[28:31]
  v_cvt_pk_bf16_f32 v50, v37, v37
  v_and_b32 v44, v50, v5
  v_and_b32 v45, v50, v6
  v_and_b32 v46, v50, v7
  v_and_b32 v47, v50, v8
  s_nop 1
  v_mfma_f32_16x16x32_bf16 v[28:31], v[84:87], v[44:47], v[28:31]
  v_cvt_pk_bf16_f32 v50, v38, v38
  v_and_b32 v40, v50, v5
  v_and_b32 v41, v50, v6
  v_and_b32 v42, v50, v7
  v_and_b32 v43, v50, v8
  s_nop 1
  v_mfma_f32_16x16x32_bf16 v[28:31], v[88:91], v[40:43], v[28:31]
  v_cvt_pk_bf16_f32 v50, v39, v39
  v_and_b32 v44, v50, v5
  v_and_b32 v45, v50, v6
  v_and_b32 v46, v50, v7
  v_and_b32 v47, v50, v8
  s_nop 1
  v_mfma_f32_16x16x32_bf16 v[28:31], v[92:95], v[44:47], v[28:31]
L_ei_18:
  s_cmp_eq_u32 s77, 3
  s_cbranch_scc1 L_ism_19
  s_lshl_b32 s65, s86, 7
  v_add_u32 v54, s65, v63
  ds_read_b128 v[16:19], v54 offset:20480
  ds_read_b128 v[20:23], v54 offset:20496
  s_waitcnt lgkmcnt(0)
  v_max3_f32 v50, v16, v17, v18
  v_max3_f32 v51, v19, v20, v21
  v_max3_f32 v50, v22, v23, v50
  v_max_f32 v50, v50, v51
  v_mov_b32 v51, v50
  s_nop 1
  v_permlane16_swap_b32 v50, v51
  v_max_f32 v50, v50, v51
  v_mov_b32 v51, v50
  s_nop 1
  v_permlane32_swap_b32 v50, v51
  v_max3_f32 v50, v50, v51, v48
  v_mul_f32 v51, s58, v50
  v_fma_f32 v52, v48, s58, -v51
  v_fma_f32 v32, v16, s58, -v51
  v_fma_f32 v33, v17, s58, -v51
  v_fma_f32 v34, v18, s58, -v51
  v_fma_f32 v35, v19, s58, -v51
  v_fma_f32 v36, v20, s58, -v51
  v_fma_f32 v37, v21, s58, -v51
  v_fma_f32 v38, v22, s58, -v51
  v_fma_f32 v39, v23, s58, -v51
  v_exp_f32 v52, v52
  v_exp_f32 v32, v32
  v_exp_f32 v33, v33
  v_exp_f32 v34, v34
  v_exp_f32 v35, v35
  v_exp_f32 v36, v36
  v_exp_f32 v37, v37
  v_exp_f32 v38, v38
  v_exp_f32 v39, v39
  v_mov_b32 v48, v50
  v_fma_f32 v49, v49, v52, v32
  v_add_f32 v51, v33, v34
  v_add_f32 v50, v35, v36
  v_mul_f32 v28, v28, v52
  v_mul_f32 v29, v29, v52
  v_mul_f32 v30, v30, v52
  v_mul_f32 v31, v31, v52
  v_add_f32 v51, v51, v37
  v_add_f32 v50, v50, v38
  v_add_f32 v49, v49, v39
  v_add_f32 v51, v51, v50
  v_add_f32 v49, v49, v51
  s_waitcnt vmcnt(20)
  v_cvt_pk_bf16_f32 v50, v32, v32
  v_and_b32 v40, v50, v5
  v_and_b32 v41, v50, v6
  v_and_b32 v42, v50, v7
  v_and_b32 v43, v50, v8
  s_nop 1
  v_mfma_f32_16x16x32_bf16 v[28:31], v[96:99], v[40:43], v[28:31]
  v_cvt_pk_bf16_f32 v50, v33, v33
  v_and_b32 v44, v50, v5
  v_and_b32 v45, v50, v6
  v_and_b32 v46, v50, v7
  v_and_b32 v47, v50, v8
  s_nop 1
  v_mfma_f32_16x16x32_bf16 v[28:31], v[100:103], v[44:47], v[28:31]
  v_cvt_pk_bf16_f32 v50, v34, v34
  v_and_b32 v40, v50, v5
  v_and_b32 v41, v50, v6
  v_and_b32 v42, v50, v7
  v_and_b32 v43, v50, v8
  s_nop 1
  v_mfma_f32_16x16x32_bf16 v[28:31], v[104:107], v[40:43], v[28:31]
  v_cvt_pk_bf16_f32 v50, v35, v35
  v_and_b32 v44, v50, v5
  v_and_b32 v45, v50, v6
  v_and_b32 v46, v50, v7
  v_and_b32 v47, v50, v8
  s_nop 1
  v_mfma_f32_16x16x32_bf16 v[28:31], v[108:111], v[44:47], v[28:31]
  s_waitcnt vmcnt(16)
  v_cvt_pk_bf16_f32 v50, v36, v36
  v_and_b32 v40, v50, v5
  v_and_b32 v41, v50, v6
  v_and_b32 v42, v50, v7
  v_and_b32 v43, v50, v8
  s_nop 1
  v_mfma_f32_16x16x32_bf16 v[28:31], v[112:115], v[40:43], v[28:31]
  v_cvt_pk_bf16_f32 v50, v37, v37
  v_and_b32 v44, v50, v5
  v_and_b32 v45, v50, v6
  v_and_b32 v46, v50, v7
  v_and_b32 v47, v50, v8
  s_nop 1
  v_mfma_f32_16x16x32_bf16 v[28:31], v[116:119], v[44:47], v[28:31]
  v_cvt_pk_bf16_f32 v50, v38, v38
  v_and_b32 v40, v50, v5
  v_and_b32 v41, v50, v6
  v_and_b32 v42, v50, v7
  v_and_b32 v43, v50, v8
  s_nop 1
  v_mfma_f32_16x16x32_bf16 v[28:31], v[120:123], v[40:43], v[28:31]
  v_cvt_pk_bf16_f32 v50, v39, v39
  v_and_b32 v44, v50, v5
  v_and_b32 v45, v50, v6
  v_and_b32 v46, v50, v7
  v_and_b32 v47, v50, v8
  s_nop 1
  v_mfma_f32_16x16x32_bf16 v[28:31], v[124:127], v[44:47], v[28:31]
  s_branch L_ei_20
L_ism_19:
  s_waitcnt vmcnt(20)
  v_mfma_f32_16x16x32_bf16 v[32:35], v[96:99], v[224:227], 0
  v_mfma_f32_16x16x32_bf16 v[32:35], v[100:103], v[228:231], v[32:35]
  v_mfma_f32_16x16x32_bf16 v[32:35], v[104:107], v[232:235], v[32:35]
  v_mfma_f32_16x16x32_bf16 v[32:35], v[108:111], v[236:239], v[32:35]
  s_nop 7
  v_max_f32 v50, v32, v33
  v_max3_f32 v50, v34, v35, v50
  v_mov_b32 v51, v50
  s_nop 1
  v_permlane16_swap_b32 v50, v51
  v_max_f32 v50, v50, v51
  v_mov_b32 v51, v50
  s_nop 1
  v_permlane32_swap_b32 v50, v51
  v_max3_f32 v50, v50, v51, v48
  v_mul_f32 v51, s58, v50
  v_fma_f32 v52, v48, s58, -v51
  v_fma_f32 v36, v32, s58, -v51
  v_fma_f32 v37, v33, s58, -v51
  v_fma_f32 v38, v34, s58, -v51
  v_fma_f32 v39, v35, s58, -v51
  v_exp_f32 v52, v52
  v_exp_f32 v36, v36
  v_exp_f32 v37, v37
  v_exp_f32 v38, v38
  v_exp_f32 v39, v39
  v_mov_b32 v48, v50
  v_fma_f32 v49, v49, v52, v36
  v_add_f32 v51, v37, v38
  v_mul_f32 v28, v28, v52
  v_mul_f32 v29, v29, v52
  v_mul_f32 v30, v30, v52
  v_mul_f32 v31, v31, v52
  v_add_f32 v49, v49, v39
  v_add_f32 v49, v49, v51
  s_waitcnt vmcnt(16)
  v_cvt_pk_bf16_f32 v50, v36, v36
  v_and_b32 v40, v50, v5
  v_and_b32 v41, v50, v6
  v_and_b32 v42, v50, v7
  v_and_b32 v43, v50, v8
  s_nop 1
  v_mfma_f32_16x16x32_bf16 v[28:31], v[112:115], v[40:43], v[28:31]
  v_cvt_pk_bf16_f32 v50, v37, v37
  v_and_b32 v44, v50, v5
  v_and_b32 v45, v50, v6
  v_and_b32 v46, v50, v7
  v_and_b32 v47, v50, v8
  s_nop 1
  v_mfma_f32_16x16x32_bf16 v[28:31], v[116:119], v[44:47], v[28:31]
  v_cvt_pk_bf16_f32 v50, v38, v38
  v_and_b32 v40, v50, v5
  v_and_b32 v41, v50, v6
  v_and_b32 v42, v50, v7
  v_and_b32 v43, v50, v8
  s_nop 1
  v_mfma_f32_16x16x32_bf16 v[28:31], v[120:123], v[40:43], v[28:31]
  v_cvt_pk_bf16_f32 v50, v39, v39
  v_and_b32 v44, v50, v5
  v_and_b32 v45, v50, v6
  v_and_b32 v46, v50, v7
  v_and_b32 v47, v50, v8
  s_nop 1
  v_mfma_f32_16x16x32_bf16 v[28:31], v[124:127], v[44:47], v[28:31]
L_ei_20:
  s_cmp_eq_u32 s78, 3
  s_cbranch_scc1 L_ism_21
  s_lshl_b32 s65, s87, 7
  v_add_u32 v54, s65, v63
  ds_read_b128 v[16:19], v54 offset:20480
  ds_read_b128 v[20:23], v54 offset:20496
  s_waitcnt lgkmcnt(0)
  v_max3_f32 v50, v16, v17, v18
  v_max3_f32 v51, v19, v20, v21
  v_max3_f32 v50, v22, v23, v50
  v_max_f32 v50, v50, v51
  v_mov_b32 v51, v50
  s_nop 1
  v_permlane16_swap_b32 v50, v51
  v_max_f32 v50, v50, v51
  v_mov_b32 v51, v50
  s_nop 1
  v_permlane32_swap_b32 v50, v51
  v_max3_f32 v50, v50, v51, v48
  v_mul_f32 v51, s58, v50
  v_fma_f32 v52, v48, s58, -v51
  v_fma_f32 v32, v16, s58, -v51
  v_fma_f32 v33, v17, s58, -v51
  v_fma_f32 v34, v18, s58, -v51
  v_fma_f32 v35, v19, s58, -v51
  v_fma_f32 v36, v20, s58, -v51
  v_fma_f32 v37, v21, s58, -v51
  v_fma_f32 v38, v22, s58, -v51
  v_fma_f32 v39, v23, s58, -v51
  v_exp_f32 v52, v52
  v_exp_f32 v32, v32
  v_exp_f32 v33, v33
  v_exp_f32 v34, v34
  v_exp_f32 v35, v35
  v_exp_f32 v36, v36
  v_exp_f32 v37, v37
  v_exp_f32 v38, v38
  v_exp_f32 v39, v39
  v_mov_b32 v48, v50
  v_fma_f32 v49, v49, v52, v32
  v_add_f32 v51, v33, v34
  v_add_f32 v50, v35, v36
  v_mul_f32 v28, v28, v52
  v_mul_f32 v29, v29, v52
  v_mul_f32 v30, v30, v52
  v_mul_f32 v31, v31, v52
  v_add_f32 v51, v51, v37
  v_add_f32 v50, v50, v38
  v_add_f32 v49, v49, v39
  v_add_f32 v51, v51, v50
  v_add_f32 v49, v49, v51
  s_waitcnt vmcnt(12)
  v_cvt_pk_bf16_f32 v50, v32, v32
  v_and_b32 v40, v50, v5
  v_and_b32 v41, v50, v6
  v_and_b32 v42, v50, v7
  v_and_b32 v43, v50, v8
  s_nop 1
  v_mfma_f32_16x16x32_bf16 v[28:31], v[128:131], v[40:43], v[28:31]
  v_cvt_pk_bf16_f32 v50, v33, v33
  v_and_b32 v44, v50, v5
  v_and_b32 v45, v50, v6
  v_and_b32 v46, v50, v7
  v_and_b32 v47, v50, v8
  s_nop 1
  v_mfma_f32_16x16x32_bf16 v[28:31], v[132:135], v[44:47], v[28:31]
  v_cvt_pk_bf16_f32 v50, v34, v34
  v_and_b32 v40, v50, v5
  v_and_b32 v41, v50, v6
  v_and_b32 v42, v50, v7
  v_and_b32 v43, v50, v8
  s_nop 1
  v_mfma_f32_16x16x32_bf16 v[28:31], v[136:139], v[40:43], v[28:31]
  v_cvt_pk_bf16_f32 v50, v35, v35
  v_and_b32 v44, v50, v5
  v_and_b32 v45, v50, v6
  v_and_b32 v46, v50, v7
  v_and_b32 v47, v50, v8
  s_nop 1
  v_mfma_f32_16x16x32_bf16 v[28:31], v[140:143], v[44:47], v[28:31]
  s_waitcnt vmcnt(8)
  v_cvt_pk_bf16_f32 v50, v36, v36
  v_and_b32 v40, v50, v5
  v_and_b32 v41, v50, v6
  v_and_b32 v42, v50, v7
  v_and_b32 v43, v50, v8
  s_nop 1
  v_mfma_f32_16x16x32_bf16 v[28:31], v[144:147], v[40:43], v[28:31]
  v_cvt_pk_bf16_f32 v50, v37, v37
  v_and_b32 v44, v50, v5
  v_and_b32 v45, v50, v6
  v_and_b32 v46, v50, v7
  v_and_b32 v47, v50, v8
  s_nop 1
  v_mfma_f32_16x16x32_bf16 v[28:31], v[148:151], v[44:47], v[28:31]
  v_cvt_pk_bf16_f32 v50, v38, v38
  v_and_b32 v40, v50, v5
  v_and_b32 v41, v50, v6
  v_and_b32 v42, v50, v7
  v_and_b32 v43, v50, v8
  s_nop 1
  v_mfma_f32_16x16x32_bf16 v[28:31], v[152:155], v[40:43], v[28:31]
  v_cvt_pk_bf16_f32 v50, v39, v39
  v_and_b32 v44, v50, v5
  v_and_b32 v45, v50, v6
  v_and_b32 v46, v50, v7
  v_and_b32 v47, v50, v8
  s_nop 1
  v_mfma_f32_16x16x32_bf16 v[28:31], v[156:159], v[44:47], v[28:31]
  s_branch L_ei_22
L_ism_21:
  s_waitcnt vmcnt(12)
  v_mfma_f32_16x16x32_bf16 v[32:35], v[128:131], v[224:227], 0
  v_mfma_f32_16x16x32_bf16 v[32:35], v[132:135], v[228:231], v[32:35]
  v_mfma_f32_16x16x32_bf16 v[32:35], v[136:139], v[232:235], v[32:35]
  v_mfma_f32_16x16x32_bf16 v[32:35], v[140:143], v[236:239], v[32:35]
  s_nop 7
  v_max_f32 v50, v32, v33
  v_max3_f32 v50, v34, v35, v50
  v_mov_b32 v51, v50
  s_nop 1
  v_permlane16_swap_b32 v50, v51
  v_max_f32 v50, v50, v51
  v_mov_b32 v51, v50
  s_nop 1
  v_permlane32_swap_b32 v50, v51
  v_max3_f32 v50, v50, v51, v48
  v_mul_f32 v51, s58, v50
  v_fma_f32 v52, v48, s58, -v51
  v_fma_f32 v36, v32, s58, -v51
  v_fma_f32 v37, v33, s58, -v51
  v_fma_f32 v38, v34, s58, -v51
  v_fma_f32 v39, v35, s58, -v51
  v_exp_f32 v52, v52
  v_exp_f32 v36, v36
  v_exp_f32 v37, v37
  v_exp_f32 v38, v38
  v_exp_f32 v39, v39
  v_mov_b32 v48, v50
  v_fma_f32 v49, v49, v52, v36
  v_add_f32 v51, v37, v38
  v_mul_f32 v28, v28, v52
  v_mul_f32 v29, v29, v52
  v_mul_f32 v30, v30, v52
  v_mul_f32 v31, v31, v52
  v_add_f32 v49, v49, v39
  v_add_f32 v49, v49, v51
  s_waitcnt vmcnt(8)
  v_cvt_pk_bf16_f32 v50, v36, v36
  v_and_b32 v40, v50, v5
  v_and_b32 v41, v50, v6
  v_and_b32 v42, v50, v7
  v_and_b32 v43, v50, v8
  s_nop 1
  v_mfma_f32_16x16x32_bf16 v[28:31], v[144:147], v[40:43], v[28:31]
  v_cvt_pk_bf16_f32 v50, v37, v37
  v_and_b32 v44, v50, v5
  v_and_b32 v45, v50, v6
  v_and_b32 v46, v50, v7
  v_and_b32 v47, v50, v8
  s_nop 1
  v_mfma_f32_16x16x32_bf16 v[28:31], v[148:151], v[44:47], v[28:31]
  v_cvt_pk_bf16_f32 v50, v38, v38
  v_and_b32 v40, v50, v5
  v_and_b32 v41, v50, v6
  v_and_b32 v42, v50, v7
  v_and_b32 v43, v50, v8
  s_nop 1
  v_mfma_f32_16x16x32_bf16 v[28:31], v[152:155], v[40:43], v[28:31]
  v_cvt_pk_bf16_f32 v50, v39, v39
  v_and_b32 v44, v50, v5
  v_and_b32 v45, v50, v6
  v_and_b32 v46, v50, v7
  v_and_b32 v47, v50, v8
  s_nop 1
  v_mfma_f32_16x16x32_bf16 v[28:31], v[156:159], v[44:47], v[28:31]
L_ei_22:
  s_cmp_eq_u32 s79, 3
  s_cbranch_scc1 L_ism_23
  s_lshl_b32 s65, s88, 7
  v_add_u32 v54, s65, v63
  ds_read_b128 v[16:19], v54 offset:20480
  ds_read_b128 v[20:23], v54 offset:20496
  s_waitcnt lgkmcnt(0)
  v_max3_f32 v50, v16, v17, v18
  v_max3_f32 v51, v19, v20, v21
  v_max3_f32 v50, v22, v23, v50
  v_max_f32 v50, v50, v51
  v_mov_b32 v51, v50
  s_nop 1
  v_permlane16_swap_b32 v50, v51
  v_max_f32 v50, v50, v51
  v_mov_b32 v51, v50
  s_nop 1
  v_permlane32_swap_b32 v50, v51
  v_max3_f32 v50, v50, v51, v48
  v_mul_f32 v51, s58, v50
  v_fma_f32 v52, v48, s58, -v51
  v_fma_f32 v32, v16, s58, -v51
  v_fma_f32 v33, v17, s58, -v51
  v_fma_f32 v34, v18, s58, -v51
  v_fma_f32 v35, v19, s58, -v51
  v_fma_f32 v36, v20, s58, -v51
  v_fma_f32 v37, v21, s58, -v51
  v_fma_f32 v38, v22, s58, -v51
  v_fma_f32 v39, v23, s58, -v51
  v_exp_f32 v52, v52
  v_exp_f32 v32, v32
  v_exp_f32 v33, v33
  v_exp_f32 v34, v34
  v_exp_f32 v35, v35
  v_exp_f32 v36, v36
  v_exp_f32 v37, v37
  v_exp_f32 v38, v38
  v_exp_f32 v39, v39
  v_mov_b32 v48, v50
  v_fma_f32 v49, v49, v52, v32
  v_add_f32 v51, v33, v34
  v_add_f32 v50, v35, v36
  v_mul_f32 v28, v28, v52
  v_mul_f32 v29, v29, v52
  v_mul_f32 v30, v30, v52
  v_mul_f32 v31, v31, v52
  v_add_f32 v51, v51, v37
  v_add_f32 v50, v50, v38
  v_add_f32 v49, v49, v39
  v_add_f32 v51, v51, v50
  v_add_f32 v49, v49, v51
  s_waitcnt vmcnt(4)
  v_cvt_pk_bf16_f32 v50, v32, v32
  v_and_b32 v40, v50, v5
  v_and_b32 v41, v50, v6
  v_and_b32 v42, v50, v7
  v_and_b32 v43, v50, v8
  s_nop 1
  v_mfma_f32_16x16x32_bf16 v[28:31], v[160:163], v[40:43], v[28:31]
  v_cvt_pk_bf16_f32 v50, v33, v33
  v_and_b32 v44, v50, v5
  v_and_b32 v45, v50, v6
  v_and_b32 v46, v50, v7
  v_and_b32 v47, v50, v8
  s_nop 1
  v_mfma_f32_16x16x32_bf16 v[28:31], v[164:167], v[44:47], v[28:31]
  v_cvt_pk_bf16_f32 v50, v34, v34
  v_and_b32 v40, v50, v5
  v_and_b32 v41, v50, v6
  v_and_b32 v42, v50, v7
  v_and_b32 v43, v50, v8
  s_nop 1
  v_mfma_f32_16x16x32_bf16 v[28:31], v[168:171], v[40:43], v[28:31]
  v_cvt_pk_bf16_f32 v50, v35, v35
  v_and_b32 v44, v50, v5
  v_and_b32 v45, v50, v6
  v_and_b32 v46, v50, v7
  v_and_b32 v47, v50, v8
  s_nop 1
  v_mfma_f32_16x16x32_bf16 v[28:31], v[172:175], v[44:47], v[28:31]
  s_waitcnt vmcnt(0)
  v_cvt_pk_bf16_f32 v50, v36, v36
  v_and_b32 v40, v50, v5
  v_and_b32 v41, v50, v6
  v_and_b32 v42, v50, v7
  v_and_b32 v43, v50, v8
  s_nop 1
  v_mfma_f32_16x16x32_bf16 v[28:31], v[176:179], v[40:43], v[28:31]
  v_cvt_pk_bf16_f32 v50, v37, v37
  v_and_b32 v44, v50, v5
  v_and_b32 v45, v50, v6
  v_and_b32 v46, v50, v7
  v_and_b32 v47, v50, v8
  s_nop 1
  v_mfma_f32_16x16x32_bf16 v[28:31], v[180:183], v[44:47], v[28:31]
  v_cvt_pk_bf16_f32 v50, v38, v38
  v_and_b32 v40, v50, v5
  v_and_b32 v41, v50, v6
  v_and_b32 v42, v50, v7
  v_and_b32 v43, v50, v8
  s_nop 1
  v_mfma_f32_16x16x32_bf16 v[28:31], v[184:187], v[40:43], v[28:31]
  v_cvt_pk_bf16_f32 v50, v39, v39
  v_and_b32 v44, v50, v5
  v_and_b32 v45, v50, v6
  v_and_b32 v46, v50, v7
  v_and_b32 v47, v50, v8
  s_nop 1
  v_mfma_f32_16x16x32_bf16 v[28:31], v[188:191], v[44:47], v[28:31]
  s_branch L_ei_24
L_ism_23:
  s_waitcnt vmcnt(4)
  v_mfma_f32_16x16x32_bf16 v[32:35], v[160:163], v[224:227], 0
  v_mfma_f32_16x16x32_bf16 v[32:35], v[164:167], v[228:231], v[32:35]
  v_mfma_f32_16x16x32_bf16 v[32:35], v[168:171], v[232:235], v[32:35]
  v_mfma_f32_16x16x32_bf16 v[32:35], v[172:175], v[236:239], v[32:35]
  s_nop 7
  v_max_f32 v50, v32, v33
  v_max3_f32 v50, v34, v35, v50
  v_mov_b32 v51, v50
  s_nop 1
  v_permlane16_swap_b32 v50, v51
  v_max_f32 v50, v50, v51
  v_mov_b32 v51, v50
  s_nop 1
  v_permlane32_swap_b32 v50, v51
  v_max3_f32 v50, v50, v51, v48
  v_mul_f32 v51, s58, v50
  v_fma_f32 v52, v48, s58, -v51
  v_fma_f32 v36, v32, s58, -v51
  v_fma_f32 v37, v33, s58, -v51
  v_fma_f32 v38, v34, s58, -v51
  v_fma_f32 v39, v35, s58, -v51
  v_exp_f32 v52, v52
  v_exp_f32 v36, v36
  v_exp_f32 v37, v37
  v_exp_f32 v38, v38
  v_exp_f32 v39, v39
  v_mov_b32 v48, v50
  v_fma_f32 v49, v49, v52, v36
  v_add_f32 v51, v37, v38
  v_mul_f32 v28, v28, v52
  v_mul_f32 v29, v29, v52
  v_mul_f32 v30, v30, v52
  v_mul_f32 v31, v31, v52
  v_add_f32 v49, v49, v39
  v_add_f32 v49, v49, v51
  s_waitcnt vmcnt(0)
  v_cvt_pk_bf16_f32 v50, v36, v36
  v_and_b32 v40, v50, v5
  v_and_b32 v41, v50, v6
  v_and_b32 v42, v50, v7
  v_and_b32 v43, v50, v8
  s_nop 1
  v_mfma_f32_16x16x32_bf16 v[28:31], v[176:179], v[40:43], v[28:31]
  v_cvt_pk_bf16_f32 v50, v37, v37
  v_and_b32 v44, v50, v5
  v_and_b32 v45, v50, v6
  v_and_b32 v46, v50, v7
  v_and_b32 v47, v50, v8
  s_nop 1
  v_mfma_f32_16x16x32_bf16 v[28:31], v[180:183], v[44:47], v[28:31]
  v_cvt_pk_bf16_f32 v50, v38, v38
  v_and_b32 v40, v50, v5
  v_and_b32 v41, v50, v6
  v_and_b32 v42, v50, v7
  v_and_b32 v43, v50, v8
  s_nop 1
  v_mfma_f32_16x16x32_bf16 v[28:31], v[184:187], v[40:43], v[28:31]
  v_cvt_pk_bf16_f32 v50, v39, v39
  v_and_b32 v44, v50, v5
  v_and_b32 v45, v50, v6
  v_and_b32 v46, v50, v7
  v_and_b32 v47, v50, v8
  s_nop 1
  v_mfma_f32_16x16x32_bf16 v[28:31], v[188:191], v[44:47], v[28:31]
L_ei_24:
  s_branch L_sdone
L_drain1:
  s_cmp_eq_u32 s77, 3
  s_cbranch_scc1 L_ism_25
  s_lshl_b32 s65, s86, 7
  v_add_u32 v54, s65, v63
  ds_read_b128 v[16:19], v54 offset:20480
  ds_read_b128 v[20:23], v54 offset:20496
  s_waitcnt lgkmcnt(0)
  v_max3_f32 v50, v16, v17, v18
  v_max3_f32 v51, v19, v20, v21
  v_max3_f32 v50, v22, v23, v50
  v_max_f32 v50, v50, v51
  v_mov_b32 v51, v50
  s_nop 1
  v_permlane16_swap_b32 v50, v51
  v_max_f32 v50, v50, v51
  v_mov_b32 v51, v50
  s_nop 1
  v_permlane32_swap_b32 v50, v51
  v_max3_f32 v50, v50, v51, v48
  v_mul_f32 v51, s58, v50
  v_fma_f32 v52, v48, s58, -v51
  v_fma_f32 v32, v16, s58, -v51
  v_fma_f32 v33, v17, s58, -v51
  v_fma_f32 v34, v18, s58, -v51
  v_fma_f32 v35, v19, s58, -v51
  v_fma_f32 v36, v20, s58, -v51
  v_fma_f32 v37, v21, s58, -v51
  v_fma_f32 v38, v22, s58, -v51
  v_fma_f32 v39, v23, s58, -v51
  v_exp_f32 v52, v52
  v_exp_f32 v32, v32
  v_exp_f32 v33, v33
  v_exp_f32 v34, v34
  v_exp_f32 v35, v35
  v_exp_f32 v36, v36
  v_exp_f32 v37, v37
  v_exp_f32 v38, v38
  v_exp_f32 v39, v39
  v_mov_b32 v48, v50
  v_fma_f32 v49, v49, v52, v32
  v_add_f32 v51, v33, v34
  v_add_f32 v50, v35, v36
  v_mul_f32 v28, v28, v52
  v_mul_f32 v29, v29, v52
  v_mul_f32 v30, v30, v52
  v_mul_f32 v31, v31, v52
  v_add_f32 v51, v51, v37
  v_add_f32 v50, v50, v38
  v_add_f32 v49, v49, v39
  v_add_f32 v51, v51, v50
  v_add_f32 v49, v49, v51
  s_waitcnt vmcnt(28)
  v_cvt_pk_bf16_f32 v50, v32, v32
  v_and_b32 v40, v50, v5
  v_and_b32 v41, v50, v6
  v_and_b32 v42, v50, v7
  v_and_b32 v43, v50, v8
  s_nop 1
  v_mfma_f32_16x16x32_bf16 v[28:31], v[96:99], v[40:43], v[28:31]
  v_cvt_pk_bf16_f32 v50, v33, v33
  v_and_b32 v44, v50, v5
  v_and_b32 v45, v50, v6
  v_and_b32 v46, v50, v7
  v_and_b32 v47, v50, v8
  s_nop 1
  v_mfma_f32_16x16x32_bf16 v[28:31], v[100:103], v[44:47], v[28:31]
  v_cvt_pk_bf16_f32 v50, v34, v34
  v_and_b32 v40, v50, v5
  v_and_b32 v41, v50, v6
  v_and_b32 v42, v50, v7
  v_and_b32 v43, v50, v8
  s_nop 1
  v_mfma_f32_16x16x32_bf16 v[28:31], v[104:107], v[40:43], v[28:31]
  v_cvt_pk_bf16_f32 v50, v35, v35
  v_and_b32 v44, v50, v5
  v_and_b32 v45, v50, v6
  v_and_b32 v46, v50, v7
  v_and_b32 v47, v50, v8
  s_nop 1
  v_mfma_f32_16x16x32_bf16 v[28:31], v[108:111], v[44:47], v[28:31]
  s_waitcnt vmcnt(24)
  v_cvt_pk_bf16_f32 v50, v36, v36
  v_and_b32 v40, v50, v5
  v_and_b32 v41, v50, v6
  v_and_b32 v42, v50, v7
  v_and_b32 v43, v50, v8
  s_nop 1
  v_mfma_f32_16x16x32_bf16 v[28:31], v[112:115], v[40:43], v[28:31]
  v_cvt_pk_bf16_f32 v50, v37, v37
  v_and_b32 v44, v50, v5
  v_and_b32 v45, v50, v6
  v_and_b32 v46, v50, v7
  v_and_b32 v47, v50, v8
  s_nop 1
  v_mfma_f32_16x16x32_bf16 v[28:31], v[116:119], v[44:47], v[28:31]
  v_cvt_pk_bf16_f32 v50, v38, v38
  v_and_b32 v40, v50, v5
  v_and_b32 v41, v50, v6
  v_and_b32 v42, v50, v7
  v_and_b32 v43, v50, v8
  s_nop 1
  v_mfma_f32_16x16x32_bf16 v[28:31], v[120:123], v[40:43], v[28:31]
  v_cvt_pk_bf16_f32 v50, v39, v39
  v_and_b32 v44, v50, v5
  v_and_b32 v45, v50, v6
  v_and_b32 v46, v50, v7
  v_and_b32 v47, v50, v8
  s_nop 1
  v_mfma_f32_16x16x32_bf16 v[28:31], v[124:127], v[44:47], v[28:31]
  s_branch L_ei_26
L_ism_25:
  s_waitcnt vmcnt(28)
  v_mfma_f32_16x16x32_bf16 v[32:35], v[96:99], v[224:227], 0
  v_mfma_f32_16x16x32_bf16 v[32:35], v[100:103], v[228:231], v[32:35]
  v_mfma_f32_16x16x32_bf16 v[32:35], v[104:107], v[232:235], v[32:35]
  v_mfma_f32_16x16x32_bf16 v[32:35], v[108:111], v[236:239], v[32:35]
  s_nop 7
  v_max_f32 v50, v32, v33
  v_max3_f32 v50, v34, v35, v50
  v_mov_b32 v51, v50
  s_nop 1
  v_permlane16_swap_b32 v50, v51
  v_max_f32 v50, v50, v51
  v_mov_b32 v51, v50
  s_nop 1
  v_permlane32_swap_b32 v50, v51
  v_max3_f32 v50, v50, v51, v48
  v_mul_f32 v51, s58, v50
  v_fma_f32 v52, v48, s58, -v51
  v_fma_f32 v36, v32, s58, -v51
  v_fma_f32 v37, v33, s58, -v51
  v_fma_f32 v38, v34, s58, -v51
  v_fma_f32 v39, v35, s58, -v51
  v_exp_f32 v52, v52
  v_exp_f32 v36, v36
  v_exp_f32 v37, v37
  v_exp_f32 v38, v38
  v_exp_f32 v39, v39
  v_mov_b32 v48, v50
  v_fma_f32 v49, v49, v52, v36
  v_add_f32 v51, v37, v38
  v_mul_f32 v28, v28, v52
  v_mul_f32 v29, v29, v52
  v_mul_f32 v30, v30, v52
  v_mul_f32 v31, v31, v52
  v_add_f32 v49, v49, v39
  v_add_f32 v49, v49, v51
  s_waitcnt vmcnt(24)
  v_cvt_pk_bf16_f32 v50, v36, v36
  v_and_b32 v40, v50, v5
  v_and_b32 v41, v50, v6
  v_and_b32 v42, v50, v7
  v_and_b32 v43, v50, v8
  s_nop 1
  v_mfma_f32_16x16x32_bf16 v[28:31], v[112:115], v[40:43], v[28:31]
  v_cvt_pk_bf16_f32 v50, v37, v37
  v_and_b32 v44, v50, v5
  v_and_b32 v45, v50, v6
  v_and_b32 v46, v50, v7
  v_and_b32 v47, v50, v8
  s_nop 1
  v_mfma_f32_16x16x32_bf16 v[28:31], v[116:119], v[44:47], v[28:31]
  v_cvt_pk_bf16_f32 v50, v38, v38
  v_and_b32 v40, v50, v5
  v_and_b32 v41, v50, v6
  v_and_b32 v42, v50, v7
  v_and_b32 v43, v50, v8
  s_nop 1
  v_mfma_f32_16x16x32_bf16 v[28:31], v[120:123], v[40:43], v[28:31]
  v_cvt_pk_bf16_f32 v50, v39, v39
  v_and_b32 v44, v50, v5
  v_and_b32 v45, v50, v6
  v_and_b32 v46, v50, v7
  v_and_b32 v47, v50, v8
  s_nop 1
  v_mfma_f32_16x16x32_bf16 v[28:31], v[124:127], v[44:47], v[28:31]
L_ei_26:
  s_cmp_eq_u32 s78, 3
  s_cbranch_scc1 L_ism_27
  s_lshl_b32 s65, s87, 7
  v_add_u32 v54, s65, v63
  ds_read_b128 v[16:19], v54 offset:20480
  ds_read_b128 v[20:23], v54 offset:20496
  s_waitcnt lgkmcnt(0)
  v_max3_f32 v50, v16, v17, v18
  v_max3_f32 v51, v19, v20, v21
  v_max3_f32 v50, v22, v23, v50
  v_max_f32 v50, v50, v51
  v_mov_b32 v51, v50
  s_nop 1
  v_permlane16_swap_b32 v50, v51
  v_max_f32 v50, v50, v51
  v_mov_b32 v51, v50
  s_nop 1
  v_permlane32_swap_b32 v50, v51
  v_max3_f32 v50, v50, v51, v48
  v_mul_f32 v51, s58, v50
  v_fma_f32 v52, v48, s58, -v51
  v_fma_f32 v32, v16, s58, -v51
  v_fma_f32 v33, v17, s58, -v51
  v_fma_f32 v34, v18, s58, -v51
  v_fma_f32 v35, v19, s58, -v51
  v_fma_f32 v36, v20, s58, -v51
  v_fma_f32 v37, v21, s58, -v51
  v_fma_f32 v38, v22, s58, -v51
  v_fma_f32 v39, v23, s58, -v51
  v_exp_f32 v52, v52
  v_exp_f32 v32, v32
  v_exp_f32 v33, v33
  v_exp_f32 v34, v34
  v_exp_f32 v35, v35
  v_exp_f32 v36, v36
  v_exp_f32 v37, v37
  v_exp_f32 v38, v38
  v_exp_f32 v39, v39
  v_mov_b32 v48, v50
  v_fma_f32 v49, v49, v52, v32
  v_add_f32 v51, v33, v34
  v_add_f32 v50, v35, v36
  v_mul_f32 v28, v28, v52
  v_mul_f32 v29, v29, v52
  v_mul_f32 v30, v30, v52
  v_mul_f32 v31, v31, v52
  v_add_f32 v51, v51, v37
  v_add_f32 v50, v50, v38
  v_add_f32 v49, v49, v39
  v_add_f32 v51, v51, v50
  v_add_f32 v49, v49, v51
  s_waitcnt vmcnt(20)
  v_cvt_pk_bf16_f32 v50, v32, v32
  v_and_b32 v40, v50, v5
  v_and_b32 v41, v50, v6
  v_and_b32 v42, v50, v7
  v_and_b32 v43, v50, v8
  s_nop 1
  v_mfma_f32_16x16x32_bf16 v[28:31], v[128:131], v[40:43], v[28:31]
  v_cvt_pk_bf16_f32 v50, v33, v33
  v_and_b32 v44, v50, v5
  v_and_b32 v45, v50, v6
  v_and_b32 v46, v50, v7
  v_and_b32 v47, v50, v8
  s_nop 1
  v_mfma_f32_16x16x32_bf16 v[28:31], v[132:135], v[44:47], v[28:31]
  v_cvt_pk_bf16_f32 v50, v34, v34
  v_and_b32 v40, v50, v5
  v_and_b32 v41, v50, v6
  v_and_b32 v42, v50, v7
  v_and_b32 v43, v50, v8
  s_nop 1
  v_mfma_f32_16x16x32_bf16 v[28:31], v[136:139], v[40:43], v[28:31]
  v_cvt_pk_bf16_f32 v50, v35, v35
  v_and_b32 v44, v50, v5
  v_and_b32 v45, v50, v6
  v_and_b32 v46, v50, v7
  v_and_b32 v47, v50, v8
  s_nop 1
  v_mfma_f32_16x16x32_bf16 v[28:31], v[140:143], v[44:47], v[28:31]
  s_waitcnt vmcnt(16)
  v_cvt_pk_bf16_f32 v50, v36, v36
  v_and_b32 v40, v50, v5
  v_and_b32 v41, v50, v6
  v_and_b32 v42, v50, v7
  v_and_b32 v43, v50, v8
  s_nop 1
  v_mfma_f32_16x16x32_bf16 v[28:31], v[144:147], v[40:43], v[28:31]
  v_cvt_pk_bf16_f32 v50, v37, v37
  v_and_b32 v44, v50, v5
  v_and_b32 v45, v50, v6
  v_and_b32 v46, v50, v7
  v_and_b32 v47, v50, v8
  s_nop 1
  v_mfma_f32_16x16x32_bf16 v[28:31], v[148:151], v[44:47], v[28:31]
  v_cvt_pk_bf16_f32 v50, v38, v38
  v_and_b32 v40, v50, v5
  v_and_b32 v41, v50, v6
  v_and_b32 v42, v50, v7
  v_and_b32 v43, v50, v8
  s_nop 1
  v_mfma_f32_16x16x32_bf16 v[28:31], v[152:155], v[40:43], v[28:31]
  v_cvt_pk_bf16_f32 v50, v39, v39
  v_and_b32 v44, v50, v5
  v_and_b32 v45, v50, v6
  v_and_b32 v46, v50, v7
  v_and_b32 v47, v50, v8
  s_nop 1
  v_mfma_f32_16x16x32_bf16 v[28:31], v[156:159], v[44:47], v[28:31]
  s_branch L_ei_28
L_ism_27:
  s_waitcnt vmcnt(20)
  v_mfma_f32_16x16x32_bf16 v[32:35], v[128:131], v[224:227], 0
  v_mfma_f32_16x16x32_bf16 v[32:35], v[132:135], v[228:231], v[32:35]
  v_mfma_f32_16x16x32_bf16 v[32:35], v[136:139], v[232:235], v[32:35]
  v_mfma_f32_16x16x32_bf16 v[32:35], v[140:143], v[236:239], v[32:35]
  s_nop 7
  v_max_f32 v50, v32, v33
  v_max3_f32 v50, v34, v35, v50
  v_mov_b32 v51, v50
  s_nop 1
  v_permlane16_swap_b32 v50, v51
  v_max_f32 v50, v50, v51
  v_mov_b32 v51, v50
  s_nop 1
  v_permlane32_swap_b32 v50, v51
  v_max3_f32 v50, v50, v51, v48
  v_mul_f32 v51, s58, v50
  v_fma_f32 v52, v48, s58, -v51
  v_fma_f32 v36, v32, s58, -v51
  v_fma_f32 v37, v33, s58, -v51
  v_fma_f32 v38, v34, s58, -v51
  v_fma_f32 v39, v35, s58, -v51
  v_exp_f32 v52, v52
  v_exp_f32 v36, v36
  v_exp_f32 v37, v37
  v_exp_f32 v38, v38
  v_exp_f32 v39, v39
  v_mov_b32 v48, v50
  v_fma_f32 v49, v49, v52, v36
  v_add_f32 v51, v37, v38
  v_mul_f32 v28, v28, v52
  v_mul_f32 v29, v29, v52
  v_mul_f32 v30, v30, v52
  v_mul_f32 v31, v31, v52
  v_add_f32 v49, v49, v39
  v_add_f32 v49, v49, v51
  s_waitcnt vmcnt(16)
  v_cvt_pk_bf16_f32 v50, v36, v36
  v_and_b32 v40, v50, v5
  v_and_b32 v41, v50, v6
  v_and_b32 v42, v50, v7
  v_and_b32 v43, v50, v8
  s_nop 1
  v_mfma_f32_16x16x32_bf16 v[28:31], v[144:147], v[40:43], v[28:31]
  v_cvt_pk_bf16_f32 v50, v37, v37
  v_and_b32 v44, v50, v5
  v_and_b32 v45, v50, v6
  v_and_b32 v46, v50, v7
  v_and_b32 v47, v50, v8
  s_nop 1
  v_mfma_f32_16x16x32_bf16 v[28:31], v[148:151], v[44:47], v[28:31]
  v_cvt_pk_bf16_f32 v50, v38, v38
  v_and_b32 v40, v50, v5
  v_and_b32 v41, v50, v6
  v_and_b32 v42, v50, v7
  v_and_b32 v43, v50, v8
  s_nop 1
  v_mfma_f32_16x16x32_bf16 v[28:31], v[152:155], v[40:43], v[28:31]
  v_cvt_pk_bf16_f32 v50, v39, v39
  v_and_b32 v44, v50, v5
  v_and_b32 v45, v50, v6
  v_and_b32 v46, v50, v7
  v_and_b32 v47, v50, v8
  s_nop 1
  v_mfma_f32_16x16x32_bf16 v[28:31], v[156:159], v[44:47], v[28:31]
L_ei_28:
  s_cmp_eq_u32 s79, 3
  s_cbranch_scc1 L_ism_29
  s_lshl_b32 s65, s88, 7
  v_add_u32 v54, s65, v63
  ds_read_b128 v[16:19], v54 offset:20480
  ds_read_b128 v[20:23], v54 offset:20496
  s_waitcnt lgkmcnt(0)
  v_max3_f32 v50, v16, v17, v18
  v_max3_f32 v51, v19, v20, v21
  v_max3_f32 v50, v22, v23, v50
  v_max_f32 v50, v50, v51
  v_mov_b32 v51, v50
  s_nop 1
  v_permlane16_swap_b32 v50, v51
  v_max_f32 v50, v50, v51
  v_mov_b32 v51, v50
  s_nop 1
  v_permlane32_swap_b32 v50, v51
  v_max3_f32 v50, v50, v51, v48
  v_mul_f32 v51, s58, v50
  v_fma_f32 v52, v48, s58, -v51
  v_fma_f32 v32, v16, s58, -v51
  v_fma_f32 v33, v17, s58, -v51
  v_fma_f32 v34, v18, s58, -v51
  v_fma_f32 v35, v19, s58, -v51
  v_fma_f32 v36, v20, s58, -v51
  v_fma_f32 v37, v21, s58, -v51
  v_fma_f32 v38, v22, s58, -v51
  v_fma_f32 v39, v23, s58, -v51
  v_exp_f32 v52, v52
  v_exp_f32 v32, v32
  v_exp_f32 v33, v33
  v_exp_f32 v34, v34
  v_exp_f32 v35, v35
  v_exp_f32 v36, v36
  v_exp_f32 v37, v37
  v_exp_f32 v38, v38
  v_exp_f32 v39, v39
  v_mov_b32 v48, v50
  v_fma_f32 v49, v49, v52, v32
  v_add_f32 v51, v33, v34
  v_add_f32 v50, v35, v36
  v_mul_f32 v28, v28, v52
  v_mul_f32 v29, v29, v52
  v_mul_f32 v30, v30, v52
  v_mul_f32 v31, v31, v52
  v_add_f32 v51, v51, v37
  v_add_f32 v50, v50, v38
  v_add_f32 v49, v49, v39
  v_add_f32 v51, v51, v50
  v_add_f32 v49, v49, v51
  s_waitcnt vmcnt(12)
  v_cvt_pk_bf16_f32 v50, v32, v32
  v_and_b32 v40, v50, v5
  v_and_b32 v41, v50, v6
  v_and_b32 v42, v50, v7
  v_and_b32 v43, v50, v8
  s_nop 1
  v_mfma_f32_16x16x32_bf16 v[28:31], v[160:163], v[40:43], v[28:31]
  v_cvt_pk_bf16_f32 v50, v33, v33
  v_and_b32 v44, v50, v5
  v_and_b32 v45, v50, v6
  v_and_b32 v46, v50, v7
  v_and_b32 v47, v50, v8
  s_nop 1
  v_mfma_f32_16x16x32_bf16 v[28:31], v[164:167], v[44:47], v[28:31]
  v_cvt_pk_bf16_f32 v50, v34, v34
  v_and_b32 v40, v50, v5
  v_and_b32 v41, v50, v6
  v_and_b32 v42, v50, v7
  v_and_b32 v43, v50, v8
  s_nop 1
  v_mfma_f32_16x16x32_bf16 v[28:31], v[168:171], v[40:43], v[28:31]
  v_cvt_pk_bf16_f32 v50, v35, v35
  v_and_b32 v44, v50, v5
  v_and_b32 v45, v50, v6
  v_and_b32 v46, v50, v7
  v_and_b32 v47, v50, v8
  s_nop 1
  v_mfma_f32_16x16x32_bf16 v[28:31], v[172:175], v[44:47], v[28:31]
  s_waitcnt vmcnt(8)
  v_cvt_pk_bf16_f32 v50, v36, v36
  v_and_b32 v40, v50, v5
  v_and_b32 v41, v50, v6
  v_and_b32 v42, v50, v7
  v_and_b32 v43, v50, v8
  s_nop 1
  v_mfma_f32_16x16x32_bf16 v[28:31], v[176:179], v[40:43], v[28:31]
  v_cvt_pk_bf16_f32 v50, v37, v37
  v_and_b32 v44, v50, v5
  v_and_b32 v45, v50, v6
  v_and_b32 v46, v50, v7
  v_and_b32 v47, v50, v8
  s_nop 1
  v_mfma_f32_16x16x32_bf16 v[28:31], v[180:183], v[44:47], v[28:31]
  v_cvt_pk_bf16_f32 v50, v38, v38
  v_and_b32 v40, v50, v5
  v_and_b32 v41, v50, v6
  v_and_b32 v42, v50, v7
  v_and_b32 v43, v50, v8
  s_nop 1
  v_mfma_f32_16x16x32_bf16 v[28:31], v[184:187], v[40:43], v[28:31]
  v_cvt_pk_bf16_f32 v50, v39, v39
  v_and_b32 v44, v50, v5
  v_and_b32 v45, v50, v6
  v_and_b32 v46, v50, v7
  v_and_b32 v47, v50, v8
  s_nop 1
  v_mfma_f32_16x16x32_bf16 v[28:31], v[188:191], v[44:47], v[28:31]
  s_branch L_ei_30
L_ism_29:
  s_waitcnt vmcnt(12)
  v_mfma_f32_16x16x32_bf16 v[32:35], v[160:163], v[224:227], 0
  v_mfma_f32_16x16x32_bf16 v[32:35], v[164:167], v[228:231], v[32:35]
  v_mfma_f32_16x16x32_bf16 v[32:35], v[168:171], v[232:235], v[32:35]
  v_mfma_f32_16x16x32_bf16 v[32:35], v[172:175], v[236:239], v[32:35]
  s_nop 7
  v_max_f32 v50, v32, v33
  v_max3_f32 v50, v34, v35, v50
  v_mov_b32 v51, v50
  s_nop 1
  v_permlane16_swap_b32 v50, v51
  v_max_f32 v50, v50, v51
  v_mov_b32 v51, v50
  s_nop 1
  v_permlane32_swap_b32 v50, v51
  v_max3_f32 v50, v50, v51, v48
  v_mul_f32 v51, s58, v50
  v_fma_f32 v52, v48, s58, -v51
  v_fma_f32 v36, v32, s58, -v51
  v_fma_f32 v37, v33, s58, -v51
  v_fma_f32 v38, v34, s58, -v51
  v_fma_f32 v39, v35, s58, -v51
  v_exp_f32 v52, v52
  v_exp_f32 v36, v36
  v_exp_f32 v37, v37
  v_exp_f32 v38, v38
  v_exp_f32 v39, v39
  v_mov_b32 v48, v50
  v_fma_f32 v49, v49, v52, v36
  v_add_f32 v51, v37, v38
  v_mul_f32 v28, v28, v52
  v_mul_f32 v29, v29, v52
  v_mul_f32 v30, v30, v52
  v_mul_f32 v31, v31, v52
  v_add_f32 v49, v49, v39
  v_add_f32 v49, v49, v51
  s_waitcnt vmcnt(8)
  v_cvt_pk_bf16_f32 v50, v36, v36
  v_and_b32 v40, v50, v5
  v_and_b32 v41, v50, v6
  v_and_b32 v42, v50, v7
  v_and_b32 v43, v50, v8
  s_nop 1
  v_mfma_f32_16x16x32_bf16 v[28:31], v[176:179], v[40:43], v[28:31]
  v_cvt_pk_bf16_f32 v50, v37, v37
  v_and_b32 v44, v50, v5
  v_and_b32 v45, v50, v6
  v_and_b32 v46, v50, v7
  v_and_b32 v47, v50, v8
  s_nop 1
  v_mfma_f32_16x16x32_bf16 v[28:31], v[180:183], v[44:47], v[28:31]
  v_cvt_pk_bf16_f32 v50, v38, v38
  v_and_b32 v40, v50, v5
  v_and_b32 v41, v50, v6
  v_and_b32 v42, v50, v7
  v_and_b32 v43, v50, v8
  s_nop 1
  v_mfma_f32_16x16x32_bf16 v[28:31], v[184:187], v[40:43], v[28:31]
  v_cvt_pk_bf16_f32 v50, v39, v39
  v_and_b32 v44, v50, v5
  v_and_b32 v45, v50, v6
  v_and_b32 v46, v50, v7
  v_and_b32 v47, v50, v8
  s_nop 1
  v_mfma_f32_16x16x32_bf16 v[28:31], v[188:191], v[44:47], v[28:31]
L_ei_30:
  s_cmp_eq_u32 s76, 3
  s_cbranch_scc1 L_ism_31
  s_lshl_b32 s65, s85, 7
  v_add_u32 v54, s65, v63
  ds_read_b128 v[16:19], v54 offset:20480
  ds_read_b128 v[20:23], v54 offset:20496
  s_waitcnt lgkmcnt(0)
  v_max3_f32 v50, v16, v17, v18
  v_max3_f32 v51, v19, v20, v21
  v_max3_f32 v50, v22, v23, v50
  v_max_f32 v50, v50, v51
  v_mov_b32 v51, v50
  s_nop 1
  v_permlane16_swap_b32 v50, v51
  v_max_f32 v50, v50, v51
  v_mov_b32 v51, v50
  s_nop 1
  v_permlane32_swap_b32 v50, v51
  v_max3_f32 v50, v50, v51, v48
  v_mul_f32 v51, s58, v50
  v_fma_f32 v52, v48, s58, -v51
  v_fma_f32 v32, v16, s58, -v51
  v_fma_f32 v33, v17, s58, -v51
  v_fma_f32 v34, v18, s58, -v51
  v_fma_f32 v35, v19, s58, -v51
  v_fma_f32 v36, v20, s58, -v51
  v_fma_f32 v37, v21, s58, -v51
  v_fma_f32 v38, v22, s58, -v51
  v_fma_f32 v39, v23, s58, -v51
  v_exp_f32 v52, v52
  v_exp_f32 v32, v32
  v_exp_f32 v33, v33
  v_exp_f32 v34, v34
  v_exp_f32 v35, v35
  v_exp_f32 v36, v36
  v_exp_f32 v37, v37
  v_exp_f32 v38, v38
  v_exp_f32 v39, v39
  v_mov_b32 v48, v50
  v_fma_f32 v49, v49, v52, v32
  v_add_f32 v51, v33, v34
  v_add_f32 v50, v35, v36
  v_mul_f32 v28, v28, v52
  v_mul_f32 v29, v29, v52
  v_mul_f32 v30, v30, v52
  v_mul_f32 v31, v31, v52
  v_add_f32 v51, v51, v37
  v_add_f32 v50, v50, v38
  v_add_f32 v49, v49, v39
  v_add_f32 v51, v51, v50
  v_add_f32 v49, v49, v51
  s_waitcnt vmcnt(4)
  v_cvt_pk_bf16_f32 v50, v32, v32
  v_and_b32 v40, v50, v5
  v_and_b32 v41, v50, v6
  v_and_b32 v42, v50, v7
  v_and_b32 v43, v50, v8
  s_nop 1
  v_mfma_f32_16x16x32_bf16 v[28:31], v[64:67], v[40:43], v[28:31]
  v_cvt_pk_bf16_f32 v50, v33, v33
  v_and_b32 v44, v50, v5
  v_and_b32 v45, v50, v6
  v_and_b32 v46, v50, v7
  v_and_b32 v47, v50, v8
  s_nop 1
  v_mfma_f32_16x16x32_bf16 v[28:31], v[68:71], v[44:47], v[28:31]
  v_cvt_pk_bf16_f32 v50, v34, v34
  v_and_b32 v40, v50, v5
  v_and_b32 v41, v50, v6
  v_and_b32 v42, v50, v7
  v_and_b32 v43, v50, v8
  s_nop 1
  v_mfma_f32_16x16x32_bf16 v[28:31], v[72:75], v[40:43], v[28:31]
  v_cvt_pk_bf16_f32 v50, v35, v35
  v_and_b32 v44, v50, v5
  v_and_b32 v45, v50, v6
  v_and_b32 v46, v50, v7
  v_and_b32 v47, v50, v8
  s_nop 1
  v_mfma_f32_16x16x32_bf16 v[28:31], v[76:79], v[44:47], v[28:31]
  s_waitcnt vmcnt(0)
  v_cvt_pk_bf16_f32 v50, v36, v36
  v_and_b32 v40, v50, v5
  v_and_b32 v41, v50, v6
  v_and_b32 v42, v50, v7
  v_and_b32 v43, v50, v8
  s_nop 1
  v_mfma_f32_16x16x32_bf16 v[28:31], v[80:83], v[40:43], v[28:31]
  v_cvt_pk_bf16_f32 v50, v37, v37
  v_and_b32 v44, v50, v5
  v_and_b32 v45, v50, v6
  v_and_b32 v46, v50, v7
  v_and_b32 v47, v50, v8
  s_nop 1
  v_mfma_f32_16x16x32_bf16 v[28:31], v[84:87], v[44:47], v[28:31]
  v_cvt_pk_bf16_f32 v50, v38, v38
  v_and_b32 v40, v50, v5
  v_and_b32 v41, v50, v6
  v_and_b32 v42, v50, v7
  v_and_b32 v43, v50, v8
  s_nop 1
  v_mfma_f32_16x16x32_bf16 v[28:31], v[88:91], v[40:43], v[28:31]
  v_cvt_pk_bf16_f32 v50, v39, v39
  v_and_b32 v44, v50, v5
  v_and_b32 v45, v50, v6
  v_and_b32 v46, v50, v7
  v_and_b32 v47, v50, v8
  s_nop 1
  v_mfma_f32_16x16x32_bf16 v[28:31], v[92:95], v[44:47], v[28:31]
  s_branch L_ei_32
L_ism_31:
  s_waitcnt vmcnt(4)
  v_mfma_f32_16x16x32_bf16 v[32:35], v[64:67], v[224:227], 0
  v_mfma_f32_16x16x32_bf16 v[32:35], v[68:71], v[228:231], v[32:35]
  v_mfma_f32_16x16x32_bf16 v[32:35], v[72:75], v[232:235], v[32:35]
  v_mfma_f32_16x16x32_bf16 v[32:35], v[76:79], v[236:239], v[32:35]
  s_nop 7
  v_max_f32 v50, v32, v33
  v_max3_f32 v50, v34, v35, v50
  v_mov_b32 v51, v50
  s_nop 1
  v_permlane16_swap_b32 v50, v51
  v_max_f32 v50, v50, v51
  v_mov_b32 v51, v50
  s_nop 1
  v_permlane32_swap_b32 v50, v51
  v_max3_f32 v50, v50, v51, v48
  v_mul_f32 v51, s58, v50
  v_fma_f32 v52, v48, s58, -v51
  v_fma_f32 v36, v32, s58, -v51
  v_fma_f32 v37, v33, s58, -v51
  v_fma_f32 v38, v34, s58, -v51
  v_fma_f32 v39, v35, s58, -v51
  v_exp_f32 v52, v52
  v_exp_f32 v36, v36
  v_exp_f32 v37, v37
  v_exp_f32 v38, v38
  v_exp_f32 v39, v39
  v_mov_b32 v48, v50
  v_fma_f32 v49, v49, v52, v36
  v_add_f32 v51, v37, v38
  v_mul_f32 v28, v28, v52
  v_mul_f32 v29, v29, v52
  v_mul_f32 v30, v30, v52
  v_mul_f32 v31, v31, v52
  v_add_f32 v49, v49, v39
  v_add_f32 v49, v49, v51
  s_waitcnt vmcnt(0)
  v_cvt_pk_bf16_f32 v50, v36, v36
  v_and_b32 v40, v50, v5
  v_and_b32 v41, v50, v6
  v_and_b32 v42, v50, v7
  v_and_b32 v43, v50, v8
  s_nop 1
  v_mfma_f32_16x16x32_bf16 v[28:31], v[80:83], v[40:43], v[28:31]
  v_cvt_pk_bf16_f32 v50, v37, v37
  v_and_b32 v44, v50, v5
  v_and_b32 v45, v50, v6
  v_and_b32 v46, v50, v7
  v_and_b32 v47, v50, v8
  s_nop 1
  v_mfma_f32_16x16x32_bf16 v[28:31], v[84:87], v[44:47], v[28:31]
  v_cvt_pk_bf16_f32 v50, v38, v38
  v_and_b32 v40, v50, v5
  v_and_b32 v41, v50, v6
  v_and_b32 v42, v50, v7
  v_and_b32 v43, v50, v8
  s_nop 1
  v_mfma_f32_16x16x32_bf16 v[28:31], v[88:91], v[40:43], v[28:31]
  v_cvt_pk_bf16_f32 v50, v39, v39
  v_and_b32 v44, v50, v5
  v_and_b32 v45, v50, v6
  v_and_b32 v46, v50, v7
  v_and_b32 v47, v50, v8
  s_nop 1
  v_mfma_f32_16x16x32_bf16 v[28:31], v[92:95], v[44:47], v[28:31]
L_ei_32:
  s_branch L_sdone
L_drain2:
  s_cmp_eq_u32 s78, 3
  s_cbranch_scc1 L_ism_33
  s_lshl_b32 s65, s87, 7
  v_add_u32 v54, s65, v63
  ds_read_b128 v[16:19], v54 offset:20480
  ds_read_b128 v[20:23], v54 offset:20496
  s_waitcnt lgkmcnt(0)
  v_max3_f32 v50, v16, v17, v18
  v_max3_f32 v51, v19, v20, v21
  v_max3_f32 v50, v22, v23, v50
  v_max_f32 v50, v50, v51
  v_mov_b32 v51, v50
  s_nop 1
  v_permlane16_swap_b32 v50, v51
  v_max_f32 v50, v50, v51
  v_mov_b32 v51, v50
  s_nop 1
  v_permlane32_swap_b32 v50, v51
  v_max3_f32 v50, v50, v51, v48
  v_mul_f32 v51, s58, v50
  v_fma_f32 v52, v48, s58, -v51
  v_fma_f32 v32, v16, s58, -v51
  v_fma_f32 v33, v17, s58, -v51
  v_fma_f32 v34, v18, s58, -v51
  v_fma_f32 v35, v19, s58, -v51
  v_fma_f32 v36, v20, s58, -v51
  v_fma_f32 v37, v21, s58, -v51
  v_fma_f32 v38, v22, s58, -v51
  v_fma_f32 v39, v23, s58, -v51
  v_exp_f32 v52, v52
  v_exp_f32 v32, v32
  v_exp_f32 v33, v33
  v_exp_f32 v34, v34
  v_exp_f32 v35, v35
  v_exp_f32 v36, v36
  v_exp_f32 v37, v37
  v_exp_f32 v38, v38
  v_exp_f32 v39, v39
  v_mov_b32 v48, v50
  v_fma_f32 v49, v49, v52, v32
  v_add_f32 v51, v33, v34
  v_add_f32 v50, v35, v36
  v_mul_f32 v28, v28, v52
  v_mul_f32 v29, v29, v52
  v_mul_f32 v30, v30, v52
  v_mul_f32 v31, v31, v52
  v_add_f32 v51, v51, v37
  v_add_f32 v50, v50, v38
  v_add_f32 v49, v49, v39
  v_add_f32 v51, v51, v50
  v_add_f32 v49, v49, v51
  s_waitcnt vmcnt(28)
  v_cvt_pk_bf16_f32 v50, v32, v32
  v_and_b32 v40, v50, v5
  v_and_b32 v41, v50, v6
  v_and_b32 v42, v50, v7
  v_and_b32 v43, v50, v8
  s_nop 1
  v_mfma_f32_16x16x32_bf16 v[28:31], v[128:131], v[40:43], v[28:31]
  v_cvt_pk_bf16_f32 v50, v33, v33
  v_and_b32 v44, v50, v5
  v_and_b32 v45, v50, v6
  v_and_b32 v46, v50, v7
  v_and_b32 v47, v50, v8
  s_nop 1
  v_mfma_f32_16x16x32_bf16 v[28:31], v[132:135], v[44:47], v[28:31]
  v_cvt_pk_bf16_f32 v50, v34, v34
  v_and_b32 v40, v50, v5
  v_and_b32 v41, v50, v6
  v_and_b32 v42, v50, v7
  v_and_b32 v43, v50, v8
  s_nop 1
  v_mfma_f32_16x16x32_bf16 v[28:31], v[136:139], v[40:43], v[28:31]
  v_cvt_pk_bf16_f32 v50, v35, v35
  v_and_b32 v44, v50, v5
  v_and_b32 v45, v50, v6
  v_and_b32 v46, v50, v7
  v_and_b32 v47, v50, v8
  s_nop 1
  v_mfma_f32_16x16x32_bf16 v[28:31], v[140:143], v[44:47], v[28:31]
  s_waitcnt vmcnt(24)
  v_cvt_pk_bf16_f32 v50, v36, v36
  v_and_b32 v40, v50, v5
  v_and_b32 v41, v50, v6
  v_and_b32 v42, v50, v7
  v_and_b32 v43, v50, v8
  s_nop 1
  v_mfma_f32_16x16x32_bf16 v[28:31], v[144:147], v[40:43], v[28:31]
  v_cvt_pk_bf16_f32 v50, v37, v37
  v_and_b32 v44, v50, v5
  v_and_b32 v45, v50, v6
  v_and_b32 v46, v50, v7
  v_and_b32 v47, v50, v8
  s_nop 1
  v_mfma_f32_16x16x32_bf16 v[28:31], v[148:151], v[44:47], v[28:31]
  v_cvt_pk_bf16_f32 v50, v38, v38
  v_and_b32 v40, v50, v5
  v_and_b32 v41, v50, v6
  v_and_b32 v42, v50, v7
  v_and_b32 v43, v50, v8
  s_nop 1
  v_mfma_f32_16x16x32_bf16 v[28:31], v[152:155], v[40:43], v[28:31]
  v_cvt_pk_bf16_f32 v50, v39, v39
  v_and_b32 v44, v50, v5
  v_and_b32 v45, v50, v6
  v_and_b32 v46, v50, v7
  v_and_b32 v47, v50, v8
  s_nop 1
  v_mfma_f32_16x16x32_bf16 v[28:31], v[156:159], v[44:47], v[28:31]
  s_branch L_ei_34
L_ism_33:
  s_waitcnt vmcnt(28)
  v_mfma_f32_16x16x32_bf16 v[32:35], v[128:131], v[224:227], 0
  v_mfma_f32_16x16x32_bf16 v[32:35], v[132:135], v[228:231], v[32:35]
  v_mfma_f32_16x16x32_bf16 v[32:35], v[136:139], v[232:235], v[32:35]
  v_mfma_f32_16x16x32_bf16 v[32:35], v[140:143], v[236:239], v[32:35]
  s_nop 7
  v_max_f32 v50, v32, v33
  v_max3_f32 v50, v34, v35, v50
  v_mov_b32 v51, v50
  s_nop 1
  v_permlane16_swap_b32 v50, v51
  v_max_f32 v50, v50, v51
  v_mov_b32 v51, v50
  s_nop 1
  v_permlane32_swap_b32 v50, v51
  v_max3_f32 v50, v50, v51, v48
  v_mul_f32 v51, s58, v50
  v_fma_f32 v52, v48, s58, -v51
  v_fma_f32 v36, v32, s58, -v51
  v_fma_f32 v37, v33, s58, -v51
  v_fma_f32 v38, v34, s58, -v51
  v_fma_f32 v39, v35, s58, -v51
  v_exp_f32 v52, v52
  v_exp_f32 v36, v36
  v_exp_f32 v37, v37
  v_exp_f32 v38, v38
  v_exp_f32 v39, v39
  v_mov_b32 v48, v50
  v_fma_f32 v49, v49, v52, v36
  v_add_f32 v51, v37, v38
  v_mul_f32 v28, v28, v52
  v_mul_f32 v29, v29, v52
  v_mul_f32 v30, v30, v52
  v_mul_f32 v31, v31, v52
  v_add_f32 v49, v49, v39
  v_add_f32 v49, v49, v51
  s_waitcnt vmcnt(24)
  v_cvt_pk_bf16_f32 v50, v36, v36
  v_and_b32 v40, v50, v5
  v_and_b32 v41, v50, v6
  v_and_b32 v42, v50, v7
  v_and_b32 v43, v50, v8
  s_nop 1
  v_mfma_f32_16x16x32_bf16 v[28:31], v[144:147], v[40:43], v[28:31]
  v_cvt_pk_bf16_f32 v50, v37, v37
  v_and_b32 v44, v50, v5
  v_and_b32 v45, v50, v6
  v_and_b32 v46, v50, v7
  v_and_b32 v47, v50, v8
  s_nop 1
  v_mfma_f32_16x16x32_bf16 v[28:31], v[148:151], v[44:47], v[28:31]
  v_cvt_pk_bf16_f32 v50, v38, v38
  v_and_b32 v40, v50, v5
  v_and_b32 v41, v50, v6
  v_and_b32 v42, v50, v7
  v_and_b32 v43, v50, v8
  s_nop 1
  v_mfma_f32_16x16x32_bf16 v[28:31], v[152:155], v[40:43], v[28:31]
  v_cvt_pk_bf16_f32 v50, v39, v39
  v_and_b32 v44, v50, v5
  v_and_b32 v45, v50, v6
  v_and_b32 v46, v50, v7
  v_and_b32 v47, v50, v8
  s_nop 1
  v_mfma_f32_16x16x32_bf16 v[28:31], v[156:159], v[44:47], v[28:31]
L_ei_34:
  s_cmp_eq_u32 s79, 3
  s_cbranch_scc1 L_ism_35
  s_lshl_b32 s65, s88, 7
  v_add_u32 v54, s65, v63
  ds_read_b128 v[16:19], v54 offset:20480
  ds_read_b128 v[20:23], v54 offset:20496
  s_waitcnt lgkmcnt(0)
  v_max3_f32 v50, v16, v17, v18
  v_max3_f32 v51, v19, v20, v21
  v_max3_f32 v50, v22, v23, v50
  v_max_f32 v50, v50, v51
  v_mov_b32 v51, v50
  s_nop 1
  v_permlane16_swap_b32 v50, v51
  v_max_f32 v50, v50, v51
  v_mov_b32 v51, v50
  s_nop 1
  v_permlane32_swap_b32 v50, v51
  v_max3_f32 v50, v50, v51, v48
  v_mul_f32 v51, s58, v50
  v_fma_f32 v52, v48, s58, -v51
  v_fma_f32 v32, v16, s58, -v51
  v_fma_f32 v33, v17, s58, -v51
  v_fma_f32 v34, v18, s58, -v51
  v_fma_f32 v35, v19, s58, -v51
  v_fma_f32 v36, v20, s58, -v51
  v_fma_f32 v37, v21, s58, -v51
  v_fma_f32 v38, v22, s58, -v51
  v_fma_f32 v39, v23, s58, -v51
  v_exp_f32 v52, v52
  v_exp_f32 v32, v32
  v_exp_f32 v33, v33
  v_exp_f32 v34, v34
  v_exp_f32 v35, v35
  v_exp_f32 v36, v36
  v_exp_f32 v37, v37
  v_exp_f32 v38, v38
  v_exp_f32 v39, v39
  v_mov_b32 v48, v50
  v_fma_f32 v49, v49, v52, v32
  v_add_f32 v51, v33, v34
  v_add_f32 v50, v35, v36
  v_mul_f32 v28, v28, v52
  v_mul_f32 v29, v29, v52
  v_mul_f32 v30, v30, v52
  v_mul_f32 v31, v31, v52
  v_add_f32 v51, v51, v37
  v_add_f32 v50, v50, v38
  v_add_f32 v49, v49, v39
  v_add_f32 v51, v51, v50
  v_add_f32 v49, v49, v51
  s_waitcnt vmcnt(20)
  v_cvt_pk_bf16_f32 v50, v32, v32
  v_and_b32 v40, v50, v5
  v_and_b32 v41, v50, v6
  v_and_b32 v42, v50, v7
  v_and_b32 v43, v50, v8
  s_nop 1
  v_mfma_f32_16x16x32_bf16 v[28:31], v[160:163], v[40:43], v[28:31]
  v_cvt_pk_bf16_f32 v50, v33, v33
  v_and_b32 v44, v50, v5
  v_and_b32 v45, v50, v6
  v_and_b32 v46, v50, v7
  v_and_b32 v47, v50, v8
  s_nop 1
  v_mfma_f32_16x16x32_bf16 v[28:31], v[164:167], v[44:47], v[28:31]
  v_cvt_pk_bf16_f32 v50, v34, v34
  v_and_b32 v40, v50, v5
  v_and_b32 v41, v50, v6
  v_and_b32 v42, v50, v7
  v_and_b32 v43, v50, v8
  s_nop 1
  v_mfma_f32_16x16x32_bf16 v[28:31], v[168:171], v[40:43], v[28:31]
  v_cvt_pk_bf16_f32 v50, v35, v35
  v_and_b32 v44, v50, v5
  v_and_b32 v45, v50, v6
  v_and_b32 v46, v50, v7
  v_and_b32 v47, v50, v8
  s_nop 1
  v_mfma_f32_16x16x32_bf16 v[28:31], v[172:175], v[44:47], v[28:31]
  s_waitcnt vmcnt(16)
  v_cvt_pk_bf16_f32 v50, v36, v36
  v_and_b32 v40, v50, v5
  v_and_b32 v41, v50, v6
  v_and_b32 v42, v50, v7
  v_and_b32 v43, v50, v8
  s_nop 1
  v_mfma_f32_16x16x32_bf16 v[28:31], v[176:179], v[40:43], v[28:31]
  v_cvt_pk_bf16_f32 v50, v37, v37
  v_and_b32 v44, v50, v5
  v_and_b32 v45, v50, v6
  v_and_b32 v46, v50, v7
  v_and_b32 v47, v50, v8
  s_nop 1
  v_mfma_f32_16x16x32_bf16 v[28:31], v[180:183], v[44:47], v[28:31]
  v_cvt_pk_bf16_f32 v50, v38, v38
  v_and_b32 v40, v50, v5
  v_and_b32 v41, v50, v6
  v_and_b32 v42, v50, v7
  v_and_b32 v43, v50, v8
  s_nop 1
  v_mfma_f32_16x16x32_bf16 v[28:31], v[184:187], v[40:43], v[28:31]
  v_cvt_pk_bf16_f32 v50, v39, v39
  v_and_b32 v44, v50, v5
  v_and_b32 v45, v50, v6
  v_and_b32 v46, v50, v7
  v_and_b32 v47, v50, v8
  s_nop 1
  v_mfma_f32_16x16x32_bf16 v[28:31], v[188:191], v[44:47], v[28:31]
  s_branch L_ei_36
L_ism_35:
  s_waitcnt vmcnt(20)
  v_mfma_f32_16x16x32_bf16 v[32:35], v[160:163], v[224:227], 0
  v_mfma_f32_16x16x32_bf16 v[32:35], v[164:167], v[228:231], v[32:35]
  v_mfma_f32_16x16x32_bf16 v[32:35], v[168:171], v[232:235], v[32:35]
  v_mfma_f32_16x16x32_bf16 v[32:35], v[172:175], v[236:239], v[32:35]
  s_nop 7
  v_max_f32 v50, v32, v33
  v_max3_f32 v50, v34, v35, v50
  v_mov_b32 v51, v50
  s_nop 1
  v_permlane16_swap_b32 v50, v51
  v_max_f32 v50, v50, v51
  v_mov_b32 v51, v50
  s_nop 1
  v_permlane32_swap_b32 v50, v51
  v_max3_f32 v50, v50, v51, v48
  v_mul_f32 v51, s58, v50
  v_fma_f32 v52, v48, s58, -v51
  v_fma_f32 v36, v32, s58, -v51
  v_fma_f32 v37, v33, s58, -v51
  v_fma_f32 v38, v34, s58, -v51
  v_fma_f32 v39, v35, s58, -v51
  v_exp_f32 v52, v52
  v_exp_f32 v36, v36
  v_exp_f32 v37, v37
  v_exp_f32 v38, v38
  v_exp_f32 v39, v39
  v_mov_b32 v48, v50
  v_fma_f32 v49, v49, v52, v36
  v_add_f32 v51, v37, v38
  v_mul_f32 v28, v28, v52
  v_mul_f32 v29, v29, v52
  v_mul_f32 v30, v30, v52
  v_mul_f32 v31, v31, v52
  v_add_f32 v49, v49, v39
  v_add_f32 v49, v49, v51
  s_waitcnt vmcnt(16)
  v_cvt_pk_bf16_f32 v50, v36, v36
  v_and_b32 v40, v50, v5
  v_and_b32 v41, v50, v6
  v_and_b32 v42, v50, v7
  v_and_b32 v43, v50, v8
  s_nop 1
  v_mfma_f32_16x16x32_bf16 v[28:31], v[176:179], v[40:43], v[28:31]
  v_cvt_pk_bf16_f32 v50, v37, v37
  v_and_b32 v44, v50, v5
  v_and_b32 v45, v50, v6
  v_and_b32 v46, v50, v7
  v_and_b32 v47, v50, v8
  s_nop 1
  v_mfma_f32_16x16x32_bf16 v[28:31], v[180:183], v[44:47], v[28:31]
  v_cvt_pk_bf16_f32 v50, v38, v38
  v_and_b32 v40, v50, v5
  v_and_b32 v41, v50, v6
  v_and_b32 v42, v50, v7
  v_and_b32 v43, v50, v8
  s_nop 1
  v_mfma_f32_16x16x32_bf16 v[28:31], v[184:187], v[40:43], v[28:31]
  v_cvt_pk_bf16_f32 v50, v39, v39
  v_and_b32 v44, v50, v5
  v_and_b32 v45, v50, v6
  v_and_b32 v46, v50, v7
  v_and_b32 v47, v50, v8
  s_nop 1
  v_mfma_f32_16x16x32_bf16 v[28:31], v[188:191], v[44:47], v[28:31]
L_ei_36:
  s_cmp_eq_u32 s76, 3
  s_cbranch_scc1 L_ism_37
  s_lshl_b32 s65, s85, 7
  v_add_u32 v54, s65, v63
  ds_read_b128 v[16:19], v54 offset:20480
  ds_read_b128 v[20:23], v54 offset:20496
  s_waitcnt lgkmcnt(0)
  v_max3_f32 v50, v16, v17, v18
  v_max3_f32 v51, v19, v20, v21
  v_max3_f32 v50, v22, v23, v50
  v_max_f32 v50, v50, v51
  v_mov_b32 v51, v50
  s_nop 1
  v_permlane16_swap_b32 v50, v51
  v_max_f32 v50, v50, v51
  v_mov_b32 v51, v50
  s_nop 1
  v_permlane32_swap_b32 v50, v51
  v_max3_f32 v50, v50, v51, v48
  v_mul_f32 v51, s58, v50
  v_fma_f32 v52, v48, s58, -v51
  v_fma_f32 v32, v16, s58, -v51
  v_fma_f32 v33, v17, s58, -v51
  v_fma_f32 v34, v18, s58, -v51
  v_fma_f32 v35, v19, s58, -v51
  v_fma_f32 v36, v20, s58, -v51
  v_fma_f32 v37, v21, s58, -v51
  v_fma_f32 v38, v22, s58, -v51
  v_fma_f32 v39, v23, s58, -v51
  v_exp_f32 v52, v52
  v_exp_f32 v32, v32
  v_exp_f32 v33, v33
  v_exp_f32 v34, v34
  v_exp_f32 v35, v35
  v_exp_f32 v36, v36
  v_exp_f32 v37, v37
  v_exp_f32 v38, v38
  v_exp_f32 v39, v39
  v_mov_b32 v48, v50
  v_fma_f32 v49, v49, v52, v32
  v_add_f32 v51, v33, v34
  v_add_f32 v50, v35, v36
  v_mul_f32 v28, v28, v52
  v_mul_f32 v29, v29, v52
  v_mul_f32 v30, v30, v52
  v_mul_f32 v31, v31, v52
  v_add_f32 v51, v51, v37
  v_add_f32 v50, v50, v38
  v_add_f32 v49, v49, v39
  v_add_f32 v51, v51, v50
  v_add_f32 v49, v49, v51
  s_waitcnt vmcnt(12)
  v_cvt_pk_bf16_f32 v50, v32, v32
  v_and_b32 v40, v50, v5
  v_and_b32 v41, v50, v6
  v_and_b32 v42, v50, v7
  v_and_b32 v43, v50, v8
  s_nop 1
  v_mfma_f32_16x16x32_bf16 v[28:31], v[64:67], v[40:43], v[28:31]
  v_cvt_pk_bf16_f32 v50, v33, v33
  v_and_b32 v44, v50, v5
  v_and_b32 v45, v50, v6
  v_and_b32 v46, v50, v7
  v_and_b32 v47, v50, v8
  s_nop 1
  v_mfma_f32_16x16x32_bf16 v[28:31], v[68:71], v[44:47], v[28:31]
  v_cvt_pk_bf16_f32 v50, v34, v34
  v_and_b32 v40, v50, v5
  v_and_b32 v41, v50, v6
  v_and_b32 v42, v50, v7
  v_and_b32 v43, v50, v8
  s_nop 1
  v_mfma_f32_16x16x32_bf16 v[28:31], v[72:75], v[40:43], v[28:31]
  v_cvt_pk_bf16_f32 v50, v35, v35
  v_and_b32 v44, v50, v5
  v_and_b32 v45, v50, v6
  v_and_b32 v46, v50, v7
  v_and_b32 v47, v50, v8
  s_nop 1
  v_mfma_f32_16x16x32_bf16 v[28:31], v[76:79], v[44:47], v[28:31]
  s_waitcnt vmcnt(8)
  v_cvt_pk_bf16_f32 v50, v36, v36
  v_and_b32 v40, v50, v5
  v_and_b32 v41, v50, v6
  v_and_b32 v42, v50, v7
  v_and_b32 v43, v50, v8
  s_nop 1
  v_mfma_f32_16x16x32_bf16 v[28:31], v[80:83], v[40:43], v[28:31]
  v_cvt_pk_bf16_f32 v50, v37, v37
  v_and_b32 v44, v50, v5
  v_and_b32 v45, v50, v6
  v_and_b32 v46, v50, v7
  v_and_b32 v47, v50, v8
  s_nop 1
  v_mfma_f32_16x16x32_bf16 v[28:31], v[84:87], v[44:47], v[28:31]
  v_cvt_pk_bf16_f32 v50, v38, v38
  v_and_b32 v40, v50, v5
  v_and_b32 v41, v50, v6
  v_and_b32 v42, v50, v7
  v_and_b32 v43, v50, v8
  s_nop 1
  v_mfma_f32_16x16x32_bf16 v[28:31], v[88:91], v[40:43], v[28:31]
  v_cvt_pk_bf16_f32 v50, v39, v39
  v_and_b32 v44, v50, v5
  v_and_b32 v45, v50, v6
  v_and_b32 v46, v50, v7
  v_and_b32 v47, v50, v8
  s_nop 1
  v_mfma_f32_16x16x32_bf16 v[28:31], v[92:95], v[44:47], v[28:31]
  s_branch L_ei_38
L_ism_37:
  s_waitcnt vmcnt(12)
  v_mfma_f32_16x16x32_bf16 v[32:35], v[64:67], v[224:227], 0
  v_mfma_f32_16x16x32_bf16 v[32:35], v[68:71], v[228:231], v[32:35]
  v_mfma_f32_16x16x32_bf16 v[32:35], v[72:75], v[232:235], v[32:35]
  v_mfma_f32_16x16x32_bf16 v[32:35], v[76:79], v[236:239], v[32:35]
  s_nop 7
  v_max_f32 v50, v32, v33
  v_max3_f32 v50, v34, v35, v50
  v_mov_b32 v51, v50
  s_nop 1
  v_permlane16_swap_b32 v50, v51
  v_max_f32 v50, v50, v51
  v_mov_b32 v51, v50
  s_nop 1
  v_permlane32_swap_b32 v50, v51
  v_max3_f32 v50, v50, v51, v48
  v_mul_f32 v51, s58, v50
  v_fma_f32 v52, v48, s58, -v51
  v_fma_f32 v36, v32, s58, -v51
  v_fma_f32 v37, v33, s58, -v51
  v_fma_f32 v38, v34, s58, -v51
  v_fma_f32 v39, v35, s58, -v51
  v_exp_f32 v52, v52
  v_exp_f32 v36, v36
  v_exp_f32 v37, v37
  v_exp_f32 v38, v38
  v_exp_f32 v39, v39
  v_mov_b32 v48, v50
  v_fma_f32 v49, v49, v52, v36
  v_add_f32 v51, v37, v38
  v_mul_f32 v28, v28, v52
  v_mul_f32 v29, v29, v52
  v_mul_f32 v30, v30, v52
  v_mul_f32 v31, v31, v52
  v_add_f32 v49, v49, v39
  v_add_f32 v49, v49, v51
  s_waitcnt vmcnt(8)
  v_cvt_pk_bf16_f32 v50, v36, v36
  v_and_b32 v40, v50, v5
  v_and_b32 v41, v50, v6
  v_and_b32 v42, v50, v7
  v_and_b32 v43, v50, v8
  s_nop 1
  v_mfma_f32_16x16x32_bf16 v[28:31], v[80:83], v[40:43], v[28:31]
  v_cvt_pk_bf16_f32 v50, v37, v37
  v_and_b32 v44, v50, v5
  v_and_b32 v45, v50, v6
  v_and_b32 v46, v50, v7
  v_and_b32 v47, v50, v8
  s_nop 1
  v_mfma_f32_16x16x32_bf16 v[28:31], v[84:87], v[44:47], v[28:31]
  v_cvt_pk_bf16_f32 v50, v38, v38
  v_and_b32 v40, v50, v5
  v_and_b32 v41, v50, v6
  v_and_b32 v42, v50, v7
  v_and_b32 v43, v50, v8
  s_nop 1
  v_mfma_f32_16x16x32_bf16 v[28:31], v[88:91], v[40:43], v[28:31]
  v_cvt_pk_bf16_f32 v50, v39, v39
  v_and_b32 v44, v50, v5
  v_and_b32 v45, v50, v6
  v_and_b32 v46, v50, v7
  v_and_b32 v47, v50, v8
  s_nop 1
  v_mfma_f32_16x16x32_bf16 v[28:31], v[92:95], v[44:47], v[28:31]
L_ei_38:
  s_cmp_eq_u32 s77, 3
  s_cbranch_scc1 L_ism_39
  s_lshl_b32 s65, s86, 7
  v_add_u32 v54, s65, v63
  ds_read_b128 v[16:19], v54 offset:20480
  ds_read_b128 v[20:23], v54 offset:20496
  s_waitcnt lgkmcnt(0)
  v_max3_f32 v50, v16, v17, v18
  v_max3_f32 v51, v19, v20, v21
  v_max3_f32 v50, v22, v23, v50
  v_max_f32 v50, v50, v51
  v_mov_b32 v51, v50
  s_nop 1
  v_permlane16_swap_b32 v50, v51
  v_max_f32 v50, v50, v51
  v_mov_b32 v51, v50
  s_nop 1
  v_permlane32_swap_b32 v50, v51
  v_max3_f32 v50, v50, v51, v48
  v_mul_f32 v51, s58, v50
  v_fma_f32 v52, v48, s58, -v51
  v_fma_f32 v32, v16, s58, -v51
  v_fma_f32 v33, v17, s58, -v51
  v_fma_f32 v34, v18, s58, -v51
  v_fma_f32 v35, v19, s58, -v51
  v_fma_f32 v36, v20, s58, -v51
  v_fma_f32 v37, v21, s58, -v51
  v_fma_f32 v38, v22, s58, -v51
  v_fma_f32 v39, v23, s58, -v51
  v_exp_f32 v52, v52
  v_exp_f32 v32, v32
  v_exp_f32 v33, v33
  v_exp_f32 v34, v34
  v_exp_f32 v35, v35
  v_exp_f32 v36, v36
  v_exp_f32 v37, v37
  v_exp_f32 v38, v38
  v_exp_f32 v39, v39
  v_mov_b32 v48, v50
  v_fma_f32 v49, v49, v52, v32
  v_add_f32 v51, v33, v34
  v_add_f32 v50, v35, v36
  v_mul_f32 v28, v28, v52
  v_mul_f32 v29, v29, v52
  v_mul_f32 v30, v30, v52
  v_mul_f32 v31, v31, v52
  v_add_f32 v51, v51, v37
  v_add_f32 v50, v50, v38
  v_add_f32 v49, v49, v39
  v_add_f32 v51, v51, v50
  v_add_f32 v49, v49, v51
  s_waitcnt vmcnt(4)
  v_cvt_pk_bf16_f32 v50, v32, v32
  v_and_b32 v40, v50, v5
  v_and_b32 v41, v50, v6
  v_and_b32 v42, v50, v7
  v_and_b32 v43, v50, v8
  s_nop 1
  v_mfma_f32_16x16x32_bf16 v[28:31], v[96:99], v[40:43], v[28:31]
  v_cvt_pk_bf16_f32 v50, v33, v33
  v_and_b32 v44, v50, v5
  v_and_b32 v45, v50, v6
  v_and_b32 v46, v50, v7
  v_and_b32 v47, v50, v8
  s_nop 1
  v_mfma_f32_16x16x32_bf16 v[28:31], v[100:103], v[44:47], v[28:31]
  v_cvt_pk_bf16_f32 v50, v34, v34
  v_and_b32 v40, v50, v5
  v_and_b32 v41, v50, v6
  v_and_b32 v42, v50, v7
  v_and_b32 v43, v50, v8
  s_nop 1
  v_mfma_f32_16x16x32_bf16 v[28:31], v[104:107], v[40:43], v[28:31]
  v_cvt_pk_bf16_f32 v50, v35, v35
  v_and_b32 v44, v50, v5
  v_and_b32 v45, v50, v6
  v_and_b32 v46, v50, v7
  v_and_b32 v47, v50, v8
  s_nop 1
  v_mfma_f32_16x16x32_bf16 v[28:31], v[108:111], v[44:47], v[28:31]
  s_waitcnt vmcnt(0)
  v_cvt_pk_bf16_f32 v50, v36, v36
  v_and_b32 v40, v50, v5
  v_and_b32 v41, v50, v6
  v_and_b32 v42, v50, v7
  v_and_b32 v43, v50, v8
  s_nop 1
  v_mfma_f32_16x16x32_bf16 v[28:31], v[112:115], v[40:43], v[28:31]
  v_cvt_pk_bf16_f32 v50, v37, v37
  v_and_b32 v44, v50, v5
  v_and_b32 v45, v50, v6
  v_and_b32 v46, v50, v7
  v_and_b32 v47, v50, v8
  s_nop 1
  v_mfma_f32_16x16x32_bf16 v[28:31], v[116:119], v[44:47], v[28:31]
  v_cvt_pk_bf16_f32 v50, v38, v38
  v_and_b32 v40, v50, v5
  v_and_b32 v41, v50, v6
  v_and_b32 v42, v50, v7
  v_and_b32 v43, v50, v8
  s_nop 1
  v_mfma_f32_16x16x32_bf16 v[28:31], v[120:123], v[40:43], v[28:31]
  v_cvt_pk_bf16_f32 v50, v39, v39
  v_and_b32 v44, v50, v5
  v_and_b32 v45, v50, v6
  v_and_b32 v46, v50, v7
  v_and_b32 v47, v50, v8
  s_nop 1
  v_mfma_f32_16x16x32_bf16 v[28:31], v[124:127], v[44:47], v[28:31]
  s_branch L_ei_40
L_ism_39:
  s_waitcnt vmcnt(4)
  v_mfma_f32_16x16x32_bf16 v[32:35], v[96:99], v[224:227], 0
  v_mfma_f32_16x16x32_bf16 v[32:35], v[100:103], v[228:231], v[32:35]
  v_mfma_f32_16x16x32_bf16 v[32:35], v[104:107], v[232:235], v[32:35]
  v_mfma_f32_16x16x32_bf16 v[32:35], v[108:111], v[236:239], v[32:35]
  s_nop 7
  v_max_f32 v50, v32, v33
  v_max3_f32 v50, v34, v35, v50
  v_mov_b32 v51, v50
  s_nop 1
  v_permlane16_swap_b32 v50, v51
  v_max_f32 v50, v50, v51
  v_mov_b32 v51, v50
  s_nop 1
  v_permlane32_swap_b32 v50, v51
  v_max3_f32 v50, v50, v51, v48
  v_mul_f32 v51, s58, v50
  v_fma_f32 v52, v48, s58, -v51
  v_fma_f32 v36, v32, s58, -v51
  v_fma_f32 v37, v33, s58, -v51
  v_fma_f32 v38, v34, s58, -v51
  v_fma_f32 v39, v35, s58, -v51
  v_exp_f32 v52, v52
  v_exp_f32 v36, v36
  v_exp_f32 v37, v37
  v_exp_f32 v38, v38
  v_exp_f32 v39, v39
  v_mov_b32 v48, v50
  v_fma_f32 v49, v49, v52, v36
  v_add_f32 v51, v37, v38
  v_mul_f32 v28, v28, v52
  v_mul_f32 v29, v29, v52
  v_mul_f32 v30, v30, v52
  v_mul_f32 v31, v31, v52
  v_add_f32 v49, v49, v39
  v_add_f32 v49, v49, v51
  s_waitcnt vmcnt(0)
  v_cvt_pk_bf16_f32 v50, v36, v36
  v_and_b32 v40, v50, v5
  v_and_b32 v41, v50, v6
  v_and_b32 v42, v50, v7
  v_and_b32 v43, v50, v8
  s_nop 1
  v_mfma_f32_16x16x32_bf16 v[28:31], v[112:115], v[40:43], v[28:31]
  v_cvt_pk_bf16_f32 v50, v37, v37
  v_and_b32 v44, v50, v5
  v_and_b32 v45, v50, v6
  v_and_b32 v46, v50, v7
  v_and_b32 v47, v50, v8
  s_nop 1
  v_mfma_f32_16x16x32_bf16 v[28:31], v[116:119], v[44:47], v[28:31]
  v_cvt_pk_bf16_f32 v50, v38, v38
  v_and_b32 v40, v50, v5
  v_and_b32 v41, v50, v6
  v_and_b32 v42, v50, v7
  v_and_b32 v43, v50, v8
  s_nop 1
  v_mfma_f32_16x16x32_bf16 v[28:31], v[120:123], v[40:43], v[28:31]
  v_cvt_pk_bf16_f32 v50, v39, v39
  v_and_b32 v44, v50, v5
  v_and_b32 v45, v50, v6
  v_and_b32 v46, v50, v7
  v_and_b32 v47, v50, v8
  s_nop 1
  v_mfma_f32_16x16x32_bf16 v[28:31], v[124:127], v[44:47], v[28:31]
L_ei_40:
  s_branch L_sdone
L_drain3:
  s_cmp_eq_u32 s79, 3
  s_cbranch_scc1 L_ism_41
  s_lshl_b32 s65, s88, 7
  v_add_u32 v54, s65, v63
  ds_read_b128 v[16:19], v54 offset:20480
  ds_read_b128 v[20:23], v54 offset:20496
  s_waitcnt lgkmcnt(0)
  v_max3_f32 v50, v16, v17, v18
  v_max3_f32 v51, v19, v20, v21
  v_max3_f32 v50, v22, v23, v50
  v_max_f32 v50, v50, v51
  v_mov_b32 v51, v50
  s_nop 1
  v_permlane16_swap_b32 v50, v51
  v_max_f32 v50, v50, v51
  v_mov_b32 v51, v50
  s_nop 1
  v_permlane32_swap_b32 v50, v51
  v_max3_f32 v50, v50, v51, v48
  v_mul_f32 v51, s58, v50
  v_fma_f32 v52, v48, s58, -v51
  v_fma_f32 v32, v16, s58, -v51
  v_fma_f32 v33, v17, s58, -v51
  v_fma_f32 v34, v18, s58, -v51
  v_fma_f32 v35, v19, s58, -v51
  v_fma_f32 v36, v20, s58, -v51
  v_fma_f32 v37, v21, s58, -v51
  v_fma_f32 v38, v22, s58, -v51
  v_fma_f32 v39, v23, s58, -v51
  v_exp_f32 v52, v52
  v_exp_f32 v32, v32
  v_exp_f32 v33, v33
  v_exp_f32 v34, v34
  v_exp_f32 v35, v35
  v_exp_f32 v36, v36
  v_exp_f32 v37, v37
  v_exp_f32 v38, v38
  v_exp_f32 v39, v39
  v_mov_b32 v48, v50
  v_fma_f32 v49, v49, v52, v32
  v_add_f32 v51, v33, v34
  v_add_f32 v50, v35, v36
  v_mul_f32 v28, v28, v52
  v_mul_f32 v29, v29, v52
  v_mul_f32 v30, v30, v52
  v_mul_f32 v31, v31, v52
  v_add_f32 v51, v51, v37
  v_add_f32 v50, v50, v38
  v_add_f32 v49, v49, v39
  v_add_f32 v51, v51, v50
  v_add_f32 v49, v49, v51
  s_waitcnt vmcnt(28)
  v_cvt_pk_bf16_f32 v50, v32, v32
  v_and_b32 v40, v50, v5
  v_and_b32 v41, v50, v6
  v_and_b32 v42, v50, v7
  v_and_b32 v43, v50, v8
  s_nop 1
  v_mfma_f32_16x16x32_bf16 v[28:31], v[160:163], v[40:43], v[28:31]
  v_cvt_pk_bf16_f32 v50, v33, v33
  v_and_b32 v44, v50, v5
  v_and_b32 v45, v50, v6
  v_and_b32 v46, v50, v7
  v_and_b32 v47, v50, v8
  s_nop 1
  v_mfma_f32_16x16x32_bf16 v[28:31], v[164:167], v[44:47], v[28:31]
  v_cvt_pk_bf16_f32 v50, v34, v34
  v_and_b32 v40, v50, v5
  v_and_b32 v41, v50, v6
  v_and_b32 v42, v50, v7
  v_and_b32 v43, v50, v8
  s_nop 1
  v_mfma_f32_16x16x32_bf16 v[28:31], v[168:171], v[40:43], v[28:31]
  v_cvt_pk_bf16_f32 v50, v35, v35
  v_and_b32 v44, v50, v5
  v_and_b32 v45, v50, v6
  v_and_b32 v46, v50, v7
  v_and_b32 v47, v50, v8
  s_nop 1
  v_mfma_f32_16x16x32_bf16 v[28:31], v[172:175], v[44:47], v[28:31]
  s_waitcnt vmcnt(24)
  v_cvt_pk_bf16_f32 v50, v36, v36
  v_and_b32 v40, v50, v5
  v_and_b32 v41, v50, v6
  v_and_b32 v42, v50, v7
  v_and_b32 v43, v50, v8
  s_nop 1
  v_mfma_f32_16x16x32_bf16 v[28:31], v[176:179], v[40:43], v[28:31]
  v_cvt_pk_bf16_f32 v50, v37, v37
  v_and_b32 v44, v50, v5
  v_and_b32 v45, v50, v6
  v_and_b32 v46, v50, v7
  v_and_b32 v47, v50, v8
  s_nop 1
  v_mfma_f32_16x16x32_bf16 v[28:31], v[180:183], v[44:47], v[28:31]
  v_cvt_pk_bf16_f32 v50, v38, v38
  v_and_b32 v40, v50, v5
  v_and_b32 v41, v50, v6
  v_and_b32 v42, v50, v7
  v_and_b32 v43, v50, v8
  s_nop 1
  v_mfma_f32_16x16x32_bf16 v[28:31], v[184:187], v[40:43], v[28:31]
  v_cvt_pk_bf16_f32 v50, v39, v39
  v_and_b32 v44, v50, v5
  v_and_b32 v45, v50, v6
  v_and_b32 v46, v50, v7
  v_and_b32 v47, v50, v8
  s_nop 1
  v_mfma_f32_16x16x32_bf16 v[28:31], v[188:191], v[44:47], v[28:31]
  s_branch L_ei_42
L_ism_41:
  s_waitcnt vmcnt(28)
  v_mfma_f32_16x16x32_bf16 v[32:35], v[160:163], v[224:227], 0
  v_mfma_f32_16x16x32_bf16 v[32:35], v[164:167], v[228:231], v[32:35]
  v_mfma_f32_16x16x32_bf16 v[32:35], v[168:171], v[232:235], v[32:35]
  v_mfma_f32_16x16x32_bf16 v[32:35], v[172:175], v[236:239], v[32:35]
  s_nop 7
  v_max_f32 v50, v32, v33
  v_max3_f32 v50, v34, v35, v50
  v_mov_b32 v51, v50
  s_nop 1
  v_permlane16_swap_b32 v50, v51
  v_max_f32 v50, v50, v51
  v_mov_b32 v51, v50
  s_nop 1
  v_permlane32_swap_b32 v50, v51
  v_max3_f32 v50, v50, v51, v48
  v_mul_f32 v51, s58, v50
  v_fma_f32 v52, v48, s58, -v51
  v_fma_f32 v36, v32, s58, -v51
  v_fma_f32 v37, v33, s58, -v51
  v_fma_f32 v38, v34, s58, -v51
  v_fma_f32 v39, v35, s58, -v51
  v_exp_f32 v52, v52
  v_exp_f32 v36, v36
  v_exp_f32 v37, v37
  v_exp_f32 v38, v38
  v_exp_f32 v39, v39
  v_mov_b32 v48, v50
  v_fma_f32 v49, v49, v52, v36
  v_add_f32 v51, v37, v38
  v_mul_f32 v28, v28, v52
  v_mul_f32 v29, v29, v52
  v_mul_f32 v30, v30, v52
  v_mul_f32 v31, v31, v52
  v_add_f32 v49, v49, v39
  v_add_f32 v49, v49, v51
  s_waitcnt vmcnt(24)
  v_cvt_pk_bf16_f32 v50, v36, v36
  v_and_b32 v40, v50, v5
  v_and_b32 v41, v50, v6
  v_and_b32 v42, v50, v7
  v_and_b32 v43, v50, v8
  s_nop 1
  v_mfma_f32_16x16x32_bf16 v[28:31], v[176:179], v[40:43], v[28:31]
  v_cvt_pk_bf16_f32 v50, v37, v37
  v_and_b32 v44, v50, v5
  v_and_b32 v45, v50, v6
  v_and_b32 v46, v50, v7
  v_and_b32 v47, v50, v8
  s_nop 1
  v_mfma_f32_16x16x32_bf16 v[28:31], v[180:183], v[44:47], v[28:31]
  v_cvt_pk_bf16_f32 v50, v38, v38
  v_and_b32 v40, v50, v5
  v_and_b32 v41, v50, v6
  v_and_b32 v42, v50, v7
  v_and_b32 v43, v50, v8
  s_nop 1
  v_mfma_f32_16x16x32_bf16 v[28:31], v[184:187], v[40:43], v[28:31]
  v_cvt_pk_bf16_f32 v50, v39, v39
  v_and_b32 v44, v50, v5
  v_and_b32 v45, v50, v6
  v_and_b32 v46, v50, v7
  v_and_b32 v47, v50, v8
  s_nop 1
  v_mfma_f32_16x16x32_bf16 v[28:31], v[188:191], v[44:47], v[28:31]
L_ei_42:
  s_cmp_eq_u32 s76, 3
  s_cbranch_scc1 L_ism_43
  s_lshl_b32 s65, s85, 7
  v_add_u32 v54, s65, v63
  ds_read_b128 v[16:19], v54 offset:20480
  ds_read_b128 v[20:23], v54 offset:20496
  s_waitcnt lgkmcnt(0)
  v_max3_f32 v50, v16, v17, v18
  v_max3_f32 v51, v19, v20, v21
  v_max3_f32 v50, v22, v23, v50
  v_max_f32 v50, v50, v51
  v_mov_b32 v51, v50
  s_nop 1
  v_permlane16_swap_b32 v50, v51
  v_max_f32 v50, v50, v51
  v_mov_b32 v51, v50
  s_nop 1
  v_permlane32_swap_b32 v50, v51
  v_max3_f32 v50, v50, v51, v48
  v_mul_f32 v51, s58, v50
  v_fma_f32 v52, v48, s58, -v51
  v_fma_f32 v32, v16, s58, -v51
  v_fma_f32 v33, v17, s58, -v51
  v_fma_f32 v34, v18, s58, -v51
  v_fma_f32 v35, v19, s58, -v51
  v_fma_f32 v36, v20, s58, -v51
  v_fma_f32 v37, v21, s58, -v51
  v_fma_f32 v38, v22, s58, -v51
  v_fma_f32 v39, v23, s58, -v51
  v_exp_f32 v52, v52
  v_exp_f32 v32, v32
  v_exp_f32 v33, v33
  v_exp_f32 v34, v34
  v_exp_f32 v35, v35
  v_exp_f32 v36, v36
  v_exp_f32 v37, v37
  v_exp_f32 v38, v38
  v_exp_f32 v39, v39
  v_mov_b32 v48, v50
  v_fma_f32 v49, v49, v52, v32
  v_add_f32 v51, v33, v34
  v_add_f32 v50, v35, v36
  v_mul_f32 v28, v28, v52
  v_mul_f32 v29, v29, v52
  v_mul_f32 v30, v30, v52
  v_mul_f32 v31, v31, v52
  v_add_f32 v51, v51, v37
  v_add_f32 v50, v50, v38
  v_add_f32 v49, v49, v39
  v_add_f32 v51, v51, v50
  v_add_f32 v49, v49, v51
  s_waitcnt vmcnt(20)
  v_cvt_pk_bf16_f32 v50, v32, v32
  v_and_b32 v40, v50, v5
  v_and_b32 v41, v50, v6
  v_and_b32 v42, v50, v7
  v_and_b32 v43, v50, v8
  s_nop 1
  v_mfma_f32_16x16x32_bf16 v[28:31], v[64:67], v[40:43], v[28:31]
  v_cvt_pk_bf16_f32 v50, v33, v33
  v_and_b32 v44, v50, v5
  v_and_b32 v45, v50, v6
  v_and_b32 v46, v50, v7
  v_and_b32 v47, v50, v8
  s_nop 1
  v_mfma_f32_16x16x32_bf16 v[28:31], v[68:71], v[44:47], v[28:31]
  v_cvt_pk_bf16_f32 v50, v34, v34
  v_and_b32 v40, v50, v5
  v_and_b32 v41, v50, v6
  v_and_b32 v42, v50, v7
  v_and_b32 v43, v50, v8
  s_nop 1
  v_mfma_f32_16x16x32_bf16 v[28:31], v[72:75], v[40:43], v[28:31]
  v_cvt_pk_bf16_f32 v50, v35, v35
  v_and_b32 v44, v50, v5
  v_and_b32 v45, v50, v6
  v_and_b32 v46, v50, v7
  v_and_b32 v47, v50, v8
  s_nop 1
  v_mfma_f32_16x16x32_bf16 v[28:31], v[76:79], v[44:47], v[28:31]
  s_waitcnt vmcnt(16)
  v_cvt_pk_bf16_f32 v50, v36, v36
  v_and_b32 v40, v50, v5
  v_and_b32 v41, v50, v6
  v_and_b32 v42, v50, v7
  v_and_b32 v43, v50, v8
  s_nop 1
  v_mfma_f32_16x16x32_bf16 v[28:31], v[80:83], v[40:43], v[28:31]
  v_cvt_pk_bf16_f32 v50, v37, v37
  v_and_b32 v44, v50, v5
  v_and_b32 v45, v50, v6
  v_and_b32 v46, v50, v7
  v_and_b32 v47, v50, v8
  s_nop 1
  v_mfma_f32_16x16x32_bf16 v[28:31], v[84:87], v[44:47], v[28:31]
  v_cvt_pk_bf16_f32 v50, v38, v38
  v_and_b32 v40, v50, v5
  v_and_b32 v41, v50, v6
  v_and_b32 v42, v50, v7
  v_and_b32 v43, v50, v8
  s_nop 1
  v_mfma_f32_16x16x32_bf16 v[28:31], v[88:91], v[40:43], v[28:31]
  v_cvt_pk_bf16_f32 v50, v39, v39
  v_and_b32 v44, v50, v5
  v_and_b32 v45, v50, v6
  v_and_b32 v46, v50, v7
  v_and_b32 v47, v50, v8
  s_nop 1
  v_mfma_f32_16x16x32_bf16 v[28:31], v[92:95], v[44:47], v[28:31]
  s_branch L_ei_44
L_ism_43:
  s_waitcnt vmcnt(20)
  v_mfma_f32_16x16x32_bf16 v[32:35], v[64:67], v[224:227], 0
  v_mfma_f32_16x16x32_bf16 v[32:35], v[68:71], v[228:231], v[32:35]
  v_mfma_f32_16x16x32_bf16 v[32:35], v[72:75], v[232:235], v[32:35]
  v_mfma_f32_16x16x32_bf16 v[32:35], v[76:79], v[236:239], v[32:35]
  s_nop 7
  v_max_f32 v50, v32, v33
  v_max3_f32 v50, v34, v35, v50
  v_mov_b32 v51, v50
  s_nop 1
  v_permlane16_swap_b32 v50, v51
  v_max_f32 v50, v50, v51
  v_mov_b32 v51, v50
  s_nop 1
  v_permlane32_swap_b32 v50, v51
  v_max3_f32 v50, v50, v51, v48
  v_mul_f32 v51, s58, v50
  v_fma_f32 v52, v48, s58, -v51
  v_fma_f32 v36, v32, s58, -v51
  v_fma_f32 v37, v33, s58, -v51
  v_fma_f32 v38, v34, s58, -v51
  v_fma_f32 v39, v35, s58, -v51
  v_exp_f32 v52, v52
  v_exp_f32 v36, v36
  v_exp_f32 v37, v37
  v_exp_f32 v38, v38
  v_exp_f32 v39, v39
  v_mov_b32 v48, v50
  v_fma_f32 v49, v49, v52, v36
  v_add_f32 v51, v37, v38
  v_mul_f32 v28, v28, v52
  v_mul_f32 v29, v29, v52
  v_mul_f32 v30, v30, v52
  v_mul_f32 v31, v31, v52
  v_add_f32 v49, v49, v39
  v_add_f32 v49, v49, v51
  s_waitcnt vmcnt(16)
  v_cvt_pk_bf16_f32 v50, v36, v36
  v_and_b32 v40, v50, v5
  v_and_b32 v41, v50, v6
  v_and_b32 v42, v50, v7
  v_and_b32 v43, v50, v8
  s_nop 1
  v_mfma_f32_16x16x32_bf16 v[28:31], v[80:83], v[40:43], v[28:31]
  v_cvt_pk_bf16_f32 v50, v37, v37
  v_and_b32 v44, v50, v5
  v_and_b32 v45, v50, v6
  v_and_b32 v46, v50, v7
  v_and_b32 v47, v50, v8
  s_nop 1
  v_mfma_f32_16x16x32_bf16 v[28:31], v[84:87], v[44:47], v[28:31]
  v_cvt_pk_bf16_f32 v50, v38, v38
  v_and_b32 v40, v50, v5
  v_and_b32 v41, v50, v6
  v_and_b32 v42, v50, v7
  v_and_b32 v43, v50, v8
  s_nop 1
  v_mfma_f32_16x16x32_bf16 v[28:31], v[88:91], v[40:43], v[28:31]
  v_cvt_pk_bf16_f32 v50, v39, v39
  v_and_b32 v44, v50, v5
  v_and_b32 v45, v50, v6
  v_and_b32 v46, v50, v7
  v_and_b32 v47, v50, v8
  s_nop 1
  v_mfma_f32_16x16x32_bf16 v[28:31], v[92:95], v[44:47], v[28:31]
L_ei_44:
  s_cmp_eq_u32 s77, 3
  s_cbranch_scc1 L_ism_45
  s_lshl_b32 s65, s86, 7
  v_add_u32 v54, s65, v63
  ds_read_b128 v[16:19], v54 offset:20480
  ds_read_b128 v[20:23], v54 offset:20496
  s_waitcnt lgkmcnt(0)
  v_max3_f32 v50, v16, v17, v18
  v_max3_f32 v51, v19, v20, v21
  v_max3_f32 v50, v22, v23, v50
  v_max_f32 v50, v50, v51
  v_mov_b32 v51, v50
  s_nop 1
  v_permlane16_swap_b32 v50, v51
  v_max_f32 v50, v50, v51
  v_mov_b32 v51, v50
  s_nop 1
  v_permlane32_swap_b32 v50, v51
  v_max3_f32 v50, v50, v51, v48
  v_mul_f32 v51, s58, v50
  v_fma_f32 v52, v48, s58, -v51
  v_fma_f32 v32, v16, s58, -v51
  v_fma_f32 v33, v17, s58, -v51
  v_fma_f32 v34, v18, s58, -v51
  v_fma_f32 v35, v19, s58, -v51
  v_fma_f32 v36, v20, s58, -v51
  v_fma_f32 v37, v21, s58, -v51
  v_fma_f32 v38, v22, s58, -v51
  v_fma_f32 v39, v23, s58, -v51
  v_exp_f32 v52, v52
  v_exp_f32 v32, v32
  v_exp_f32 v33, v33
  v_exp_f32 v34, v34
  v_exp_f32 v35, v35
  v_exp_f32 v36, v36
  v_exp_f32 v37, v37
  v_exp_f32 v38, v38
  v_exp_f32 v39, v39
  v_mov_b32 v48, v50
  v_fma_f32 v49, v49, v52, v32
  v_add_f32 v51, v33, v34
  v_add_f32 v50, v35, v36
  v_mul_f32 v28, v28, v52
  v_mul_f32 v29, v29, v52
  v_mul_f32 v30, v30, v52
  v_mul_f32 v31, v31, v52
  v_add_f32 v51, v51, v37
  v_add_f32 v50, v50, v38
  v_add_f32 v49, v49, v39
  v_add_f32 v51, v51, v50
  v_add_f32 v49, v49, v51
  s_waitcnt vmcnt(12)
  v_cvt_pk_bf16_f32 v50, v32, v32
  v_and_b32 v40, v50, v5
  v_and_b32 v41, v50, v6
  v_and_b32 v42, v50, v7
  v_and_b32 v43, v50, v8
  s_nop 1
  v_mfma_f32_16x16x32_bf16 v[28:31], v[96:99], v[40:43], v[28:31]
  v_cvt_pk_bf16_f32 v50, v33, v33
  v_and_b32 v44, v50, v5
  v_and_b32 v45, v50, v6
  v_and_b32 v46, v50, v7
  v_and_b32 v47, v50, v8
  s_nop 1
  v_mfma_f32_16x16x32_bf16 v[28:31], v[100:103], v[44:47], v[28:31]
  v_cvt_pk_bf16_f32 v50, v34, v34
  v_and_b32 v40, v50, v5
  v_and_b32 v41, v50, v6
  v_and_b32 v42, v50, v7
  v_and_b32 v43, v50, v8
  s_nop 1
  v_mfma_f32_16x16x32_bf16 v[28:31], v[104:107], v[40:43], v[28:31]
  v_cvt_pk_bf16_f32 v50, v35, v35
  v_and_b32 v44, v50, v5
  v_and_b32 v45, v50, v6
  v_and_b32 v46, v50, v7
  v_and_b32 v47, v50, v8
  s_nop 1
  v_mfma_f32_16x16x32_bf16 v[28:31], v[108:111], v[44:47], v[28:31]
  s_waitcnt vmcnt(8)
  v_cvt_pk_bf16_f32 v50, v36, v36
  v_and_b32 v40, v50, v5
  v_and_b32 v41, v50, v6
  v_and_b32 v42, v50, v7
  v_and_b32 v43, v50, v8
  s_nop 1
  v_mfma_f32_16x16x32_bf16 v[28:31], v[112:115], v[40:43], v[28:31]
  v_cvt_pk_bf16_f32 v50, v37, v37
  v_and_b32 v44, v50, v5
  v_and_b32 v45, v50, v6
  v_and_b32 v46, v50, v7
  v_and_b32 v47, v50, v8
  s_nop 1
  v_mfma_f32_16x16x32_bf16 v[28:31], v[116:119], v[44:47], v[28:31]
  v_cvt_pk_bf16_f32 v50, v38, v38
  v_and_b32 v40, v50, v5
  v_and_b32 v41, v50, v6
  v_and_b32 v42, v50, v7
  v_and_b32 v43, v50, v8
  s_nop 1
  v_mfma_f32_16x16x32_bf16 v[28:31], v[120:123], v[40:43], v[28:31]
  v_cvt_pk_bf16_f32 v50, v39, v39
  v_and_b32 v44, v50, v5
  v_and_b32 v45, v50, v6
  v_and_b32 v46, v50, v7
  v_and_b32 v47, v50, v8
  s_nop 1
  v_mfma_f32_16x16x32_bf16 v[28:31], v[124:127], v[44:47], v[28:31]
  s_branch L_ei_46
L_ism_45:
  s_waitcnt vmcnt(12)
  v_mfma_f32_16x16x32_bf16 v[32:35], v[96:99], v[224:227], 0
  v_mfma_f32_16x16x32_bf16 v[32:35], v[100:103], v[228:231], v[32:35]
  v_mfma_f32_16x16x32_bf16 v[32:35], v[104:107], v[232:235], v[32:35]
  v_mfma_f32_16x16x32_bf16 v[32:35], v[108:111], v[236:239], v[32:35]
  s_nop 7
  v_max_f32 v50, v32, v33
  v_max3_f32 v50, v34, v35, v50
  v_mov_b32 v51, v50
  s_nop 1
  v_permlane16_swap_b32 v50, v51
  v_max_f32 v50, v50, v51
  v_mov_b32 v51, v50
  s_nop 1
  v_permlane32_swap_b32 v50, v51
  v_max3_f32 v50, v50, v51, v48
  v_mul_f32 v51, s58, v50
  v_fma_f32 v52, v48, s58, -v51
  v_fma_f32 v36, v32, s58, -v51
  v_fma_f32 v37, v33, s58, -v51
  v_fma_f32 v38, v34, s58, -v51
  v_fma_f32 v39, v35, s58, -v51
  v_exp_f32 v52, v52
  v_exp_f32 v36, v36
  v_exp_f32 v37, v37
  v_exp_f32 v38, v38
  v_exp_f32 v39, v39
  v_mov_b32 v48, v50
  v_fma_f32 v49, v49, v52, v36
  v_add_f32 v51, v37, v38
  v_mul_f32 v28, v28, v52
  v_mul_f32 v29, v29, v52
  v_mul_f32 v30, v30, v52
  v_mul_f32 v31, v31, v52
  v_add_f32 v49, v49, v39
  v_add_f32 v49, v49, v51
  s_waitcnt vmcnt(8)
  v_cvt_pk_bf16_f32 v50, v36, v36
  v_and_b32 v40, v50, v5
  v_and_b32 v41, v50, v6
  v_and_b32 v42, v50, v7
  v_and_b32 v43, v50, v8
  s_nop 1
  v_mfma_f32_16x16x32_bf16 v[28:31], v[112:115], v[40:43], v[28:31]
  v_cvt_pk_bf16_f32 v50, v37, v37
  v_and_b32 v44, v50, v5
  v_and_b32 v45, v50, v6
  v_and_b32 v46, v50, v7
  v_and_b32 v47, v50, v8
  s_nop 1
  v_mfma_f32_16x16x32_bf16 v[28:31], v[116:119], v[44:47], v[28:31]
  v_cvt_pk_bf16_f32 v50, v38, v38
  v_and_b32 v40, v50, v5
  v_and_b32 v41, v50, v6
  v_and_b32 v42, v50, v7
  v_and_b32 v43, v50, v8
  s_nop 1
  v_mfma_f32_16x16x32_bf16 v[28:31], v[120:123], v[40:43], v[28:31]
  v_cvt_pk_bf16_f32 v50, v39, v39
  v_and_b32 v44, v50, v5
  v_and_b32 v45, v50, v6
  v_and_b32 v46, v50, v7
  v_and_b32 v47, v50, v8
  s_nop 1
  v_mfma_f32_16x16x32_bf16 v[28:31], v[124:127], v[44:47], v[28:31]
L_ei_46:
  s_cmp_eq_u32 s78, 3
  s_cbranch_scc1 L_ism_47
  s_lshl_b32 s65, s87, 7
  v_add_u32 v54, s65, v63
  ds_read_b128 v[16:19], v54 offset:20480
  ds_read_b128 v[20:23], v54 offset:20496
  s_waitcnt lgkmcnt(0)
  v_max3_f32 v50, v16, v17, v18
  v_max3_f32 v51, v19, v20, v21
  v_max3_f32 v50, v22, v23, v50
  v_max_f32 v50, v50, v51
  v_mov_b32 v51, v50
  s_nop 1
  v_permlane16_swap_b32 v50, v51
  v_max_f32 v50, v50, v51
  v_mov_b32 v51, v50
  s_nop 1
  v_permlane32_swap_b32 v50, v51
  v_max3_f32 v50, v50, v51, v48
  v_mul_f32 v51, s58, v50
  v_fma_f32 v52, v48, s58, -v51
  v_fma_f32 v32, v16, s58, -v51
  v_fma_f32 v33, v17, s58, -v51
  v_fma_f32 v34, v18, s58, -v51
  v_fma_f32 v35, v19, s58, -v51
  v_fma_f32 v36, v20, s58, -v51
  v_fma_f32 v37, v21, s58, -v51
  v_fma_f32 v38, v22, s58, -v51
  v_fma_f32 v39, v23, s58, -v51
  v_exp_f32 v52, v52
  v_exp_f32 v32, v32
  v_exp_f32 v33, v33
  v_exp_f32 v34, v34
  v_exp_f32 v35, v35
  v_exp_f32 v36, v36
  v_exp_f32 v37, v37
  v_exp_f32 v38, v38
  v_exp_f32 v39, v39
  v_mov_b32 v48, v50
  v_fma_f32 v49, v49, v52, v32
  v_add_f32 v51, v33, v34
  v_add_f32 v50, v35, v36
  v_mul_f32 v28, v28, v52
  v_mul_f32 v29, v29, v52
  v_mul_f32 v30, v30, v52
  v_mul_f32 v31, v31, v52
  v_add_f32 v51, v51, v37
  v_add_f32 v50, v50, v38
  v_add_f32 v49, v49, v39
  v_add_f32 v51, v51, v50
  v_add_f32 v49, v49, v51
  s_waitcnt vmcnt(4)
  v_cvt_pk_bf16_f32 v50, v32, v32
  v_and_b32 v40, v50, v5
  v_and_b32 v41, v50, v6
  v_and_b32 v42, v50, v7
  v_and_b32 v43, v50, v8
  s_nop 1
  v_mfma_f32_16x16x32_bf16 v[28:31], v[128:131], v[40:43], v[28:31]
  v_cvt_pk_bf16_f32 v50, v33, v33
  v_and_b32 v44, v50, v5
  v_and_b32 v45, v50, v6
  v_and_b32 v46, v50, v7
  v_and_b32 v47, v50, v8
  s_nop 1
  v_mfma_f32_16x16x32_bf16 v[28:31], v[132:135], v[44:47], v[28:31]
  v_cvt_pk_bf16_f32 v50, v34, v34
  v_and_b32 v40, v50, v5
  v_and_b32 v41, v50, v6
  v_and_b32 v42, v50, v7
  v_and_b32 v43, v50, v8
  s_nop 1
  v_mfma_f32_16x16x32_bf16 v[28:31], v[136:139], v[40:43], v[28:31]
  v_cvt_pk_bf16_f32 v50, v35, v35
  v_and_b32 v44, v50, v5
  v_and_b32 v45, v50, v6
  v_and_b32 v46, v50, v7
  v_and_b32 v47, v50, v8
  s_nop 1
  v_mfma_f32_16x16x32_bf16 v[28:31], v[140:143], v[44:47], v[28:31]
  s_waitcnt vmcnt(0)
  v_cvt_pk_bf16_f32 v50, v36, v36
  v_and_b32 v40, v50, v5
  v_and_b32 v41, v50, v6
  v_and_b32 v42, v50, v7
  v_and_b32 v43, v50, v8
  s_nop 1
  v_mfma_f32_16x16x32_bf16 v[28:31], v[144:147], v[40:43], v[28:31]
  v_cvt_pk_bf16_f32 v50, v37, v37
  v_and_b32 v44, v50, v5
  v_and_b32 v45, v50, v6
  v_and_b32 v46, v50, v7
  v_and_b32 v47, v50, v8
  s_nop 1
  v_mfma_f32_16x16x32_bf16 v[28:31], v[148:151], v[44:47], v[28:31]
  v_cvt_pk_bf16_f32 v50, v38, v38
  v_and_b32 v40, v50, v5
  v_and_b32 v41, v50, v6
  v_and_b32 v42, v50, v7
  v_and_b32 v43, v50, v8
  s_nop 1
  v_mfma_f32_16x16x32_bf16 v[28:31], v[152:155], v[40:43], v[28:31]
  v_cvt_pk_bf16_f32 v50, v39, v39
  v_and_b32 v44, v50, v5
  v_and_b32 v45, v50, v6
  v_and_b32 v46, v50, v7
  v_and_b32 v47, v50, v8
  s_nop 1
  v_mfma_f32_16x16x32_bf16 v[28:31], v[156:159], v[44:47], v[28:31]
  s_branch L_ei_48
L_ism_47:
  s_waitcnt vmcnt(4)
  v_mfma_f32_16x16x32_bf16 v[32:35], v[128:131], v[224:227], 0
  v_mfma_f32_16x16x32_bf16 v[32:35], v[132:135], v[228:231], v[32:35]
  v_mfma_f32_16x16x32_bf16 v[32:35], v[136:139], v[232:235], v[32:35]
  v_mfma_f32_16x16x32_bf16 v[32:35], v[140:143], v[236:239], v[32:35]
  s_nop 7
  v_max_f32 v50, v32, v33
  v_max3_f32 v50, v34, v35, v50
  v_mov_b32 v51, v50
  s_nop 1
  v_permlane16_swap_b32 v50, v51
  v_max_f32 v50, v50, v51
  v_mov_b32 v51, v50
  s_nop 1
  v_permlane32_swap_b32 v50, v51
  v_max3_f32 v50, v50, v51, v48
  v_mul_f32 v51, s58, v50
  v_fma_f32 v52, v48, s58, -v51
  v_fma_f32 v36, v32, s58, -v51
  v_fma_f32 v37, v33, s58, -v51
  v_fma_f32 v38, v34, s58, -v51
  v_fma_f32 v39, v35, s58, -v51
  v_exp_f32 v52, v52
  v_exp_f32 v36, v36
  v_exp_f32 v37, v37
  v_exp_f32 v38, v38
  v_exp_f32 v39, v39
  v_mov_b32 v48, v50
  v_fma_f32 v49, v49, v52, v36
  v_add_f32 v51, v37, v38
  v_mul_f32 v28, v28, v52
  v_mul_f32 v29, v29, v52
  v_mul_f32 v30, v30, v52
  v_mul_f32 v31, v31, v52
  v_add_f32 v49, v49, v39
  v_add_f32 v49, v49, v51
  s_waitcnt vmcnt(0)
  v_cvt_pk_bf16_f32 v50, v36, v36
  v_and_b32 v40, v50, v5
  v_and_b32 v41, v50, v6
  v_and_b32 v42, v50, v7
  v_and_b32 v43, v50, v8
  s_nop 1
  v_mfma_f32_16x16x32_bf16 v[28:31], v[144:147], v[40:43], v[28:31]
  v_cvt_pk_bf16_f32 v50, v37, v37
  v_and_b32 v44, v50, v5
  v_and_b32 v45, v50, v6
  v_and_b32 v46, v50, v7
  v_and_b32 v47, v50, v8
  s_nop 1
  v_mfma_f32_16x16x32_bf16 v[28:31], v[148:151], v[44:47], v[28:31]
  v_cvt_pk_bf16_f32 v50, v38, v38
  v_and_b32 v40, v50, v5
  v_and_b32 v41, v50, v6
  v_and_b32 v42, v50, v7
  v_and_b32 v43, v50, v8
  s_nop 1
  v_mfma_f32_16x16x32_bf16 v[28:31], v[152:155], v[40:43], v[28:31]
  v_cvt_pk_bf16_f32 v50, v39, v39
  v_and_b32 v44, v50, v5
  v_and_b32 v45, v50, v6
  v_and_b32 v46, v50, v7
  v_and_b32 v47, v50, v8
  s_nop 1
  v_mfma_f32_16x16x32_bf16 v[28:31], v[156:159], v[44:47], v[28:31]
L_ei_48:
  s_nop 3
L_sdone:
  v_mov_b32 v50, v49
  s_nop 1
  v_permlane16_swap_b32 v49, v50
  v_add_f32 v49, v49, v50
  v_mov_b32 v50, v49
  s_nop 1
  v_permlane32_swap_b32 v49, v50
  v_add_f32 v49, v49, v50
  v_and_b32 v51, 7, v1
  v_lshl_add_u32 v51, v2, 5, v51
  v_lshlrev_b32 v51, 2, v51
  s_lshl_b32 s65, s3, 9
  v_add_u32 v51, s65, v51
  s_lshl_b32 s65, s3, 3
  v_mov_b32 v52, s65
  ds_write_b32 v51, v28 offset:6144
  ds_write_b32 v51, v29 offset:6176
  ds_write_b32 v51, v30 offset:6208
  ds_write_b32 v51, v31 offset:6240
  ds_write_b64 v52, v[48:49] offset:10240
  s_waitcnt lgkmcnt(0)
  s_barrier
  s_cmp_eq_u32 s3, 0
  s_cbranch_scc1 L_btail
  s_endpgm
L_btail:
  s_setprio 3
  s_cmp_eq_u32 s101, 0
  s_cbranch_scc1 L_s_nowo3
  s_mov_b32 s12, s50
  s_mov_b32 s13, s51
  s_mov_b32 s14, 0x400000
  s_mov_b32 s15, 0x00020000
  v_lshlrev_b32 v51, 14, v2
  v_lshl_add_u32 v51, v1, 4, v51
  s_lshl_b32 s65, s60, 17
  s_lshr_b32 s66, s61, 2
  s_lshl_b32 s66, s66, 16
  s_add_u32 s65, s65, s66
  s_and_b32 s66, s61, 3
  s_lshl_b32 s66, s66, 8
  s_add_u32 s65, s65, s66
  buffer_load_dwordx4 v[192:195], v51, s[12:15], s65 offen offset:0 nt
  buffer_load_dwordx4 v[196:199], v51, s[12:15], s65 offen offset:1024 nt
  buffer_load_dwordx4 v[200:203], v51, s[12:15], s65 offen offset:2048 nt
  buffer_load_dwordx4 v[204:207], v51, s[12:15], s65 offen offset:3072 nt
  s_add_u32 s65, s65, 4096
  buffer_load_dwordx4 v[208:211], v51, s[12:15], s65 offen offset:0 nt
  buffer_load_dwordx4 v[212:215], v51, s[12:15], s65 offen offset:1024 nt
  buffer_load_dwordx4 v[216:219], v51, s[12:15], s65 offen offset:2048 nt
  buffer_load_dwordx4 v[220:223], v51, s[12:15], s65 offen offset:3072 nt
  s_add_u32 s65, s65, 4096
  buffer_load_dwordx4 v[224:227], v51, s[12:15], s65 offen offset:0 nt
  buffer_load_dwordx4 v[228:231], v51, s[12:15], s65 offen offset:1024 nt
  buffer_load_dwordx4 v[232:235], v51, s[12:15], s65 offen offset:2048 nt
  buffer_load_dwordx4 v[236:239], v51, s[12:15], s65 offen offset:3072 nt
  s_add_u32 s65, s65, 4096
  buffer_load_dwordx4 v[240:243], v51, s[12:15], s65 offen offset:0 nt
  buffer_load_dwordx4 v[244:247], v51, s[12:15], s65 offen offset:1024 nt
  buffer_load_dwordx4 v[248:251], v51, s[12:15], s65 offen offset:2048 nt
  buffer_load_dwordx4 v[252:255], v51, s[12:15], s65 offen offset:3072 nt
L_s_nowo3:
  v_mov_b32 v51, 0
  ds_read_b32 v50, v51 offset:10312
  s_add_u32 s59, s60, 32
  s_mov_b32 s28, s52
  s_mov_b32 s29, s53
  s_mov_b32 s30, 0x800
  s_mov_b32 s31, 0x00020000
  v_and_b32 v12, 7, v0
  v_lshlrev_b32 v12, 4, v12
  v_lshlrev_b32 v13, 3, v0
  v_lshlrev_b32 v14, 4, v1
  v_lshl_add_u32 v14, v2, 14, v14
  v_lshlrev_b32 v15, 4, v0
  v_and_b32 v16, 7, v1
  v_lshrrev_b32 v52, 3, v1
  v_lshl_add_u32 v16, v52, 4, v16
  v_lshlrev_b32 v16, 1, v16
  s_lshl_b32 s86, s59, 7
  s_add_u32 s86, s86, 131072
  s_lshl_b32 s84, s59, 13
  s_lshr_b32 s66, s61, 2
  s_lshl_b32 s66, s66, 9
  s_add_u32 s84, s84, s66
  s_add_u32 s84, s84, 1048576
  s_add_u32 s85, s84, 4096
  s_lshr_b32 s67, s59, 5
  s_lshl_b32 s87, s67, 18
  s_add_u32 s87, s87, 2097152
  s_mov_b32 s88, s87
  s_and_b32 s65, s61, 3
  s_lshl_b32 s65, s65, 16
  s_add_u32 s87, s87, s65
  s_lshl_b32 s65, s60, 1
  s_lshr_b32 s66, s61, 2
  s_add_u32 s65, s65, s66
  s_lshl_b32 s65, s65, 8
  s_add_u32 s87, s87, s65
  s_lshr_b32 s68, s2, 4
  s_lshl_b32 s65, s68, 14
  s_add_u32 s88, s88, s65
  s_lshl_b32 s89, s68, 6
  s_lshl_b32 s65, s67, 10
  s_add_u32 s89, s89, s65
  s_and_b32 s65, s68, 7
  s_lshl_b32 s66, s67, 3
  s_add_u32 s65, s65, s66
  s_and_b32 s66, s2, 15
  s_cmp_eq_u32 s65, s66
  s_cselect_b32 s94, 1, 0
  s_waitcnt lgkmcnt(0)
  v_readfirstlane_b32 s69, v50
  s_branch L_tail
L_s_prod:
  s_setprio 2
  s_cmp_lt_u32 s61, 2
  s_cselect_b32 s12, s38, s48
  s_cselect_b32 s13, s39, s49
  s_mov_b32 s14, 0x400000
  s_mov_b32 s15, 0x00020000
  s_cselect_b32 s20, s32, s42
  s_cselect_b32 s21, s33, s43
  s_mov_b32 s22, 1024
  s_mov_b32 s23, 0x00020000
  v_lshrrev_b32 v9, 3, v1
  v_lshl_add_u32 v9, v2, 1, v9
  v_lshlrev_b32 v10, 4, v9
  v_lshlrev_b32 v9, 16, v9
  v_and_b32 v11, 7, v1
  v_lshl_add_u32 v9, v11, 4, v9
  s_mul_i32 s66, s3, 256
  buffer_load_dwordx4 v[56:59], v10, s[20:23], s66 offen offset:0
  buffer_load_dwordx4 v[60:63], v10, s[20:23], s66 offen offset:128
  s_mul_i32 s65, s3, 1048576
  s_lshl_b32 s66, s60, 8
  s_add_u32 s65, s65, s66
  s_and_b32 s66, s61, 1
  s_lshl_b32 s66, s66, 7
  s_add_u32 s65, s65, s66
  buffer_load_dwordx4 v[192:195], v9, s[12:15], s65 offen nt
  s_add_u32 s65, s65, 8192
  buffer_load_dwordx4 v[196:199], v9, s[12:15], s65 offen nt
  s_add_u32 s65, s65, 8192
  buffer_load_dwordx4 v[200:203], v9, s[12:15], s65 offen nt
  s_add_u32 s65, s65, 8192
  buffer_load_dwordx4 v[204:207], v9, s[12:15], s65 offen nt
  s_add_u32 s65, s65, 8192
  buffer_load_dwordx4 v[208:211], v9, s[12:15], s65 offen nt
  s_add_u32 s65, s65, 8192
  buffer_load_dwordx4 v[212:215], v9, s[12:15], s65 offen nt
  s_add_u32 s65, s65, 8192
  buffer_load_dwordx4 v[216:219], v9, s[12:15], s65 offen nt
  s_add_u32 s65, s65, 8192
  buffer_load_dwordx4 v[220:223], v9, s[12:15], s65 offen nt
  s_add_u32 s65, s65, 466944
  buffer_load_dwordx4 v[224:227], v9, s[12:15], s65 offen nt
  s_add_u32 s65, s65, 8192
  buffer_load_dwordx4 v[228:231], v9, s[12:15], s65 offen nt
  s_add_u32 s65, s65, 8192
  buffer_load_dwordx4 v[232:235], v9, s[12:15], s65 offen nt
  s_add_u32 s65, s65, 8192
  buffer_load_dwordx4 v[236:239], v9, s[12:15], s65 offen nt
  s_add_u32 s65, s65, 8192
  buffer_load_dwordx4 v[240:243], v9, s[12:15], s65 offen nt
  s_add_u32 s65, s65, 8192
  buffer_load_dwordx4 v[244:247], v9, s[12:15], s65 offen nt
  s_add_u32 s65, s65, 8192
  buffer_load_dwordx4 v[248:251], v9, s[12:15], s65 offen nt
  s_add_u32 s65, s65, 8192
  buffer_load_dwordx4 v[252:255], v9, s[12:15], s65 offen nt
  v_and_b32 v50, 1, v1
  v_mov_b32 v51, 0xffff
  v_lshlrev_b32 v50, 4, v50
  v_lshlrev_b32 v51, v50, v51
  v_bfe_u32 v50, v1, 1, 2
  v_cmp_eq_u32 vcc, 0, v50
  s_nop 1
  v_cndmask_b32 v5, 0, v51, vcc
  v_cmp_eq_u32 vcc, 1, v50
  s_nop 1
  v_cndmask_b32 v6, 0, v51, vcc
  v_cmp_eq_u32 vcc, 2, v50
  s_nop 1
  v_cndmask_b32 v7, 0, v51, vcc
  v_cmp_eq_u32 vcc, 3, v50
  s_nop 1
  v_cndmask_b32 v8, 0, v51, vcc
  v_cmp_lt_u32 s[72:73], 7, v1
  s_mov_b32 s58, 0x3e0293ee
  s_mov_b32 s70, 0x01000100
  s_mov_b32 s71, 0x03020302
  s_waitcnt vmcnt(0)
  v_perm_b32 v50, v56, v56, s70
  v_and_b32 v40, v50, v5
  v_and_b32 v41, v50, v6
  v_and_b32 v42, v50, v7
  v_and_b32 v43, v50, v8
  s_nop 1
  v_mfma_f32_16x16x32_bf16 v[32:35], v[192:195], v[40:43], 0
  v_perm_b32 v50, v56, v56, s71
  v_and_b32 v44, v50, v5
  v_and_b32 v45, v50, v6
  v_and_b32 v46, v50, v7
  v_and_b32 v47, v50, v8
  s_nop 1
  v_mfma_f32_16x16x32_bf16 v[32:35], v[196:199], v[44:47], v[32:35]
  v_perm_b32 v50, v57, v57, s70
  v_and_b32 v40, v50, v5
  v_and_b32 v41, v50, v6
  v_and_b32 v42, v50, v7
  v_and_b32 v43, v50, v8
  s_nop 1
  v_mfma_f32_16x16x32_bf16 v[32:35], v[200:203], v[40:43], v[32:35]
  v_perm_b32 v50, v57, v57, s71
  v_and_b32 v44, v50, v5
  v_and_b32 v45, v50, v6
  v_and_b32 v46, v50, v7
  v_and_b32 v47, v50, v8
  s_nop 1
  v_mfma_f32_16x16x32_bf16 v[32:35], v[204:207], v[44:47], v[32:35]
  v_perm_b32 v50, v58, v58, s70
  v_and_b32 v40, v50, v5
  v_and_b32 v41, v50, v6
  v_and_b32 v42, v50, v7
  v_and_b32 v43, v50, v8
  s_nop 1
  v_mfma_f32_16x16x32_bf16 v[32:35], v[208:211], v[40:43], v[32:35]
  v_perm_b32 v50, v58, v58, s71
  v_and_b32 v44, v50, v5
  v_and_b32 v45, v50, v6
  v_and_b32 v46, v50, v7
  v_and_b32 v47, v50, v8
  s_nop 1
  v_mfma_f32_16x16x32_bf16 v[32:35], v[212:215], v[44:47], v[32:35]
  v_perm_b32 v50, v59, v59, s70
  v_and_b32 v40, v50, v5
  v_and_b32 v41, v50, v6
  v_and_b32 v42, v50, v7
  v_and_b32 v43, v50, v8
  s_nop 1
  v_mfma_f32_16x16x32_bf16 v[32:35], v[216:219], v[40:43], v[32:35]
  v_perm_b32 v50, v59, v59, s71
  v_and_b32 v44, v50, v5
  v_and_b32 v45, v50, v6
  v_and_b32 v46, v50, v7
  v_and_b32 v47, v50, v8
  s_nop 1
  v_mfma_f32_16x16x32_bf16 v[32:35], v[220:223], v[44:47], v[32:35]
  v_perm_b32 v50, v60, v60, s70
  v_and_b32 v40, v50, v5
  v_and_b32 v41, v50, v6
  v_and_b32 v42, v50, v7
  v_and_b32 v43, v50, v8
  s_nop 1
  v_mfma_f32_16x16x32_bf16 v[32:35], v[224:227], v[40:43], v[32:35]
  v_perm_b32 v50, v60, v60, s71
  v_and_b32 v44, v50, v5
  v_and_b32 v45, v50, v6
  v_and_b32 v46, v50, v7
  v_and_b32 v47, v50, v8
  s_nop 1
  v_mfma_f32_16x16x32_bf16 v[32:35], v[228:231], v[44:47], v[32:35]
  v_perm_b32 v50, v61, v61, s70
  v_and_b32 v40, v50, v5
  v_and_b32 v41, v50, v6
  v_and_b32 v42, v50, v7
  v_and_b32 v43, v50, v8
  s_nop 1
  v_mfma_f32_16x16x32_bf16 v[32:35], v[232:235], v[40:43], v[32:35]
  v_perm_b32 v50, v61, v61, s71
  v_and_b32 v44, v50, v5
  v_and_b32 v45, v50, v6
  v_and_b32 v46, v50, v7
  v_and_b32 v47, v50, v8
  s_nop 1
  v_mfma_f32_16x16x32_bf16 v[32:35], v[236:239], v[44:47], v[32:35]
  v_perm_b32 v50, v62, v62, s70
  v_and_b32 v40, v50, v5
  v_and_b32 v41, v50, v6
  v_and_b32 v42, v50, v7
  v_and_b32 v43, v50, v8
  s_nop 1
  v_mfma_f32_16x16x32_bf16 v[32:35], v[240:243], v[40:43], v[32:35]
  v_perm_b32 v50, v62, v62, s71
  v_and_b32 v44, v50, v5
  v_and_b32 v45, v50, v6
  v_and_b32 v46, v50, v7
  v_and_b32 v47, v50, v8
  s_nop 1
  v_mfma_f32_16x16x32_bf16 v[32:35], v[244:247], v[44:47], v[32:35]
  v_perm_b32 v50, v63, v63, s70
  v_and_b32 v40, v50, v5
  v_and_b32 v41, v50, v6
  v_and_b32 v42, v50, v7
  v_and_b32 v43, v50, v8
  s_nop 1
  v_mfma_f32_16x16x32_bf16 v[32:35], v[248:251], v[40:43], v[32:35]
  v_perm_b32 v50, v63, v63, s71
  v_and_b32 v44, v50, v5
  v_and_b32 v45, v50, v6
  v_and_b32 v46, v50, v7
  v_and_b32 v47, v50, v8
  s_nop 1
  v_mfma_f32_16x16x32_bf16 v[32:35], v[252:255], v[44:47], v[32:35]
  v_and_b32 v51, 7, v1
  v_lshl_add_u32 v51, v2, 5, v51
  v_lshlrev_b32 v51, 2, v51
  s_lshl_b32 s65, s3, 9
  v_add_u32 v51, s65, v51
  s_mov_b32 exec_lo, 0x00ff00ff
  s_mov_b32 exec_hi, 0xff00ff00
  s_nop 3
  ds_write_b32 v51, v32 offset:0
  ds_write_b32 v51, v33 offset:32
  ds_write_b32 v51, v34 offset:64
  ds_write_b32 v51, v35 offset:96
  s_mov_b64 exec, -1
  s_waitcnt lgkmcnt(0)
  s_barrier
  s_setprio 0
  v_lshlrev_b32 v62, 4, v0
  s_add_u32 s89, s62, 4096
  buffer_load_dwordx2 v[64:65], v62, s[4:7], s62 offen offset:0 nt
  buffer_load_dwordx2 v[66:67], v62, s[4:7], s62 offen offset:8 nt
  buffer_load_dwordx2 v[68:69], v62, s[4:7], s62 offen offset:1024 nt
  buffer_load_dwordx2 v[70:71], v62, s[4:7], s62 offen offset:1032 nt
  buffer_load_dwordx2 v[72:73], v62, s[4:7], s62 offen offset:2048 nt
  buffer_load_dwordx2 v[74:75], v62, s[4:7], s62 offen offset:2056 nt
  buffer_load_dwordx2 v[76:77], v62, s[4:7], s62 offen offset:3072 nt
  buffer_load_dwordx2 v[78:79], v62, s[4:7], s62 offen offset:3080 nt
  buffer_load_dwordx4 v[80:83], v62, s[4:7], s89 offen offset:0 nt
  buffer_load_dwordx4 v[84:87], v62, s[4:7], s89 offen offset:1024 nt
  buffer_load_dwordx4 v[88:91], v62, s[4:7], s89 offen offset:2048 nt
  buffer_load_dwordx4 v[92:95], v62, s[4:7], s89 offen offset:3072 nt
  s_add_u32 s62, s62, 32768
  s_add_u32 s89, s62, 4096
  buffer_load_dwordx2 v[96:97], v62, s[4:7], s62 offen offset:0 nt
  buffer_load_dwordx2 v[98:99], v62, s[4:7], s62 offen offset:8 nt
  buffer_load_dwordx2 v[100:101], v62, s[4:7], s62 offen offset:1024 nt
  buffer_load_dwordx2 v[102:103], v62, s[4:7], s62 offen offset:1032 nt
  buffer_load_dwordx2 v[104:105], v62, s[4:7], s62 offen offset:2048 nt
  buffer_load_dwordx2 v[106:107], v62, s[4:7], s62 offen offset:2056 nt
  buffer_load_dwordx2 v[108:109], v62, s[4:7], s62 offen offset:3072 nt
  buffer_load_dwordx2 v[110:111], v62, s[4:7], s62 offen offset:3080 nt
  buffer_load_dwordx4 v[112:115], v62, s[4:7], s89 offen offset:0 nt
  buffer_load_dwordx4 v[116:119], v62, s[4:7], s89 offen offset:1024 nt
  buffer_load_dwordx4 v[120:123], v62, s[4:7], s89 offen offset:2048 nt
  buffer_load_dwordx4 v[124:127], v62, s[4:7], s89 offen offset:3072 nt
  s_add_u32 s62, s62, 32768
  s_add_u32 s89, s62, 4096
  buffer_load_dwordx2 v[128:129], v62, s[4:7], s62 offen offset:0 nt
  buffer_load_dwordx2 v[130:131], v62, s[4:7], s62 offen offset:8 nt
  buffer_load_dwordx2 v[132:133], v62, s[4:7], s62 offen offset:1024 nt
  buffer_load_dwordx2 v[134:135], v62, s[4:7], s62 offen offset:1032 nt
  buffer_load_dwordx2 v[136:137], v62, s[4:7], s62 offen offset:2048 nt
  buffer_load_dwordx2 v[138:139], v62, s[4:7], s62 offen offset:2056 nt
  buffer_load_dwordx2 v[140:141], v62, s[4:7], s62 offen offset:3072 nt
  buffer_load_dwordx2 v[142:143], v62, s[4:7], s62 offen offset:3080 nt
  buffer_load_dwordx4 v[144:147], v62, s[4:7], s89 offen offset:0 nt
  buffer_load_dwordx4 v[148:151], v62, s[4:7], s89 offen offset:1024 nt
  buffer_load_dwordx4 v[152:155], v62, s[4:7], s89 offen offset:2048 nt
  buffer_load_dwordx4 v[156:159], v62, s[4:7], s89 offen offset:3072 nt
  s_add_u32 s62, s62, 32768
  s_add_u32 s89, s62, 4096
  buffer_load_dwordx2 v[160:161], v62, s[4:7], s62 offen offset:0 nt
  buffer_load_dwordx2 v[162:163], v62, s[4:7], s62 offen offset:8 nt
  buffer_load_dwordx2 v[164:165], v62, s[4:7], s62 offen offset:1024 nt
  buffer_load_dwordx2 v[166:167], v62, s[4:7], s62 offen offset:1032 nt
  buffer_load_dwordx2 v[168:169], v62, s[4:7], s62 offen offset:2048 nt
  buffer_load_dwordx2 v[170:171], v62, s[4:7], s62 offen offset:2056 nt
  buffer_load_dwordx2 v[172:173], v62, s[4:7], s62 offen offset:3072 nt
  buffer_load_dwordx2 v[174:175], v62, s[4:7], s62 offen offset:3080 nt
  buffer_load_dwordx4 v[176:179], v62, s[4:7], s89 offen offset:0 nt
  buffer_load_dwordx4 v[180:183], v62, s[4:7], s89 offen offset:1024 nt
  buffer_load_dwordx4 v[184:187], v62, s[4:7], s89 offen offset:2048 nt
  buffer_load_dwordx4 v[188:191], v62, s[4:7], s89 offen offset:3072 nt
  s_add_u32 s62, s62, 32768
  s_branch L_s_join
L_s_bwg:
  s_mov_b32 s84, s62
  s_mov_b32 s4, s44
  s_mov_b32 s5, s45
  s_mov_b32 s6, 0x4000000
  s_mov_b32 s7, 0x00020000
  s_mov_b32 s8, s46
  s_mov_b32 s9, s47
  s_mov_b32 s10, 0x4000000
  s_mov_b32 s11, 0x00020000
  s_lshl_b32 s65, s60, 1
  s_add_u32 s65, s65, s61
  s_sub_u32 s65, s65, 6
  s_lshr_b32 s66, s65, 3
  s_and_b32 s98, s65, 7
  s_lshl_b32 s97, s66, 23
  s_add_u32 s97, s97, 7340032
  s_lshl_b32 s67, s98, 12
  s_add_u32 s97, s97, s67
  s_mul_i32 s99, s65, 5
  s_add_u32 s99, s99, s3
  s_and_b32 s62, s99, 31
  s_lshl_b32 s62, s62, 15
  s_add_u32 s62, s62, s97
  s_add_u32 s99, s99, 4
  buffer_load_dwordx4 v[64:67], v3, s[4:7], s62 offen offset:0 nt
  buffer_load_dwordx4 v[68:71], v3, s[4:7], s62 offen offset:64 nt
  buffer_load_dwordx4 v[72:75], v3, s[4:7], s62 offen offset:128 nt
  buffer_load_dwordx4 v[76:79], v3, s[4:7], s62 offen offset:192 nt
  buffer_load_dwordx4 v[80:83], v4, s[8:11], s62 offen offset:0 nt
  buffer_load_dwordx4 v[84:87], v4, s[8:11], s62 offen offset:256 nt
  buffer_load_dwordx4 v[88:91], v4, s[8:11], s62 offen offset:512 nt
  buffer_load_dwordx4 v[92:95], v4, s[8:11], s62 offen offset:768 nt
  s_and_b32 s62, s99, 31
  s_lshl_b32 s62, s62, 15
  s_add_u32 s62, s62, s97
  s_add_u32 s99, s99, 4
  buffer_load_dwordx4 v[96:99], v3, s[4:7], s62 offen offset:0 nt
  buffer_load_dwordx4 v[100:103], v3, s[4:7], s62 offen offset:64 nt
  buffer_load_dwordx4 v[104:107], v3, s[4:7], s62 offen offset:128 nt
  buffer_load_dwordx4 v[108:111], v3, s[4:7], s62 offen offset:192 nt
  buffer_load_dwordx4 v[112:115], v4, s[8:11], s62 offen offset:0 nt
  buffer_load_dwordx4 v[116:119], v4, s[8:11], s62 offen offset:256 nt
  buffer_load_dwordx4 v[120:123], v4, s[8:11], s62 offen offset:512 nt
  buffer_load_dwordx4 v[124:127], v4, s[8:11], s62 offen offset:768 nt
  s_and_b32 s62, s99, 31
  s_lshl_b32 s62, s62, 15
  s_add_u32 s62, s62, s97
  s_add_u32 s99, s99, 4
  buffer_load_dwordx4 v[128:131], v3, s[4:7], s62 offen offset:0 nt
  buffer_load_dwordx4 v[132:135], v3, s[4:7], s62 offen offset:64 nt
  buffer_load_dwordx4 v[136:139], v3, s[4:7], s62 offen offset:128 nt
  buffer_load_dwordx4 v[140:143], v3, s[4:7], s62 offen offset:192 nt
  buffer_load_dwordx4 v[144:147], v4, s[8:11], s62 offen offset:0 nt
  buffer_load_dwordx4 v[148:151], v4, s[8:11], s62 offen offset:256 nt
  buffer_load_dwordx4 v[152:155], v4, s[8:11], s62 offen offset:512 nt
  buffer_load_dwordx4 v[156:159], v4, s[8:11], s62 offen offset:768 nt
  s_and_b32 s62, s99, 31
  s_lshl_b32 s62, s62, 15
  s_add_u32 s62, s62, s97
  s_add_u32 s99, s99, 4
  buffer_load_dwordx4 v[160:163], v3, s[4:7], s62 offen offset:0 nt
  buffer_load_dwordx4 v[164:167], v3, s[4:7], s62 offen offset:64 nt
  buffer_load_dwordx4 v[168:171], v3, s[4:7], s62 offen offset:128 nt
  buffer_load_dwordx4 v[172:175], v3, s[4:7], s62 offen offset:192 nt
  buffer_load_dwordx4 v[176:179], v4, s[8:11], s62 offen offset:0 nt
  buffer_load_dwordx4 v[180:183], v4, s[8:11], s62 offen offset:256 nt
  buffer_load_dwordx4 v[184:187], v4, s[8:11], s62 offen offset:512 nt
  buffer_load_dwordx4 v[188:191], v4, s[8:11], s62 offen offset:768 nt
  v_and_b32 v50, 1, v1
  v_mov_b32 v51, 0xffff
  v_lshlrev_b32 v50, 4, v50
  v_lshlrev_b32 v51, v50, v51
  v_bfe_u32 v50, v1, 1, 2
  v_cmp_eq_u32 vcc, 0, v50
  s_nop 1
  v_cndmask_b32 v5, 0, v51, vcc
  v_cmp_eq_u32 vcc, 1, v50
  s_nop 1
  v_cndmask_b32 v6, 0, v51, vcc
  v_cmp_eq_u32 vcc, 2, v50
  s_nop 1
  v_cndmask_b32 v7, 0, v51, vcc
  v_cmp_eq_u32 vcc, 3, v50
  s_nop 1
  v_cndmask_b32 v8, 0, v51, vcc
  v_cmp_lt_u32 s[72:73], 7, v1
  s_mov_b32 s58, 0x3e0293ee
  s_mov_b32 s70, 0x01000100
  s_mov_b32 s71, 0x03020302
  v_mov_b32 v48, 0xff800000
  v_mov_b32 v49, 0
  v_mov_b32 v28, 0
  v_mov_b32 v29, 0
  v_mov_b32 v30, 0
  v_mov_b32 v31, 0
  v_mov_b32 v220, 0xff800000
  v_mov_b32 v221, 0
  v_mov_b32 v208, 0
  v_mov_b32 v209, 0
  v_mov_b32 v210, 0
  v_mov_b32 v211, 0
  v_lshrrev_b32 v53, 3, v1
  v_lshlrev_b32 v53, 8, v53
  v_lshl_add_u32 v53, v2, 4, v53
  s_barrier
  ds_read_b128 v[12:15], v53 offset:4352
  ds_read_b128 v[16:19], v53 offset:4416
  ds_read_b128 v[20:23], v53 offset:4480
  ds_read_b128 v[24:27], v53 offset:4544
  ds_read_b128 v[192:195], v53 offset:4864
  ds_read_b128 v[196:199], v53 offset:4928
  ds_read_b128 v[200:203], v53 offset:4992
  ds_read_b128 v[204:207], v53 offset:5056
  s_waitcnt lgkmcnt(0)
  s_waitcnt vmcnt(28)
  v_mfma_f32_16x16x32_bf16 v[32:35], v[64:67], v[12:15], 0
  v_mfma_f32_16x16x32_bf16 v[32:35], v[68:71], v[16:19], v[32:35]
  v_mfma_f32_16x16x32_bf16 v[32:35], v[72:75], v[20:23], v[32:35]
  v_mfma_f32_16x16x32_bf16 v[32:35], v[76:79], v[24:27], v[32:35]
  v_mfma_f32_16x16x32_bf16 v[212:215], v[64:67], v[192:195], 0
  v_mfma_f32_16x16x32_bf16 v[212:215], v[68:71], v[196:199], v[212:215]
  v_mfma_f32_16x16x32_bf16 v[212:215], v[72:75], v[200:203], v[212:215]
  v_mfma_f32_16x16x32_bf16 v[212:215], v[76:79], v[204:207], v[212:215]
  s_and_b32 s62, s99, 31
  s_lshl_b32 s62, s62, 15
  s_add_u32 s62, s62, s97
  s_add_u32 s99, s99, 4
  buffer_load_dwordx4 v[64:67], v3, s[4:7], s62 offen offset:0 nt
  buffer_load_dwordx4 v[68:71], v3, s[4:7], s62 offen offset:64 nt
  buffer_load_dwordx4 v[72:75], v3, s[4:7], s62 offen offset:128 nt
  buffer_load_dwordx4 v[76:79], v3, s[4:7], s62 offen offset:192 nt
  v_max_f32 v50, v32, v33
  v_max3_f32 v50, v34, v35, v50
  v_mov_b32 v51, v50
  s_nop 1
  v_permlane16_swap_b32 v50, v51
  v_max_f32 v50, v50, v51
  v_mov_b32 v51, v50
  s_nop 1
  v_permlane32_swap_b32 v50, v51
  v_max3_f32 v50, v50, v51, v48
  v_mul_f32 v51, s58, v50
  v_fma_f32 v52, v48, s58, -v51
  v_fma_f32 v36, v32, s58, -v51
  v_fma_f32 v37, v33, s58, -v51
  v_fma_f32 v38, v34, s58, -v51
  v_fma_f32 v39, v35, s58, -v51
  v_exp_f32 v52, v52
  v_exp_f32 v36, v36
  v_exp_f32 v37, v37
  v_exp_f32 v38, v38
  v_exp_f32 v39, v39
  v_mov_b32 v48, v50
  v_fma_f32 v49, v49, v52, v36
  v_add_f32 v51, v37, v38
  v_mul_f32 v28, v28, v52
  v_mul_f32 v29, v29, v52
  v_mul_f32 v30, v30, v52
  v_mul_f32 v31, v31, v52
  v_add_f32 v49, v49, v39
  v_add_f32 v49, v49, v51
  v_max_f32 v50, v212, v213
  v_max3_f32 v50, v214, v215, v50
  v_mov_b32 v51, v50
  s_nop 1
  v_permlane16_swap_b32 v50, v51
  v_max_f32 v50, v50, v51
  v_mov_b32 v51, v50
  s_nop 1
  v_permlane32_swap_b32 v50, v51
  v_max3_f32 v50, v50, v51, v220
  v_mul_f32 v51, s58, v50
  v_fma_f32 v52, v220, s58, -v51
  v_fma_f32 v216, v212, s58, -v51
  v_fma_f32 v217, v213, s58, -v51
  v_fma_f32 v218, v214, s58, -v51
  v_fma_f32 v219, v215, s58, -v51
  v_exp_f32 v52, v52
  v_exp_f32 v216, v216
  v_exp_f32 v217, v217
  v_exp_f32 v218, v218
  v_exp_f32 v219, v219
  v_mov_b32 v220, v50
  v_fma_f32 v221, v221, v52, v216
  v_add_f32 v51, v217, v218
  v_mul_f32 v208, v208, v52
  v_mul_f32 v209, v209, v52
  v_mul_f32 v210, v210, v52
  v_mul_f32 v211, v211, v52
  v_add_f32 v221, v221, v219
  v_add_f32 v221, v221, v51
  s_waitcnt vmcnt(28)
  v_cvt_pk_bf16_f32 v50, v36, v36
  v_and_b32 v40, v50, v5
  v_and_b32 v41, v50, v6
  v_and_b32 v42, v50, v7
  v_and_b32 v43, v50, v8
  s_nop 1
  v_mfma_f32_16x16x32_bf16 v[28:31], v[80:83], v[40:43], v[28:31]
  v_cvt_pk_bf16_f32 v50, v37, v37
  v_and_b32 v44, v50, v5
  v_and_b32 v45, v50, v6
  v_and_b32 v46, v50, v7
  v_and_b32 v47, v50, v8
  s_nop 1
  v_mfma_f32_16x16x32_bf16 v[28:31], v[84:87], v[44:47], v[28:31]
  v_cvt_pk_bf16_f32 v50, v38, v38
  v_and_b32 v40, v50, v5
  v_and_b32 v41, v50, v6
  v_and_b32 v42, v50, v7
  v_and_b32 v43, v50, v8
  s_nop 1
  v_mfma_f32_16x16x32_bf16 v[28:31], v[88:91], v[40:43], v[28:31]
  v_cvt_pk_bf16_f32 v50, v39, v39
  v_and_b32 v44, v50, v5
  v_and_b32 v45, v50, v6
  v_and_b32 v46, v50, v7
  v_and_b32 v47, v50, v8
  s_nop 1
  v_mfma_f32_16x16x32_bf16 v[28:31], v[92:95], v[44:47], v[28:31]
  v_cvt_pk_bf16_f32 v50, v216, v216
  v_and_b32 v40, v50, v5
  v_and_b32 v41, v50, v6
  v_and_b32 v42, v50, v7
  v_and_b32 v43, v50, v8
  s_nop 1
  v_mfma_f32_16x16x32_bf16 v[208:211], v[80:83], v[40:43], v[208:211]
  v_cvt_pk_bf16_f32 v50, v217, v217
  v_and_b32 v44, v50, v5
  v_and_b32 v45, v50, v6
  v_and_b32 v46, v50, v7
  v_and_b32 v47, v50, v8
  s_nop 1
  v_mfma_f32_16x16x32_bf16 v[208:211], v[84:87], v[44:47], v[208:211]
  v_cvt_pk_bf16_f32 v50, v218, v218
  v_and_b32 v40, v50, v5
  v_and_b32 v41, v50, v6
  v_and_b32 v42, v50, v7
  v_and_b32 v43, v50, v8
  s_nop 1
  v_mfma_f32_16x16x32_bf16 v[208:211], v[88:91], v[40:43], v[208:211]
  v_cvt_pk_bf16_f32 v50, v219, v219
  v_and_b32 v44, v50, v5
  v_and_b32 v45, v50, v6
  v_and_b32 v46, v50, v7
  v_and_b32 v47, v50, v8
  s_nop 1
  v_mfma_f32_16x16x32_bf16 v[208:211], v[92:95], v[44:47], v[208:211]
  buffer_load_dwordx4 v[80:83], v4, s[8:11], s62 offen offset:0 nt
  buffer_load_dwordx4 v[84:87], v4, s[8:11], s62 offen offset:256 nt
  buffer_load_dwordx4 v[88:91], v4, s[8:11], s62 offen offset:512 nt
  buffer_load_dwordx4 v[92:95], v4, s[8:11], s62 offen offset:768 nt
  s_waitcnt vmcnt(28)
  v_mfma_f32_16x16x32_bf16 v[32:35], v[96:99], v[12:15], 0
  v_mfma_f32_16x16x32_bf16 v[32:35], v[100:103], v[16:19], v[32:35]
  v_mfma_f32_16x16x32_bf16 v[32:35], v[104:107], v[20:23], v[32:35]
  v_mfma_f32_16x16x32_bf16 v[32:35], v[108:111], v[24:27], v[32:35]
  v_mfma_f32_16x16x32_bf16 v[212:215], v[96:99], v[192:195], 0
  v_mfma_f32_16x16x32_bf16 v[212:215], v[100:103], v[196:199], v[212:215]
  v_mfma_f32_16x16x32_bf16 v[212:215], v[104:107], v[200:203], v[212:215]
  v_mfma_f32_16x16x32_bf16 v[212:215], v[108:111], v[204:207], v[212:215]
  s_and_b32 s62, s99, 31
  s_lshl_b32 s62, s62, 15
  s_add_u32 s62, s62, s97
  s_add_u32 s99, s99, 4
  buffer_load_dwordx4 v[96:99], v3, s[4:7], s62 offen offset:0 nt
  buffer_load_dwordx4 v[100:103], v3, s[4:7], s62 offen offset:64 nt
  buffer_load_dwordx4 v[104:107], v3, s[4:7], s62 offen offset:128 nt
  buffer_load_dwordx4 v[108:111], v3, s[4:7], s62 offen offset:192 nt
  v_max_f32 v50, v32, v33
  v_max3_f32 v50, v34, v35, v50
  v_mov_b32 v51, v50
  s_nop 1
  v_permlane16_swap_b32 v50, v51
  v_max_f32 v50, v50, v51
  v_mov_b32 v51, v50
  s_nop 1
  v_permlane32_swap_b32 v50, v51
  v_max3_f32 v50, v50, v51, v48
  v_mul_f32 v51, s58, v50
  v_fma_f32 v52, v48, s58, -v51
  v_fma_f32 v36, v32, s58, -v51
  v_fma_f32 v37, v33, s58, -v51
  v_fma_f32 v38, v34, s58, -v51
  v_fma_f32 v39, v35, s58, -v51
  v_exp_f32 v52, v52
  v_exp_f32 v36, v36
  v_exp_f32 v37, v37
  v_exp_f32 v38, v38
  v_exp_f32 v39, v39
  v_mov_b32 v48, v50
  v_fma_f32 v49, v49, v52, v36
  v_add_f32 v51, v37, v38
  v_mul_f32 v28, v28, v52
  v_mul_f32 v29, v29, v52
  v_mul_f32 v30, v30, v52
  v_mul_f32 v31, v31, v52
  v_add_f32 v49, v49, v39
  v_add_f32 v49, v49, v51
  v_max_f32 v50, v212, v213
  v_max3_f32 v50, v214, v215, v50
  v_mov_b32 v51, v50
  s_nop 1
  v_permlane16_swap_b32 v50, v51
  v_max_f32 v50, v50, v51
  v_mov_b32 v51, v50
  s_nop 1
  v_permlane32_swap_b32 v50, v51
  v_max3_f32 v50, v50, v51, v220
  v_mul_f32 v51, s58, v50
  v_fma_f32 v52, v220, s58, -v51
  v_fma_f32 v216, v212, s58, -v51
  v_fma_f32 v217, v213, s58, -v51
  v_fma_f32 v218, v214, s58, -v51
  v_fma_f32 v219, v215, s58, -v51
  v_exp_f32 v52, v52
  v_exp_f32 v216, v216
  v_exp_f32 v217, v217
  v_exp_f32 v218, v218
  v_exp_f32 v219, v219
  v_mov_b32 v220, v50
  v_fma_f32 v221, v221, v52, v216
  v_add_f32 v51, v217, v218
  v_mul_f32 v208, v208, v52
  v_mul_f32 v209, v209, v52
  v_mul_f32 v210, v210, v52
  v_mul_f32 v211, v211, v52
  v_add_f32 v221, v221, v219
  v_add_f32 v221, v221, v51
  s_waitcnt vmcnt(28)
  v_cvt_pk_bf16_f32 v50, v36, v36
  v_and_b32 v40, v50, v5
  v_and_b32 v41, v50, v6
  v_and_b32 v42, v50, v7
  v_and_b32 v43, v50, v8
  s_nop 1
  v_mfma_f32_16x16x32_bf16 v[28:31], v[112:115], v[40:43], v[28:31]
  v_cvt_pk_bf16_f32 v50, v37, v37
  v_and_b32 v44, v50, v5
  v_and_b32 v45, v50, v6
  v_and_b32 v46, v50, v7
  v_and_b32 v47, v50, v8
  s_nop 1
  v_mfma_f32_16x16x32_bf16 v[28:31], v[116:119], v[44:47], v[28:31]
  v_cvt_pk_bf16_f32 v50, v38, v38
  v_and_b32 v40, v50, v5
  v_and_b32 v41, v50, v6
  v_and_b32 v42, v50, v7
  v_and_b32 v43, v50, v8
  s_nop 1
  v_mfma_f32_16x16x32_bf16 v[28:31], v[120:123], v[40:43], v[28:31]
  v_cvt_pk_bf16_f32 v50, v39, v39
  v_and_b32 v44, v50, v5
  v_and_b32 v45, v50, v6
  v_and_b32 v46, v50, v7
  v_and_b32 v47, v50, v8
  s_nop 1
  v_mfma_f32_16x16x32_bf16 v[28:31], v[124:127], v[44:47], v[28:31]
  v_cvt_pk_bf16_f32 v50, v216, v216
  v_and_b32 v40, v50, v5
  v_and_b32 v41, v50, v6
  v_and_b32 v42, v50, v7
  v_and_b32 v43, v50, v8
  s_nop 1
  v_mfma_f32_16x16x32_bf16 v[208:211], v[112:115], v[40:43], v[208:211]
  v_cvt_pk_bf16_f32 v50, v217, v217
  v_and_b32 v44, v50, v5
  v_and_b32 v45, v50, v6
  v_and_b32 v46, v50, v7
  v_and_b32 v47, v50, v8
  s_nop 1
  v_mfma_f32_16x16x32_bf16 v[208:211], v[116:119], v[44:47], v[208:211]
  v_cvt_pk_bf16_f32 v50, v218, v218
  v_and_b32 v40, v50, v5
  v_and_b32 v41, v50, v6
  v_and_b32 v42, v50, v7
  v_and_b32 v43, v50, v8
  s_nop 1
  v_mfma_f32_16x16x32_bf16 v[208:211], v[120:123], v[40:43], v[208:211]
  v_cvt_pk_bf16_f32 v50, v219, v219
  v_and_b32 v44, v50, v5
  v_and_b32 v45, v50, v6
  v_and_b32 v46, v50, v7
  v_and_b32 v47, v50, v8
  s_nop 1
  v_mfma_f32_16x16x32_bf16 v[208:211], v[124:127], v[44:47], v[208:211]
  buffer_load_dwordx4 v[112:115], v4, s[8:11], s62 offen offset:0 nt
  buffer_load_dwordx4 v[116:119], v4, s[8:11], s62 offen offset:256 nt
  buffer_load_dwordx4 v[120:123], v4, s[8:11], s62 offen offset:512 nt
  buffer_load_dwordx4 v[124:127], v4, s[8:11], s62 offen offset:768 nt
  s_waitcnt vmcnt(28)
  v_mfma_f32_16x16x32_bf16 v[32:35], v[128:131], v[12:15], 0
  v_mfma_f32_16x16x32_bf16 v[32:35], v[132:135], v[16:19], v[32:35]
  v_mfma_f32_16x16x32_bf16 v[32:35], v[136:139], v[20:23], v[32:35]
  v_mfma_f32_16x16x32_bf16 v[32:35], v[140:143], v[24:27], v[32:35]
  v_mfma_f32_16x16x32_bf16 v[212:215], v[128:131], v[192:195], 0
  v_mfma_f32_16x16x32_bf16 v[212:215], v[132:135], v[196:199], v[212:215]
  v_mfma_f32_16x16x32_bf16 v[212:215], v[136:139], v[200:203], v[212:215]
  v_mfma_f32_16x16x32_bf16 v[212:215], v[140:143], v[204:207], v[212:215]
  s_and_b32 s62, s99, 31
  s_lshl_b32 s62, s62, 15
  s_add_u32 s62, s62, s97
  s_add_u32 s99, s99, 4
  buffer_load_dwordx4 v[128:131], v3, s[4:7], s62 offen offset:0 nt
  buffer_load_dwordx4 v[132:135], v3, s[4:7], s62 offen offset:64 nt
  buffer_load_dwordx4 v[136:139], v3, s[4:7], s62 offen offset:128 nt
  buffer_load_dwordx4 v[140:143], v3, s[4:7], s62 offen offset:192 nt
  v_max_f32 v50, v32, v33
  v_max3_f32 v50, v34, v35, v50
  v_mov_b32 v51, v50
  s_nop 1
  v_permlane16_swap_b32 v50, v51
  v_max_f32 v50, v50, v51
  v_mov_b32 v51, v50
  s_nop 1
  v_permlane32_swap_b32 v50, v51
  v_max3_f32 v50, v50, v51, v48
  v_mul_f32 v51, s58, v50
  v_fma_f32 v52, v48, s58, -v51
  v_fma_f32 v36, v32, s58, -v51
  v_fma_f32 v37, v33, s58, -v51
  v_fma_f32 v38, v34, s58, -v51
  v_fma_f32 v39, v35, s58, -v51
  v_exp_f32 v52, v52
  v_exp_f32 v36, v36
  v_exp_f32 v37, v37
  v_exp_f32 v38, v38
  v_exp_f32 v39, v39
  v_mov_b32 v48, v50
  v_fma_f32 v49, v49, v52, v36
  v_add_f32 v51, v37, v38
  v_mul_f32 v28, v28, v52
  v_mul_f32 v29, v29, v52
  v_mul_f32 v30, v30, v52
  v_mul_f32 v31, v31, v52
  v_add_f32 v49, v49, v39
  v_add_f32 v49, v49, v51
  v_max_f32 v50, v212, v213
  v_max3_f32 v50, v214, v215, v50
  v_mov_b32 v51, v50
  s_nop 1
  v_permlane16_swap_b32 v50, v51
  v_max_f32 v50, v50, v51
  v_mov_b32 v51, v50
  s_nop 1
  v_permlane32_swap_b32 v50, v51
  v_max3_f32 v50, v50, v51, v220
  v_mul_f32 v51, s58, v50
  v_fma_f32 v52, v220, s58, -v51
  v_fma_f32 v216, v212, s58, -v51
  v_fma_f32 v217, v213, s58, -v51
  v_fma_f32 v218, v214, s58, -v51
  v_fma_f32 v219, v215, s58, -v51
  v_exp_f32 v52, v52
  v_exp_f32 v216, v216
  v_exp_f32 v217, v217
  v_exp_f32 v218, v218
  v_exp_f32 v219, v219
  v_mov_b32 v220, v50
  v_fma_f32 v221, v221, v52, v216
  v_add_f32 v51, v217, v218
  v_mul_f32 v208, v208, v52
  v_mul_f32 v209, v209, v52
  v_mul_f32 v210, v210, v52
  v_mul_f32 v211, v211, v52
  v_add_f32 v221, v221, v219
  v_add_f32 v221, v221, v51
  s_waitcnt vmcnt(28)
  v_cvt_pk_bf16_f32 v50, v36, v36
  v_and_b32 v40, v50, v5
  v_and_b32 v41, v50, v6
  v_and_b32 v42, v50, v7
  v_and_b32 v43, v50, v8
  s_nop 1
  v_mfma_f32_16x16x32_bf16 v[28:31], v[144:147], v[40:43], v[28:31]
  v_cvt_pk_bf16_f32 v50, v37, v37
  v_and_b32 v44, v50, v5
  v_and_b32 v45, v50, v6
  v_and_b32 v46, v50, v7
  v_and_b32 v47, v50, v8
  s_nop 1
  v_mfma_f32_16x16x32_bf16 v[28:31], v[148:151], v[44:47], v[28:31]
  v_cvt_pk_bf16_f32 v50, v38, v38
  v_and_b32 v40, v50, v5
  v_and_b32 v41, v50, v6
  v_and_b32 v42, v50, v7
  v_and_b32 v43, v50, v8
  s_nop 1
  v_mfma_f32_16x16x32_bf16 v[28:31], v[152:155], v[40:43], v[28:31]
  v_cvt_pk_bf16_f32 v50, v39, v39
  v_and_b32 v44, v50, v5
  v_and_b32 v45, v50, v6
  v_and_b32 v46, v50, v7
  v_and_b32 v47, v50, v8
  s_nop 1
  v_mfma_f32_16x16x32_bf16 v[28:31], v[156:159], v[44:47], v[28:31]
  v_cvt_pk_bf16_f32 v50, v216, v216
  v_and_b32 v40, v50, v5
  v_and_b32 v41, v50, v6
  v_and_b32 v42, v50, v7
  v_and_b32 v43, v50, v8
  s_nop 1
  v_mfma_f32_16x16x32_bf16 v[208:211], v[144:147], v[40:43], v[208:211]
  v_cvt_pk_bf16_f32 v50, v217, v217
  v_and_b32 v44, v50, v5
  v_and_b32 v45, v50, v6
  v_and_b32 v46, v50, v7
  v_and_b32 v47, v50, v8
  s_nop 1
  v_mfma_f32_16x16x32_bf16 v[208:211], v[148:151], v[44:47], v[208:211]
  v_cvt_pk_bf16_f32 v50, v218, v218
  v_and_b32 v40, v50, v5
  v_and_b32 v41, v50, v6
  v_and_b32 v42, v50, v7
  v_and_b32 v43, v50, v8
  s_nop 1
  v_mfma_f32_16x16x32_bf16 v[208:211], v[152:155], v[40:43], v[208:211]
  v_cvt_pk_bf16_f32 v50, v219, v219
  v_and_b32 v44, v50, v5
  v_and_b32 v45, v50, v6
  v_and_b32 v46, v50, v7
  v_and_b32 v47, v50, v8
  s_nop 1
  v_mfma_f32_16x16x32_bf16 v[208:211], v[156:159], v[44:47], v[208:211]
  buffer_load_dwordx4 v[144:147], v4, s[8:11], s62 offen offset:0 nt
  buffer_load_dwordx4 v[148:151], v4, s[8:11], s62 offen offset:256 nt
  buffer_load_dwordx4 v[152:155], v4, s[8:11], s62 offen offset:512 nt
  buffer_load_dwordx4 v[156:159], v4, s[8:11], s62 offen offset:768 nt
  s_waitcnt vmcnt(28)
  v_mfma_f32_16x16x32_bf16 v[32:35], v[160:163], v[12:15], 0
  v_mfma_f32_16x16x32_bf16 v[32:35], v[164:167], v[16:19], v[32:35]
  v_mfma_f32_16x16x32_bf16 v[32:35], v[168:171], v[20:23], v[32:35]
  v_mfma_f32_16x16x32_bf16 v[32:35], v[172:175], v[24:27], v[32:35]
  v_mfma_f32_16x16x32_bf16 v[212:215], v[160:163], v[192:195], 0
  v_mfma_f32_16x16x32_bf16 v[212:215], v[164:167], v[196:199], v[212:215]
  v_mfma_f32_16x16x32_bf16 v[212:215], v[168:171], v[200:203], v[212:215]
  v_mfma_f32_16x16x32_bf16 v[212:215], v[172:175], v[204:207], v[212:215]
  s_and_b32 s62, s99, 31
  s_lshl_b32 s62, s62, 15
  s_add_u32 s62, s62, s97
  s_add_u32 s99, s99, 4
  buffer_load_dwordx4 v[160:163], v3, s[4:7], s62 offen offset:0 nt
  buffer_load_dwordx4 v[164:167], v3, s[4:7], s62 offen offset:64 nt
  buffer_load_dwordx4 v[168:171], v3, s[4:7], s62 offen offset:128 nt
  buffer_load_dwordx4 v[172:175], v3, s[4:7], s62 offen offset:192 nt
  v_max_f32 v50, v32, v33
  v_max3_f32 v50, v34, v35, v50
  v_mov_b32 v51, v50
  s_nop 1
  v_permlane16_swap_b32 v50, v51
  v_max_f32 v50, v50, v51
  v_mov_b32 v51, v50
  s_nop 1
  v_permlane32_swap_b32 v50, v51
  v_max3_f32 v50, v50, v51, v48
  v_mul_f32 v51, s58, v50
  v_fma_f32 v52, v48, s58, -v51
  v_fma_f32 v36, v32, s58, -v51
  v_fma_f32 v37, v33, s58, -v51
  v_fma_f32 v38, v34, s58, -v51
  v_fma_f32 v39, v35, s58, -v51
  v_exp_f32 v52, v52
  v_exp_f32 v36, v36
  v_exp_f32 v37, v37
  v_exp_f32 v38, v38
  v_exp_f32 v39, v39
  v_mov_b32 v48, v50
  v_fma_f32 v49, v49, v52, v36
  v_add_f32 v51, v37, v38
  v_mul_f32 v28, v28, v52
  v_mul_f32 v29, v29, v52
  v_mul_f32 v30, v30, v52
  v_mul_f32 v31, v31, v52
  v_add_f32 v49, v49, v39
  v_add_f32 v49, v49, v51
  v_max_f32 v50, v212, v213
  v_max3_f32 v50, v214, v215, v50
  v_mov_b32 v51, v50
  s_nop 1
  v_permlane16_swap_b32 v50, v51
  v_max_f32 v50, v50, v51
  v_mov_b32 v51, v50
  s_nop 1
  v_permlane32_swap_b32 v50, v51
  v_max3_f32 v50, v50, v51, v220
  v_mul_f32 v51, s58, v50
  v_fma_f32 v52, v220, s58, -v51
  v_fma_f32 v216, v212, s58, -v51
  v_fma_f32 v217, v213, s58, -v51
  v_fma_f32 v218, v214, s58, -v51
  v_fma_f32 v219, v215, s58, -v51
  v_exp_f32 v52, v52
  v_exp_f32 v216, v216
  v_exp_f32 v217, v217
  v_exp_f32 v218, v218
  v_exp_f32 v219, v219
  v_mov_b32 v220, v50
  v_fma_f32 v221, v221, v52, v216
  v_add_f32 v51, v217, v218
  v_mul_f32 v208, v208, v52
  v_mul_f32 v209, v209, v52
  v_mul_f32 v210, v210, v52
  v_mul_f32 v211, v211, v52
  v_add_f32 v221, v221, v219
  v_add_f32 v221, v221, v51
  s_waitcnt vmcnt(28)
  v_cvt_pk_bf16_f32 v50, v36, v36
  v_and_b32 v40, v50, v5
  v_and_b32 v41, v50, v6
  v_and_b32 v42, v50, v7
  v_and_b32 v43, v50, v8
  s_nop 1
  v_mfma_f32_16x16x32_bf16 v[28:31], v[176:179], v[40:43], v[28:31]
  v_cvt_pk_bf16_f32 v50, v37, v37
  v_and_b32 v44, v50, v5
  v_and_b32 v45, v50, v6
  v_and_b32 v46, v50, v7
  v_and_b32 v47, v50, v8
  s_nop 1
  v_mfma_f32_16x16x32_bf16 v[28:31], v[180:183], v[44:47], v[28:31]
  v_cvt_pk_bf16_f32 v50, v38, v38
  v_and_b32 v40, v50, v5
  v_and_b32 v41, v50, v6
  v_and_b32 v42, v50, v7
  v_and_b32 v43, v50, v8
  s_nop 1
  v_mfma_f32_16x16x32_bf16 v[28:31], v[184:187], v[40:43], v[28:31]
  v_cvt_pk_bf16_f32 v50, v39, v39
  v_and_b32 v44, v50, v5
  v_and_b32 v45, v50, v6
  v_and_b32 v46, v50, v7
  v_and_b32 v47, v50, v8
  s_nop 1
  v_mfma_f32_16x16x32_bf16 v[28:31], v[188:191], v[44:47], v[28:31]
  v_cvt_pk_bf16_f32 v50, v216, v216
  v_and_b32 v40, v50, v5
  v_and_b32 v41, v50, v6
  v_and_b32 v42, v50, v7
  v_and_b32 v43, v50, v8
  s_nop 1
  v_mfma_f32_16x16x32_bf16 v[208:211], v[176:179], v[40:43], v[208:211]
  v_cvt_pk_bf16_f32 v50, v217, v217
  v_and_b32 v44, v50, v5
  v_and_b32 v45, v50, v6
  v_and_b32 v46, v50, v7
  v_and_b32 v47, v50, v8
  s_nop 1
  v_mfma_f32_16x16x32_bf16 v[208:211], v[180:183], v[44:47], v[208:211]
  v_cvt_pk_bf16_f32 v50, v218, v218
  v_and_b32 v40, v50, v5
  v_and_b32 v41, v50, v6
  v_and_b32 v42, v50, v7
  v_and_b32 v43, v50, v8
  s_nop 1
  v_mfma_f32_16x16x32_bf16 v[208:211], v[184:187], v[40:43], v[208:211]
  v_cvt_pk_bf16_f32 v50, v219, v219
  v_and_b32 v44, v50, v5
  v_and_b32 v45, v50, v6
  v_and_b32 v46, v50, v7
  v_and_b32 v47, v50, v8
  s_nop 1
  v_mfma_f32_16x16x32_bf16 v[208:211], v[188:191], v[44:47], v[208:211]
  buffer_load_dwordx4 v[176:179], v4, s[8:11], s62 offen offset:0 nt
  buffer_load_dwordx4 v[180:183], v4, s[8:11], s62 offen offset:256 nt
  buffer_load_dwordx4 v[184:187], v4, s[8:11], s62 offen offset:512 nt
  buffer_load_dwordx4 v[188:191], v4, s[8:11], s62 offen offset:768 nt
  s_waitcnt vmcnt(28)
  v_mfma_f32_16x16x32_bf16 v[32:35], v[64:67], v[12:15], 0
  v_mfma_f32_16x16x32_bf16 v[32:35], v[68:71], v[16:19], v[32:35]
  v_mfma_f32_16x16x32_bf16 v[32:35], v[72:75], v[20:23], v[32:35]
  v_mfma_f32_16x16x32_bf16 v[32:35], v[76:79], v[24:27], v[32:35]
  v_mfma_f32_16x16x32_bf16 v[212:215], v[64:67], v[192:195], 0
  v_mfma_f32_16x16x32_bf16 v[212:215], v[68:71], v[196:199], v[212:215]
  v_mfma_f32_16x16x32_bf16 v[212:215], v[72:75], v[200:203], v[212:215]
  v_mfma_f32_16x16x32_bf16 v[212:215], v[76:79], v[204:207], v[212:215]
  s_mov_b32 s4, s34
  s_mov_b32 s5, s35
  s_mov_b32 s6, 0x10000000
  s_mov_b32 s7, 0x00020000
  s_mov_b32 s62, s84
  s_add_u32 s89, s62, 4096
  buffer_load_dwordx2 v[64:65], v62, s[4:7], s62 offen offset:0 nt
  buffer_load_dwordx2 v[66:67], v62, s[4:7], s62 offen offset:8 nt
  buffer_load_dwordx2 v[68:69], v62, s[4:7], s62 offen offset:1024 nt
  buffer_load_dwordx2 v[70:71], v62, s[4:7], s62 offen offset:1032 nt
  buffer_load_dwordx2 v[72:73], v62, s[4:7], s62 offen offset:2048 nt
  buffer_load_dwordx2 v[74:75], v62, s[4:7], s62 offen offset:2056 nt
  buffer_load_dwordx2 v[76:77], v62, s[4:7], s62 offen offset:3072 nt
  buffer_load_dwordx2 v[78:79], v62, s[4:7], s62 offen offset:3080 nt
  v_max_f32 v50, v32, v33
  v_max3_f32 v50, v34, v35, v50
  v_mov_b32 v51, v50
  s_nop 1
  v_permlane16_swap_b32 v50, v51
  v_max_f32 v50, v50, v51
  v_mov_b32 v51, v50
  s_nop 1
  v_permlane32_swap_b32 v50, v51
  v_max3_f32 v50, v50, v51, v48
  v_mul_f32 v51, s58, v50
  v_fma_f32 v52, v48, s58, -v51
  v_fma_f32 v36, v32, s58, -v51
  v_fma_f32 v37, v33, s58, -v51
  v_fma_f32 v38, v34, s58, -v51
  v_fma_f32 v39, v35, s58, -v51
  v_exp_f32 v52, v52
  v_exp_f32 v36, v36
  v_exp_f32 v37, v37
  v_exp_f32 v38, v38
  v_exp_f32 v39, v39
  v_mov_b32 v48, v50
  v_fma_f32 v49, v49, v52, v36
  v_add_f32 v51, v37, v38
  v_mul_f32 v28, v28, v52
  v_mul_f32 v29, v29, v52
  v_mul_f32 v30, v30, v52
  v_mul_f32 v31, v31, v52
  v_add_f32 v49, v49, v39
  v_add_f32 v49, v49, v51
  v_max_f32 v50, v212, v213
  v_max3_f32 v50, v214, v215, v50
  v_mov_b32 v51, v50
  s_nop 1
  v_permlane16_swap_b32 v50, v51
  v_max_f32 v50, v50, v51
  v_mov_b32 v51, v50
  s_nop 1
  v_permlane32_swap_b32 v50, v51
  v_max3_f32 v50, v50, v51, v220
  v_mul_f32 v51, s58, v50
  v_fma_f32 v52, v220, s58, -v51
  v_fma_f32 v216, v212, s58, -v51
  v_fma_f32 v217, v213, s58, -v51
  v_fma_f32 v218, v214, s58, -v51
  v_fma_f32 v219, v215, s58, -v51
  v_exp_f32 v52, v52
  v_exp_f32 v216, v216
  v_exp_f32 v217, v217
  v_exp_f32 v218, v218
  v_exp_f32 v219, v219
  v_mov_b32 v220, v50
  v_fma_f32 v221, v221, v52, v216
  v_add_f32 v51, v217, v218
  v_mul_f32 v208, v208, v52
  v_mul_f32 v209, v209, v52
  v_mul_f32 v210, v210, v52
  v_mul_f32 v211, v211, v52
  v_add_f32 v221, v221, v219
  v_add_f32 v221, v221, v51
  s_waitcnt vmcnt(32)
  v_cvt_pk_bf16_f32 v50, v36, v36
  v_and_b32 v40, v50, v5
  v_and_b32 v41, v50, v6
  v_and_b32 v42, v50, v7
  v_and_b32 v43, v50, v8
  s_nop 1
  v_mfma_f32_16x16x32_bf16 v[28:31], v[80:83], v[40:43], v[28:31]
  v_cvt_pk_bf16_f32 v50, v37, v37
  v_and_b32 v44, v50, v5
  v_and_b32 v45, v50, v6
  v_and_b32 v46, v50, v7
  v_and_b32 v47, v50, v8
  s_nop 1
  v_mfma_f32_16x16x32_bf16 v[28:31], v[84:87], v[44:47], v[28:31]
  v_cvt_pk_bf16_f32 v50, v38, v38
  v_and_b32 v40, v50, v5
  v_and_b32 v41, v50, v6
  v_and_b32 v42, v50, v7
  v_and_b32 v43, v50, v8
  s_nop 1
  v_mfma_f32_16x16x32_bf16 v[28:31], v[88:91], v[40:43], v[28:31]
  v_cvt_pk_bf16_f32 v50, v39, v39
  v_and_b32 v44, v50, v5
  v_and_b32 v45, v50, v6
  v_and_b32 v46, v50, v7
  v_and_b32 v47, v50, v8
  s_nop 1
  v_mfma_f32_16x16x32_bf16 v[28:31], v[92:95], v[44:47], v[28:31]
  v_cvt_pk_bf16_f32 v50, v216, v216
  v_and_b32 v40, v50, v5
  v_and_b32 v41, v50, v6
  v_and_b32 v42, v50, v7
  v_and_b32 v43, v50, v8
  s_nop 1
  v_mfma_f32_16x16x32_bf16 v[208:211], v[80:83], v[40:43], v[208:211]
  v_cvt_pk_bf16_f32 v50, v217, v217
  v_and_b32 v44, v50, v5
  v_and_b32 v45, v50, v6
  v_and_b32 v46, v50, v7
  v_and_b32 v47, v50, v8
  s_nop 1
  v_mfma_f32_16x16x32_bf16 v[208:211], v[84:87], v[44:47], v[208:211]
  v_cvt_pk_bf16_f32 v50, v218, v218
  v_and_b32 v40, v50, v5
  v_and_b32 v41, v50, v6
  v_and_b32 v42, v50, v7
  v_and_b32 v43, v50, v8
  s_nop 1
  v_mfma_f32_16x16x32_bf16 v[208:211], v[88:91], v[40:43], v[208:211]
  v_cvt_pk_bf16_f32 v50, v219, v219
  v_and_b32 v44, v50, v5
  v_and_b32 v45, v50, v6
  v_and_b32 v46, v50, v7
  v_and_b32 v47, v50, v8
  s_nop 1
  v_mfma_f32_16x16x32_bf16 v[208:211], v[92:95], v[44:47], v[208:211]
  buffer_load_dwordx4 v[80:83], v62, s[4:7], s89 offen offset:0 nt
  buffer_load_dwordx4 v[84:87], v62, s[4:7], s89 offen offset:1024 nt
  buffer_load_dwordx4 v[88:91], v62, s[4:7], s89 offen offset:2048 nt
  buffer_load_dwordx4 v[92:95], v62, s[4:7], s89 offen offset:3072 nt
  s_waitcnt vmcnt(32)
  v_mfma_f32_16x16x32_bf16 v[32:35], v[96:99], v[12:15], 0
  v_mfma_f32_16x16x32_bf16 v[32:35], v[100:103], v[16:19], v[32:35]
  v_mfma_f32_16x16x32_bf16 v[32:35], v[104:107], v[20:23], v[32:35]
  v_mfma_f32_16x16x32_bf16 v[32:35], v[108:111], v[24:27], v[32:35]
  v_mfma_f32_16x16x32_bf16 v[212:215], v[96:99], v[192:195], 0
  v_mfma_f32_16x16x32_bf16 v[212:215], v[100:103], v[196:199], v[212:215]
  v_mfma_f32_16x16x32_bf16 v[212:215], v[104:107], v[200:203], v[212:215]
  v_mfma_f32_16x16x32_bf16 v[212:215], v[108:111], v[204:207], v[212:215]
  s_add_u32 s62, s62, 32768
  s_add_u32 s89, s62, 4096
  buffer_load_dwordx2 v[96:97], v62, s[4:7], s62 offen offset:0 nt
  buffer_load_dwordx2 v[98:99], v62, s[4:7], s62 offen offset:8 nt
  buffer_load_dwordx2 v[100:101], v62, s[4:7], s62 offen offset:1024 nt
  buffer_load_dwordx2 v[102:103], v62, s[4:7], s62 offen offset:1032 nt
  buffer_load_dwordx2 v[104:105], v62, s[4:7], s62 offen offset:2048 nt
  buffer_load_dwordx2 v[106:107], v62, s[4:7], s62 offen offset:2056 nt
  buffer_load_dwordx2 v[108:109], v62, s[4:7], s62 offen offset:3072 nt
  buffer_load_dwordx2 v[110:111], v62, s[4:7], s62 offen offset:3080 nt
  v_max_f32 v50, v32, v33
  v_max3_f32 v50, v34, v35, v50
  v_mov_b32 v51, v50
  s_nop 1
  v_permlane16_swap_b32 v50, v51
  v_max_f32 v50, v50, v51
  v_mov_b32 v51, v50
  s_nop 1
  v_permlane32_swap_b32 v50, v51
  v_max3_f32 v50, v50, v51, v48
  v_mul_f32 v51, s58, v50
  v_fma_f32 v52, v48, s58, -v51
  v_fma_f32 v36, v32, s58, -v51
  v_fma_f32 v37, v33, s58, -v51
  v_fma_f32 v38, v34, s58, -v51
  v_fma_f32 v39, v35, s58, -v51
  v_exp_f32 v52, v52
  v_exp_f32 v36, v36
  v_exp_f32 v37, v37
  v_exp_f32 v38, v38
  v_exp_f32 v39, v39
  v_mov_b32 v48, v50
  v_fma_f32 v49, v49, v52, v36
  v_add_f32 v51, v37, v38
  v_mul_f32 v28, v28, v52
  v_mul_f32 v29, v29, v52
  v_mul_f32 v30, v30, v52
  v_mul_f32 v31, v31, v52
  v_add_f32 v49, v49, v39
  v_add_f32 v49, v49, v51
  v_max_f32 v50, v212, v213
  v_max3_f32 v50, v214, v215, v50
  v_mov_b32 v51, v50
  s_nop 1
  v_permlane16_swap_b32 v50, v51
  v_max_f32 v50, v50, v51
  v_mov_b32 v51, v50
  s_nop 1
  v_permlane32_swap_b32 v50, v51
  v_max3_f32 v50, v50, v51, v220
  v_mul_f32 v51, s58, v50
  v_fma_f32 v52, v220, s58, -v51
  v_fma_f32 v216, v212, s58, -v51
  v_fma_f32 v217, v213, s58, -v51
  v_fma_f32 v218, v214, s58, -v51
  v_fma_f32 v219, v215, s58, -v51
  v_exp_f32 v52, v52
  v_exp_f32 v216, v216
  v_exp_f32 v217, v217
  v_exp_f32 v218, v218
  v_exp_f32 v219, v219
  v_mov_b32 v220, v50
  v_fma_f32 v221, v221, v52, v216
  v_add_f32 v51, v217, v218
  v_mul_f32 v208, v208, v52
  v_mul_f32 v209, v209, v52
  v_mul_f32 v210, v210, v52
  v_mul_f32 v211, v211, v52
  v_add_f32 v221, v221, v219
  v_add_f32 v221, v221, v51
  s_waitcnt vmcnt(36)
  v_cvt_pk_bf16_f32 v50, v36, v36
  v_and_b32 v40, v50, v5
  v_and_b32 v41, v50, v6
  v_and_b32 v42, v50, v7
  v_and_b32 v43, v50, v8
  s_nop 1
  v_mfma_f32_16x16x32_bf16 v[28:31], v[112:115], v[40:43], v[28:31]
  v_cvt_pk_bf16_f32 v50, v37, v37
  v_and_b32 v44, v50, v5
  v_and_b32 v45, v50, v6
  v_and_b32 v46, v50, v7
  v_and_b32 v47, v50, v8
  s_nop 1
  v_mfma_f32_16x16x32_bf16 v[28:31], v[116:119], v[44:47], v[28:31]
  v_cvt_pk_bf16_f32 v50, v38, v38
  v_and_b32 v40, v50, v5
  v_and_b32 v41, v50, v6
  v_and_b32 v42, v50, v7
  v_and_b32 v43, v50, v8
  s_nop 1
  v_mfma_f32_16x16x32_bf16 v[28:31], v[120:123], v[40:43], v[28:31]
  v_cvt_pk_bf16_f32 v50, v39, v39
  v_and_b32 v44, v50, v5
  v_and_b32 v45, v50, v6
  v_and_b32 v46, v50, v7
  v_and_b32 v47, v50, v8
  s_nop 1
  v_mfma_f32_16x16x32_bf16 v[28:31], v[124:127], v[44:47], v[28:31]
  v_cvt_pk_bf16_f32 v50, v216, v216
  v_and_b32 v40, v50, v5
  v_and_b32 v41, v50, v6
  v_and_b32 v42, v50, v7
  v_and_b32 v43, v50, v8
  s_nop 1
  v_mfma_f32_16x16x32_bf16 v[208:211], v[112:115], v[40:43], v[208:211]
  v_cvt_pk_bf16_f32 v50, v217, v217
  v_and_b32 v44, v50, v5
  v_and_b32 v45, v50, v6
  v_and_b32 v46, v50, v7
  v_and_b32 v47, v50, v8
  s_nop 1
  v_mfma_f32_16x16x32_bf16 v[208:211], v[116:119], v[44:47], v[208:211]
  v_cvt_pk_bf16_f32 v50, v218, v218
  v_and_b32 v40, v50, v5
  v_and_b32 v41, v50, v6
  v_and_b32 v42, v50, v7
  v_and_b32 v43, v50, v8
  s_nop 1
  v_mfma_f32_16x16x32_bf16 v[208:211], v[120:123], v[40:43], v[208:211]
  v_cvt_pk_bf16_f32 v50, v219, v219
  v_and_b32 v44, v50, v5
  v_and_b32 v45, v50, v6
  v_and_b32 v46, v50, v7
  v_and_b32 v47, v50, v8
  s_nop 1
  v_mfma_f32_16x16x32_bf16 v[208:211], v[124:127], v[44:47], v[208:211]
  buffer_load_dwordx4 v[112:115], v62, s[4:7], s89 offen offset:0 nt
  buffer_load_dwordx4 v[116:119], v62, s[4:7], s89 offen offset:1024 nt
  buffer_load_dwordx4 v[120:123], v62, s[4:7], s89 offen offset:2048 nt
  buffer_load_dwordx4 v[124:127], v62, s[4:7], s89 offen offset:3072 nt
  s_waitcnt vmcnt(36)
  v_mfma_f32_16x16x32_bf16 v[32:35], v[128:131], v[12:15], 0
  v_mfma_f32_16x16x32_bf16 v[32:35], v[132:135], v[16:19], v[32:35]
  v_mfma_f32_16x16x32_bf16 v[32:35], v[136:139], v[20:23], v[32:35]
  v_mfma_f32_16x16x32_bf16 v[32:35], v[140:143], v[24:27], v[32:35]
  v_mfma_f32_16x16x32_bf16 v[212:215], v[128:131], v[192:195], 0
  v_mfma_f32_16x16x32_bf16 v[212:215], v[132:135], v[196:199], v[212:215]
  v_mfma_f32_16x16x32_bf16 v[212:215], v[136:139], v[200:203], v[212:215]
  v_mfma_f32_16x16x32_bf16 v[212:215], v[140:143], v[204:207], v[212:215]
  s_add_u32 s62, s62, 32768
  s_add_u32 s89, s62, 4096
  buffer_load_dwordx2 v[128:129], v62, s[4:7], s62 offen offset:0 nt
  buffer_load_dwordx2 v[130:131], v62, s[4:7], s62 offen offset:8 nt
  buffer_load_dwordx2 v[132:133], v62, s[4:7], s62 offen offset:1024 nt
  buffer_load_dwordx2 v[134:135], v62, s[4:7], s62 offen offset:1032 nt
  buffer_load_dwordx2 v[136:137], v62, s[4:7], s62 offen offset:2048 nt
  buffer_load_dwordx2 v[138:139], v62, s[4:7], s62 offen offset:2056 nt
  buffer_load_dwordx2 v[140:141], v62, s[4:7], s62 offen offset:3072 nt
  buffer_load_dwordx2 v[142:143], v62, s[4:7], s62 offen offset:3080 nt
  v_max_f32 v50, v32, v33
  v_max3_f32 v50, v34, v35, v50
  v_mov_b32 v51, v50
  s_nop 1
  v_permlane16_swap_b32 v50, v51
  v_max_f32 v50, v50, v51
  v_mov_b32 v51, v50
  s_nop 1
  v_permlane32_swap_b32 v50, v51
  v_max3_f32 v50, v50, v51, v48
  v_mul_f32 v51, s58, v50
  v_fma_f32 v52, v48, s58, -v51
  v_fma_f32 v36, v32, s58, -v51
  v_fma_f32 v37, v33, s58, -v51
  v_fma_f32 v38, v34, s58, -v51
  v_fma_f32 v39, v35, s58, -v51
  v_exp_f32 v52, v52
  v_exp_f32 v36, v36
  v_exp_f32 v37, v37
  v_exp_f32 v38, v38
  v_exp_f32 v39, v39
  v_mov_b32 v48, v50
  v_fma_f32 v49, v49, v52, v36
  v_add_f32 v51, v37, v38
  v_mul_f32 v28, v28, v52
  v_mul_f32 v29, v29, v52
  v_mul_f32 v30, v30, v52
  v_mul_f32 v31, v31, v52
  v_add_f32 v49, v49, v39
  v_add_f32 v49, v49, v51
  v_max_f32 v50, v212, v213
  v_max3_f32 v50, v214, v215, v50
  v_mov_b32 v51, v50
  s_nop 1
  v_permlane16_swap_b32 v50, v51
  v_max_f32 v50, v50, v51
  v_mov_b32 v51, v50
  s_nop 1
  v_permlane32_swap_b32 v50, v51
  v_max3_f32 v50, v50, v51, v220
  v_mul_f32 v51, s58, v50
  v_fma_f32 v52, v220, s58, -v51
  v_fma_f32 v216, v212, s58, -v51
  v_fma_f32 v217, v213, s58, -v51
  v_fma_f32 v218, v214, s58, -v51
  v_fma_f32 v219, v215, s58, -v51
  v_exp_f32 v52, v52
  v_exp_f32 v216, v216
  v_exp_f32 v217, v217
  v_exp_f32 v218, v218
  v_exp_f32 v219, v219
  v_mov_b32 v220, v50
  v_fma_f32 v221, v221, v52, v216
  v_add_f32 v51, v217, v218
  v_mul_f32 v208, v208, v52
  v_mul_f32 v209, v209, v52
  v_mul_f32 v210, v210, v52
  v_mul_f32 v211, v211, v52
  v_add_f32 v221, v221, v219
  v_add_f32 v221, v221, v51
  s_waitcnt vmcnt(40)
  v_cvt_pk_bf16_f32 v50, v36, v36
  v_and_b32 v40, v50, v5
  v_and_b32 v41, v50, v6
  v_and_b32 v42, v50, v7
  v_and_b32 v43, v50, v8
  s_nop 1
  v_mfma_f32_16x16x32_bf16 v[28:31], v[144:147], v[40:43], v[28:31]
  v_cvt_pk_bf16_f32 v50, v37, v37
  v_and_b32 v44, v50, v5
  v_and_b32 v45, v50, v6
  v_and_b32 v46, v50, v7
  v_and_b32 v47, v50, v8
  s_nop 1
  v_mfma_f32_16x16x32_bf16 v[28:31], v[148:151], v[44:47], v[28:31]
  v_cvt_pk_bf16_f32 v50, v38, v38
  v_and_b32 v40, v50, v5
  v_and_b32 v41, v50, v6
  v_and_b32 v42, v50, v7
  v_and_b32 v43, v50, v8
  s_nop 1
  v_mfma_f32_16x16x32_bf16 v[28:31], v[152:155], v[40:43], v[28:31]
  v_cvt_pk_bf16_f32 v50, v39, v39
  v_and_b32 v44, v50, v5
  v_and_b32 v45, v50, v6
  v_and_b32 v46, v50, v7
  v_and_b32 v47, v50, v8
  s_nop 1
  v_mfma_f32_16x16x32_bf16 v[28:31], v[156:159], v[44:47], v[28:31]
  v_cvt_pk_bf16_f32 v50, v216, v216
  v_and_b32 v40, v50, v5
  v_and_b32 v41, v50, v6
  v_and_b32 v42, v50, v7
  v_and_b32 v43, v50, v8
  s_nop 1
  v_mfma_f32_16x16x32_bf16 v[208:211], v[144:147], v[40:43], v[208:211]
  v_cvt_pk_bf16_f32 v50, v217, v217
  v_and_b32 v44, v50, v5
  v_and_b32 v45, v50, v6
  v_and_b32 v46, v50, v7
  v_and_b32 v47, v50, v8
  s_nop 1
  v_mfma_f32_16x16x32_bf16 v[208:211], v[148:151], v[44:47], v[208:211]
  v_cvt_pk_bf16_f32 v50, v218, v218
  v_and_b32 v40, v50, v5
  v_and_b32 v41, v50, v6
  v_and_b32 v42, v50, v7
  v_and_b32 v43, v50, v8
  s_nop 1
  v_mfma_f32_16x16x32_bf16 v[208:211], v[152:155], v[40:43], v[208:211]
  v_cvt_pk_bf16_f32 v50, v219, v219
  v_and_b32 v44, v50, v5
  v_and_b32 v45, v50, v6
  v_and_b32 v46, v50, v7
  v_and_b32 v47, v50, v8
  s_nop 1
  v_mfma_f32_16x16x32_bf16 v[208:211], v[156:159], v[44:47], v[208:211]
  buffer_load_dwordx4 v[144:147], v62, s[4:7], s89 offen offset:0 nt
  buffer_load_dwordx4 v[148:151], v62, s[4:7], s89 offen offset:1024 nt
  buffer_load_dwordx4 v[152:155], v62, s[4:7], s89 offen offset:2048 nt
  buffer_load_dwordx4 v[156:159], v62, s[4:7], s89 offen offset:3072 nt
  s_waitcnt vmcnt(40)
  v_mfma_f32_16x16x32_bf16 v[32:35], v[160:163], v[12:15], 0
  v_mfma_f32_16x16x32_bf16 v[32:35], v[164:167], v[16:19], v[32:35]
  v_mfma_f32_16x16x32_bf16 v[32:35], v[168:171], v[20:23], v[32:35]
  v_mfma_f32_16x16x32_bf16 v[32:35], v[172:175], v[24:27], v[32:35]
  v_mfma_f32_16x16x32_bf16 v[212:215], v[160:163], v[192:195], 0
  v_mfma_f32_16x16x32_bf16 v[212:215], v[164:167], v[196:199], v[212:215]
  v_mfma_f32_16x16x32_bf16 v[212:215], v[168:171], v[200:203], v[212:215]
  v_mfma_f32_16x16x32_bf16 v[212:215], v[172:175], v[204:207], v[212:215]
  s_add_u32 s62, s62, 32768
  s_add_u32 s89, s62, 4096
  buffer_load_dwordx2 v[160:161], v62, s[4:7], s62 offen offset:0 nt
  buffer_load_dwordx2 v[162:163], v62, s[4:7], s62 offen offset:8 nt
  buffer_load_dwordx2 v[164:165], v62, s[4:7], s62 offen offset:1024 nt
  buffer_load_dwordx2 v[166:167], v62, s[4:7], s62 offen offset:1032 nt
  buffer_load_dwordx2 v[168:169], v62, s[4:7], s62 offen offset:2048 nt
  buffer_load_dwordx2 v[170:171], v62, s[4:7], s62 offen offset:2056 nt
  buffer_load_dwordx2 v[172:173], v62, s[4:7], s62 offen offset:3072 nt
  buffer_load_dwordx2 v[174:175], v62, s[4:7], s62 offen offset:3080 nt
  v_max_f32 v50, v32, v33
  v_max3_f32 v50, v34, v35, v50
  v_mov_b32 v51, v50
  s_nop 1
  v_permlane16_swap_b32 v50, v51
  v_max_f32 v50, v50, v51
  v_mov_b32 v51, v50
  s_nop 1
  v_permlane32_swap_b32 v50, v51
  v_max3_f32 v50, v50, v51, v48
  v_mul_f32 v51, s58, v50
  v_fma_f32 v52, v48, s58, -v51
  v_fma_f32 v36, v32, s58, -v51
  v_fma_f32 v37, v33, s58, -v51
  v_fma_f32 v38, v34, s58, -v51
  v_fma_f32 v39, v35, s58, -v51
  v_exp_f32 v52, v52
  v_exp_f32 v36, v36
  v_exp_f32 v37, v37
  v_exp_f32 v38, v38
  v_exp_f32 v39, v39
  v_mov_b32 v48, v50
  v_fma_f32 v49, v49, v52, v36
  v_add_f32 v51, v37, v38
  v_mul_f32 v28, v28, v52
  v_mul_f32 v29, v29, v52
  v_mul_f32 v30, v30, v52
  v_mul_f32 v31, v31, v52
  v_add_f32 v49, v49, v39
  v_add_f32 v49, v49, v51
  v_max_f32 v50, v212, v213
  v_max3_f32 v50, v214, v215, v50
  v_mov_b32 v51, v50
  s_nop 1
  v_permlane16_swap_b32 v50, v51
  v_max_f32 v50, v50, v51
  v_mov_b32 v51, v50
  s_nop 1
  v_permlane32_swap_b32 v50, v51
  v_max3_f32 v50, v50, v51, v220
  v_mul_f32 v51, s58, v50
  v_fma_f32 v52, v220, s58, -v51
  v_fma_f32 v216, v212, s58, -v51
  v_fma_f32 v217, v213, s58, -v51
  v_fma_f32 v218, v214, s58, -v51
  v_fma_f32 v219, v215, s58, -v51
  v_exp_f32 v52, v52
  v_exp_f32 v216, v216
  v_exp_f32 v217, v217
  v_exp_f32 v218, v218
  v_exp_f32 v219, v219
  v_mov_b32 v220, v50
  v_fma_f32 v221, v221, v52, v216
  v_add_f32 v51, v217, v218
  v_mul_f32 v208, v208, v52
  v_mul_f32 v209, v209, v52
  v_mul_f32 v210, v210, v52
  v_mul_f32 v211, v211, v52
  v_add_f32 v221, v221, v219
  v_add_f32 v221, v221, v51
  s_waitcnt vmcnt(44)
  v_cvt_pk_bf16_f32 v50, v36, v36
  v_and_b32 v40, v50, v5
  v_and_b32 v41, v50, v6
  v_and_b32 v42, v50, v7
  v_and_b32 v43, v50, v8
  s_nop 1
  v_mfma_f32_16x16x32_bf16 v[28:31], v[176:179], v[40:43], v[28:31]
  v_cvt_pk_bf16_f32 v50, v37, v37
  v_and_b32 v44, v50, v5
  v_and_b32 v45, v50, v6
  v_and_b32 v46, v50, v7
  v_and_b32 v47, v50, v8
  s_nop 1
  v_mfma_f32_16x16x32_bf16 v[28:31], v[180:183], v[44:47], v[28:31]
  v_cvt_pk_bf16_f32 v50, v38, v38
  v_and_b32 v40, v50, v5
  v_and_b32 v41, v50, v6
  v_and_b32 v42, v50, v7
  v_and_b32 v43, v50, v8
  s_nop 1
  v_mfma_f32_16x16x32_bf16 v[28:31], v[184:187], v[40:43], v[28:31]
  v_cvt_pk_bf16_f32 v50, v39, v39
  v_and_b32 v44, v50, v5
  v_and_b32 v45, v50, v6
  v_and_b32 v46, v50, v7
  v_and_b32 v47, v50, v8
  s_nop 1
  v_mfma_f32_16x16x32_bf16 v[28:31], v[188:191], v[44:47], v[28:31]
  v_cvt_pk_bf16_f32 v50, v216, v216
  v_and_b32 v40, v50, v5
  v_and_b32 v41, v50, v6
  v_and_b32 v42, v50, v7
  v_and_b32 v43, v50, v8
  s_nop 1
  v_mfma_f32_16x16x32_bf16 v[208:211], v[176:179], v[40:43], v[208:211]
  v_cvt_pk_bf16_f32 v50, v217, v217
  v_and_b32 v44, v50, v5
  v_and_b32 v45, v50, v6
  v_and_b32 v46, v50, v7
  v_and_b32 v47, v50, v8
  s_nop 1
  v_mfma_f32_16x16x32_bf16 v[208:211], v[180:183], v[44:47], v[208:211]
  v_cvt_pk_bf16_f32 v50, v218, v218
  v_and_b32 v40, v50, v5
  v_and_b32 v41, v50, v6
  v_and_b32 v42, v50, v7
  v_and_b32 v43, v50, v8
  s_nop 1
  v_mfma_f32_16x16x32_bf16 v[208:211], v[184:187], v[40:43], v[208:211]
  v_cvt_pk_bf16_f32 v50, v219, v219
  v_and_b32 v44, v50, v5
  v_and_b32 v45, v50, v6
  v_and_b32 v46, v50, v7
  v_and_b32 v47, v50, v8
  s_nop 1
  v_mfma_f32_16x16x32_bf16 v[208:211], v[188:191], v[44:47], v[208:211]
  buffer_load_dwordx4 v[176:179], v62, s[4:7], s89 offen offset:0 nt
  buffer_load_dwordx4 v[180:183], v62, s[4:7], s89 offen offset:1024 nt
  buffer_load_dwordx4 v[184:187], v62, s[4:7], s89 offen offset:2048 nt
  buffer_load_dwordx4 v[188:191], v62, s[4:7], s89 offen offset:3072 nt
  v_and_b32 v51, 7, v1
  v_lshl_add_u32 v51, v2, 5, v51
  v_lshrrev_b32 v52, 3, v1
  v_lshl_add_u32 v51, v52, 7, v51
  v_lshlrev_b32 v51, 2, v51
  s_lshl_b32 s65, s3, 11
  v_add_u32 v51, s65, v51
  v_lshlrev_b32 v52, 3, v52
  s_lshl_b32 s65, s3, 5
  v_add_u32 v52, s65, v52
  v_mov_b32 v50, v49
  s_nop 1
  v_permlane16_swap_b32 v49, v50
  v_add_f32 v49, v49, v50
  v_mov_b32 v50, v49
  s_nop 1
  v_permlane32_swap_b32 v49, v50
  v_add_f32 v49, v49, v50
  ds_write_b32 v51, v28 offset:12288
  ds_write_b32 v51, v29 offset:12320
  ds_write_b32 v51, v30 offset:12352
  ds_write_b32 v51, v31 offset:12384
  ds_write_b64 v52, v[48:49] offset:10496
  v_mov_b32 v50, v221
  s_nop 1
  v_permlane16_swap_b32 v221, v50
  v_add_f32 v221, v221, v50
  v_mov_b32 v50, v221
  s_nop 1
  v_permlane32_swap_b32 v221, v50
  v_add_f32 v221, v221, v50
  ds_write_b32 v51, v208 offset:13312
  ds_write_b32 v51, v209 offset:13344
  ds_write_b32 v51, v210 offset:13376
  ds_write_b32 v51, v211 offset:13408
  ds_write_b64 v52, v[220:221] offset:10512
  v_mov_b32 v10, 0
  v_mov_b32 v9, 1
  s_waitcnt lgkmcnt(0)
  s_mov_b64 exec, 1
  ds_add_u32 v10, v9 offset:10328
  s_mov_b64 exec, -1
  v_mov_b32 v48, 0xff800000
  v_mov_b32 v49, 0
  v_mov_b32 v28, 0
  v_mov_b32 v29, 0
  v_mov_b32 v30, 0
  v_mov_b32 v31, 0
  s_mov_b32 s76, 0
  s_add_u32 s85, s3, 0
  s_mov_b32 s77, 0
  s_add_u32 s86, s3, 4
  s_mov_b32 s78, 0
  s_add_u32 s87, s3, 8
  s_mov_b32 s79, 0
  s_add_u32 s88, s3, 12
  s_mov_b32 s63, 0
  s_mov_b32 s82, -1
  s_mov_b32 s83, 0
  v_lshlrev_b32 v53, 4, v1
  v_lshlrev_b32 v63, 5, v2
  v_mov_b32 v10, 0
  v_mov_b32 v9, 1
  s_branch L_s_join2
L_service:
  s_setprio 3
  s_mov_b32 s24, s54
  s_mov_b32 s25, s55
  s_mov_b32 s26, 0x100
  s_mov_b32 s27, 0x00020000
  v_mov_b32 v51, 0
  s_cmp_lg_u32 s2, 0
  s_cbranch_scc1 L_v_noep0
  s_memrealtime s[90:91]
  s_waitcnt lgkmcnt(0)
  s_max_u32 s69, s90, 1
  v_mov_b32 v50, s69
  s_mov_b64 exec, 1
  buffer_store_dword v50, v51, s[24:27], 0 offen sc1
  s_mov_b64 exec, -1
L_v_noep0:
  v_and_b32 v50, 1, v1
  v_mov_b32 v51, 0xffff
  v_lshlrev_b32 v50, 4, v50
  v_lshlrev_b32 v51, v50, v51
  v_bfe_u32 v50, v1, 1, 2
  v_cmp_eq_u32 vcc, 0, v50
  s_nop 1
  v_cndmask_b32 v5, 0, v51, vcc
  v_cmp_eq_u32 vcc, 1, v50
  s_nop 1
  v_cndmask_b32 v6, 0, v51, vcc
  v_cmp_eq_u32 vcc, 2, v50
  s_nop 1
  v_cndmask_b32 v7, 0, v51, vcc
  v_cmp_eq_u32 vcc, 3, v50
  s_nop 1
  v_cndmask_b32 v8, 0, v51, vcc
  v_cmp_lt_u32 s[72:73], 7, v1
  s_mov_b32 s58, 0x3e0293ee
  s_mov_b32 s70, 0x01000100
  s_mov_b32 s71, 0x03020302
  v_mov_b32 v50, 16
  v_mov_b32 v51, 0
  v_mov_b32 v52, -1
  ds_write_b32 v51, v50 offset:10304
  ds_write_b32 v51, v52 offset:10320
  ds_write_b32 v51, v51 offset:10328
  s_mov_b32 s74, 262144
  s_memrealtime s[90:91]
L_ep_loop:
  buffer_load_dword v50, v51, s[24:27], 0 offen sc1
  s_waitcnt vmcnt(0) lgkmcnt(0)
  v_readfirstlane_b32 s69, v50
  s_nop 3
  s_cmp_eq_u32 s69, 0
  s_cbranch_scc1 L_ep_next
  s_sub_u32 s65, s90, s69
  s_cmp_lt_i32 s65, 5000
  s_cbranch_scc1 L_ep_done
  s_cmp_lt_u32 s74, 262016
  s_cbranch_scc1 L_ep_done
L_ep_next:
  s_sleep 2
  s_sub_u32 s74, s74, 1
  s_cmp_lg_u32 s74, 0
  s_cbranch_scc1 L_ep_loop
L_ep_done:
  v_lshlrev_b32 v55, 3, v0
  s_cmp_ge_u32 s61, 4
  s_cbranch_scc1 L_v_noprod3
  v_and_b32 v51, 31, v0
  v_lshlrev_b32 v51, 3, v51
  s_lshr_b32 s65, s61, 1
  s_lshl_b32 s65, s65, 5
  s_add_u32 s65, s65, s60
  s_lshl_b32 s65, s65, 9
  s_and_b32 s66, s61, 1
  s_lshl_b32 s66, s66, 8
  s_add_u32 s65, s65, s66
  s_add_u32 s65, s65, 65536
  s_barrier
  ds_read_b64 v[192:193], v51 offset:0
  ds_read_b64 v[194:195], v51 offset:256
  ds_read_b64 v[196:197], v51 offset:512
  ds_read_b64 v[198:199], v51 offset:768
  ds_read_b64 v[200:201], v51 offset:1024
  ds_read_b64 v[202:203], v51 offset:1280
  ds_read_b64 v[204:205], v51 offset:1536
  ds_read_b64 v[206:207], v51 offset:1792
  s_waitcnt lgkmcnt(0)
  v_add_f32 v192, v192, v194
  v_add_f32 v193, v193, v195
  v_add_f32 v192, v192, v196
  v_add_f32 v193, v193, v197
  v_add_f32 v192, v192, v198
  v_add_f32 v193, v193, v199
  v_add_f32 v192, v192, v200
  v_add_f32 v193, v193, v201
  v_add_f32 v192, v192, v202
  v_add_f32 v193, v193, v203
  v_add_f32 v192, v192, v204
  v_add_f32 v193, v193, v205
  v_add_f32 v192, v192, v206
  v_add_f32 v193, v193, v207
  v_cvt_pk_bf16_f32 v40, v192, v193
  v_mov_b32 v41, s69
  s_mov_b32 exec_hi, 0
  buffer_store_dwordx2 v[40:41], v51, s[16:19], s65 offen sc1
  s_mov_b64 exec, -1
L_v_noprod3:
  s_lshl_b32 s65, s60, 9
  s_add_u32 s65, s65, 65536
  s_mov_b32 s74, 262144
L_poll_49:
  buffer_load_dwordx2 v[12:13], v55, s[16:19], s65 offen sc1
  s_waitcnt vmcnt(0)
  v_xor_b32 v50, s69, v13
  v_cmp_ne_u32 vcc, 0, v50
  s_nop 4
  s_cbranch_vccz L_pdone_50
  s_sleep 2
  s_sub_u32 s74, s74, 1
  s_cmp_lg_u32 s74, 0
  s_cbranch_scc1 L_poll_49
L_pdone_50:
  v_lshlrev_b32 v52, 2, v0
  ds_write_b32 v52, v12 offset:4096
  v_mov_b32 v50, s69
  v_mov_b32 v51, 0
  ds_write_b32 v51, v50 offset:10312
  s_cmp_lt_u32 s61, 6
  s_cbranch_scc1 L_v_noqb
  s_lshr_b32 s65, s60, 2
  s_lshl_b32 s65, s65, 11
  s_add_u32 s65, s65, 81920
  s_mov_b32 s74, 262144
L_poll_51:
  buffer_load_dwordx2 v[12:13], v55, s[16:19], s65 offen offset:0 sc1
  buffer_load_dwordx2 v[14:15], v55, s[16:19], s65 offen offset:512 sc1
  buffer_load_dwordx2 v[16:17], v55, s[16:19], s65 offen offset:1024 sc1
  buffer_load_dwordx2 v[18:19], v55, s[16:19], s65 offen offset:1536 sc1
  s_waitcnt vmcnt(0)
  v_xor_b32 v50, s69, v13
  v_xor_b32 v51, s69, v15
  v_xor_b32 v9, s69, v17
  v_or3_b32 v50, v50, v51, v9
  v_xor_b32 v51, s69, v19
  v_or_b32 v50, v50, v51
  v_cmp_ne_u32 vcc, 0, v50
  s_nop 4
  s_cbranch_vccz L_pdone_52
  s_sleep 2
  s_sub_u32 s74, s74, 1
  s_cmp_lg_u32 s74, 0
  s_cbranch_scc1 L_poll_51
L_pdone_52:
  ds_write_b32 v52, v12 offset:4352
  ds_write_b32 v52, v14 offset:4608
  ds_write_b32 v52, v16 offset:4864
  ds_write_b32 v52, v18 offset:5120
L_v_noqb:
  s_waitcnt lgkmcnt(0)
  s_barrier
  s_cmp_lt_u32 s61, 6
  s_cbranch_scc1 L_v_noB
  s_lshl_b32 s65, s60, 1
  s_add_u32 s65, s65, s61
  s_sub_u32 s65, s65, 6
  s_and_b32 s98, s65, 7
  v_mov_b32 v51, 0
  s_mov_b32 s74, 262144
L_v_bd:
  ds_read_b32 v50, v51 offset:10328
  s_waitcnt lgkmcnt(0)
  v_readfirstlane_b32 s65, v50
  s_nop 3
  s_cmp_ge_u32 s65, 4
  s_cbranch_scc1 L_v_bdok
  s_sleep 16
  s_sub_u32 s74, s74, 1
  s_cmp_lg_u32 s74, 0
  s_cbranch_scc1 L_v_bd
L_v_bdok:
  ds_read_b64 v[128:129], v51 offset:10496
  ds_read_b64 v[144:145], v55 offset:12288
  ds_read_b64 v[130:131], v51 offset:10528
  ds_read_b64 v[146:147], v55 offset:14336
  ds_read_b64 v[132:133], v51 offset:10560
  ds_read_b64 v[148:149], v55 offset:16384
  ds_read_b64 v[134:135], v51 offset:10592
  ds_read_b64 v[150:151], v55 offset:18432
  s_waitcnt lgkmcnt(0)
  v_max_f32 v50, v128, v130
  v_max3_f32 v50, v132, v134, v50
  v_sub_f32 v128, v128, v50
  v_sub_f32 v130, v130, v50
  v_sub_f32 v132, v132, v50
  v_sub_f32 v134, v134, v50
  v_mul_f32 v128, s58, v128
  v_mul_f32 v130, s58, v130
  v_mul_f32 v132, s58, v132
  v_mul_f32 v134, s58, v134
  v_exp_f32 v128, v128
  v_exp_f32 v130, v130
  v_exp_f32 v132, v132
  v_exp_f32 v134, v134
  s_nop 0
  v_mul_f32 v64, v144, v128
  v_mul_f32 v66, v145, v128
  v_mul_f32 v52, v129, v128
  v_fma_f32 v64, v146, v130, v64
  v_fma_f32 v66, v147, v130, v66
  v_fma_f32 v52, v131, v130, v52
  v_fma_f32 v64, v148, v132, v64
  v_fma_f32 v66, v149, v132, v66
  v_fma_f32 v52, v133, v132, v52
  v_fma_f32 v64, v150, v134, v64
  v_fma_f32 v66, v151, v134, v66
  v_fma_f32 v52, v135, v134, v52
  v_mov_b32 v65, s69
  v_mov_b32 v67, s69
  v_mov_b32 v80, v50
  v_mov_b32 v82, v52
  v_mov_b32 v81, s69
  v_mov_b32 v83, s69
  ds_read_b64 v[128:129], v51 offset:10504
  ds_read_b64 v[144:145], v55 offset:12800
  ds_read_b64 v[130:131], v51 offset:10536
  ds_read_b64 v[146:147], v55 offset:14848
  ds_read_b64 v[132:133], v51 offset:10568
  ds_read_b64 v[148:149], v55 offset:16896
  ds_read_b64 v[134:135], v51 offset:10600
  ds_read_b64 v[150:151], v55 offset:18944
  s_waitcnt lgkmcnt(0)
  v_max_f32 v50, v128, v130
  v_max3_f32 v50, v132, v134, v50
  v_sub_f32 v128, v128, v50
  v_sub_f32 v130, v130, v50
  v_sub_f32 v132, v132, v50
  v_sub_f32 v134, v134, v50
  v_mul_f32 v128, s58, v128
  v_mul_f32 v130, s58, v130
  v_mul_f32 v132, s58, v132
  v_mul_f32 v134, s58, v134
  v_exp_f32 v128, v128
  v_exp_f32 v130, v130
  v_exp_f32 v132, v132
  v_exp_f32 v134, v134
  s_nop 0
  v_mul_f32 v68, v144, v128
  v_mul_f32 v70, v145, v128
  v_mul_f32 v52, v129, v128
  v_fma_f32 v68, v146, v130, v68
  v_fma_f32 v70, v147, v130, v70
  v_fma_f32 v52, v131, v130, v52
  v_fma_f32 v68, v148, v132, v68
  v_fma_f32 v70, v149, v132, v70
  v_fma_f32 v52, v133, v132, v52
  v_fma_f32 v68, v150, v134, v68
  v_fma_f32 v70, v151, v134, v70
  v_fma_f32 v52, v135, v134, v52
  v_mov_b32 v69, s69
  v_mov_b32 v71, s69
  v_cndmask_b32 v80, v80, v50, s[72:73]
  v_cndmask_b32 v82, v82, v52, s[72:73]
  ds_read_b64 v[128:129], v51 offset:10512
  ds_read_b64 v[144:145], v55 offset:13312
  ds_read_b64 v[130:131], v51 offset:10544
  ds_read_b64 v[146:147], v55 offset:15360
  ds_read_b64 v[132:133], v51 offset:10576
  ds_read_b64 v[148:149], v55 offset:17408
  ds_read_b64 v[134:135], v51 offset:10608
  ds_read_b64 v[150:151], v55 offset:19456
  s_waitcnt lgkmcnt(0)
  v_max_f32 v50, v128, v130
  v_max3_f32 v50, v132, v134, v50
  v_sub_f32 v128, v128, v50
  v_sub_f32 v130, v130, v50
  v_sub_f32 v132, v132, v50
  v_sub_f32 v134, v134, v50
  v_mul_f32 v128, s58, v128
  v_mul_f32 v130, s58, v130
  v_mul_f32 v132, s58, v132
  v_mul_f32 v134, s58, v134
  v_exp_f32 v128, v128
  v_exp_f32 v130, v130
  v_exp_f32 v132, v132
  v_exp_f32 v134, v134
  s_nop 0
  v_mul_f32 v72, v144, v128
  v_mul_f32 v74, v145, v128
  v_mul_f32 v52, v129, v128
  v_fma_f32 v72, v146, v130, v72
  v_fma_f32 v74, v147, v130, v74
  v_fma_f32 v52, v131, v130, v52
  v_fma_f32 v72, v148, v132, v72
  v_fma_f32 v74, v149, v132, v74
  v_fma_f32 v52, v133, v132, v52
  v_fma_f32 v72, v150, v134, v72
  v_fma_f32 v74, v151, v134, v74
  v_fma_f32 v52, v135, v134, v52
  v_mov_b32 v73, s69
  v_mov_b32 v75, s69
  v_mov_b32 v84, v50
  v_mov_b32 v86, v52
  v_mov_b32 v85, s69
  v_mov_b32 v87, s69
  ds_read_b64 v[128:129], v51 offset:10520
  ds_read_b64 v[144:145], v55 offset:13824
  ds_read_b64 v[130:131], v51 offset:10552
  ds_read_b64 v[146:147], v55 offset:15872
  ds_read_b64 v[132:133], v51 offset:10584
  ds_read_b64 v[148:149], v55 offset:17920
  ds_read_b64 v[134:135], v51 offset:10616
  ds_read_b64 v[150:151], v55 offset:19968
  s_waitcnt lgkmcnt(0)
  v_max_f32 v50, v128, v130
  v_max3_f32 v50, v132, v134, v50
  v_sub_f32 v128, v128, v50
  v_sub_f32 v130, v130, v50
  v_sub_f32 v132, v132, v50
  v_sub_f32 v134, v134, v50
  v_mul_f32 v128, s58, v128
  v_mul_f32 v130, s58, v130
  v_mul_f32 v132, s58, v132
  v_mul_f32 v134, s58, v134
  v_exp_f32 v128, v128
  v_exp_f32 v130, v130
  v_exp_f32 v132, v132
  v_exp_f32 v134, v134
  s_nop 0
  v_mul_f32 v76, v144, v128
  v_mul_f32 v78, v145, v128
  v_mul_f32 v52, v129, v128
  v_fma_f32 v76, v146, v130, v76
  v_fma_f32 v78, v147, v130, v78
  v_fma_f32 v52, v131, v130, v52
  v_fma_f32 v76, v148, v132, v76
  v_fma_f32 v78, v149, v132, v78
  v_fma_f32 v52, v133, v132, v52
  v_fma_f32 v76, v150, v134, v76
  v_fma_f32 v78, v151, v134, v78
  v_fma_f32 v52, v135, v134, v52
  v_mov_b32 v77, s69
  v_mov_b32 v79, s69
  v_cndmask_b32 v84, v84, v50, s[72:73]
  v_cndmask_b32 v86, v86, v52, s[72:73]
  s_lshr_b32 s65, s60, 2
  s_lshl_b32 s65, s65, 5
  s_add_u32 s65, s65, s98
  s_add_u32 s65, s65, 256
  s_lshl_b32 s76, s65, 10
  s_add_u32 s76, s76, 1048576
  s_lshl_b32 s78, s65, 4
  s_add_u32 s78, s78, 131072
L_v_noB:
  v_lshrrev_b32 v88, 3, v1
  v_lshlrev_b32 v88, 7, v88
  s_mov_b32 s59, s60
  s_mov_b32 s28, s52
  s_mov_b32 s29, s53
  s_mov_b32 s30, 0x800
  s_mov_b32 s31, 0x00020000
  v_and_b32 v12, 7, v0
  v_lshlrev_b32 v12, 4, v12
  v_lshlrev_b32 v13, 3, v0
  v_lshlrev_b32 v14, 4, v1
  v_lshl_add_u32 v14, v2, 14, v14
  v_lshlrev_b32 v15, 4, v0
  v_and_b32 v16, 7, v1
  v_lshrrev_b32 v52, 3, v1
  v_lshl_add_u32 v16, v52, 4, v16
  v_lshlrev_b32 v16, 1, v16
  s_lshl_b32 s86, s59, 7
  s_add_u32 s86, s86, 131072
  s_lshl_b32 s84, s59, 13
  s_lshr_b32 s66, s61, 2
  s_lshl_b32 s66, s66, 9
  s_add_u32 s84, s84, s66
  s_add_u32 s84, s84, 1048576
  s_add_u32 s85, s84, 4096
  s_lshr_b32 s67, s59, 5
  s_lshl_b32 s87, s67, 18
  s_add_u32 s87, s87, 2097152
  s_mov_b32 s88, s87
  s_and_b32 s65, s61, 3
  s_lshl_b32 s65, s65, 16
  s_add_u32 s87, s87, s65
  s_lshl_b32 s65, s60, 1
  s_lshr_b32 s66, s61, 2
  s_add_u32 s65, s65, s66
  s_lshl_b32 s65, s65, 8
  s_add_u32 s87, s87, s65
  s_lshr_b32 s68, s2, 4
  s_lshl_b32 s65, s68, 14
  s_add_u32 s88, s88, s65
  s_lshl_b32 s89, s68, 6
  s_lshl_b32 s65, s67, 10
  s_add_u32 s89, s89, s65
  s_and_b32 s65, s68, 7
  s_lshl_b32 s66, s67, 3
  s_add_u32 s65, s65, s66
  s_and_b32 s66, s2, 15
  s_cmp_eq_u32 s65, s66
  s_cselect_b32 s94, 1, 0
  s_barrier
  s_add_u32 s93, s93, s64
  s_mov_b32 s79, s93
  s_sub_u32 s68, s79, 80
  v_mov_b32 v51, 0
  s_mov_b32 s74, 262144
L_cw_53:
  ds_read_b32 v50, v51 offset:10304
  s_waitcnt lgkmcnt(0)
  v_readfirstlane_b32 s65, v50
  s_nop 3
  s_cmp_ge_u32 s65, s68
  s_cbranch_scc1 L_cwok_54
  s_sleep 4
  s_sub_u32 s74, s74, 1
  s_cmp_lg_u32 s74, 0
  s_cbranch_scc1 L_cw_53
L_cwok_54:
  s_memrealtime s[90:91]
  s_mov_b32 s80, s65
  s_waitcnt lgkmcnt(0)
  s_mov_b32 s81, s90
  s_sub_u32 s68, s79, 32
  s_add_u32 s66, s80, 16
  s_max_u32 s68, s68, s66
  s_min_u32 s68, s68, s93
  v_mov_b32 v51, 0
  s_mov_b32 s74, 262144
L_cw_55:
  ds_read_b32 v50, v51 offset:10304
  s_waitcnt lgkmcnt(0)
  v_readfirstlane_b32 s65, v50
  s_nop 3
  s_cmp_ge_u32 s65, s68
  s_cbranch_scc1 L_cwok_56
  s_sleep 4
  s_sub_u32 s74, s74, 1
  s_cmp_lg_u32 s74, 0
  s_cbranch_scc1 L_cw_55
L_cwok_56:
  s_memrealtime s[90:91]
  s_waitcnt lgkmcnt(0)
  s_sub_u32 s66, s65, s80
  s_max_u32 s66, s66, 1
  s_sub_u32 s67, s90, s81
  s_max_u32 s67, s67, 1
  s_sub_u32 s68, s90, s69
  s_sub_i32 s65, s93, s65
  v_cvt_f32_u32 v50, s66
  v_cvt_f32_u32 v51, s67
  v_cvt_f32_u32 v52, s68
  v_cvt_f32_i32 v53, s65
  v_rcp_f32 v54, v51
  v_rcp_f32 v9, v50
  s_nop 0
  v_mul_f32 v40, v50, v54
  v_mul_f32 v9, v9, v51
  v_fma_f32 v42, v53, v9, v52
  v_mov_b32 v41, s69
  v_mov_b32 v43, s69
  s_lshl_b32 s67, s60, 7
  s_add_u32 s67, s67, 98304
  s_lshl_b32 s66, s61, 4
  s_add_u32 s66, s66, s67
  v_mov_b32 v51, 0
  s_mov_b64 exec, 1
  buffer_store_dwordx4 v[40:43], v51, s[16:19], s66 offen sc1
  s_mov_b64 exec, -1
  s_cmp_lt_u32 s61, 6
  s_cbranch_scc1 L_v_pbdone
  buffer_store_dwordx4 v[64:67], v15, s[16:19], s76 offen sc1
  s_add_u32 s76, s76, 8192
  buffer_store_dwordx4 v[68:71], v15, s[16:19], s76 offen sc1
  s_add_u32 s76, s76, 8192
  buffer_store_dwordx4 v[72:75], v15, s[16:19], s76 offen sc1
  s_add_u32 s76, s76, 8192
  buffer_store_dwordx4 v[76:79], v15, s[16:19], s76 offen sc1
  s_mov_b64 exec, 0x101
  buffer_store_dwordx4 v[80:83], v88, s[16:19], s78 offen offset:0 sc1
  buffer_store_dwordx4 v[84:87], v88, s[16:19], s78 offen offset:256 sc1
  s_mov_b64 exec, -1
L_v_pbdone:
  s_mov_b32 s74, 262144
L_poll_57:
  buffer_load_dwordx4 v[60:63], v12, s[16:19], s67 offen sc1
  s_waitcnt vmcnt(0)
  v_xor_b32 v50, s69, v61
  v_xor_b32 v51, s69, v63
  v_or_b32 v50, v50, v51
  v_cmp_ne_u32 vcc, 0, v50
  s_nop 4
  s_cbranch_vccz L_pdone_58
  s_sleep 4
  s_sub_u32 s74, s74, 1
  s_cmp_lg_u32 s74, 0
  s_cbranch_scc1 L_poll_57
L_pdone_58:
  v_mov_b32 v50, v60
  v_mul_f32 v51, v60, v62
  s_nop 1
  v_add_f32_dpp v50, v50, v50 quad_perm:[1,0,3,2] row_mask:0xf bank_mask:0xf
  s_nop 1
  v_add_f32_dpp v50, v50, v50 quad_perm:[2,3,0,1] row_mask:0xf bank_mask:0xf
  s_nop 1
  v_add_f32_dpp v50, v50, v50 row_half_mirror row_mask:0xf bank_mask:0xf
  s_nop 1
  v_add_f32_dpp v51, v51, v51 quad_perm:[1,0,3,2] row_mask:0xf bank_mask:0xf
  s_nop 1
  v_add_f32_dpp v51, v51, v51 quad_perm:[2,3,0,1] row_mask:0xf bank_mask:0xf
  s_nop 1
  v_add_f32_dpp v51, v51, v51 row_half_mirror row_mask:0xf bank_mask:0xf
  v_add_f32 v51, 0x42900000, v51
  v_rcp_f32 v50, v50
  s_nop 0
  v_mul_f32 v51, v51, v50
  v_sub_f32 v51, v51, v62
  v_mul_f32 v51, v51, v60
  v_max_f32 v51, 0, v51
  v_min_f32 v51, 0x45800000, v51
  v_add_f32 v51, 0x3a83126f, v51
  s_nop 1
  v_add_f32_dpp v51, v51, v51 row_shr:1 row_mask:0xf bank_mask:0xf bound_ctrl:0
  s_nop 1
  v_add_f32_dpp v51, v51, v51 row_shr:2 row_mask:0xf bank_mask:0xf bound_ctrl:0
  s_nop 1
  v_add_f32_dpp v51, v51, v51 row_shr:4 row_mask:0xf bank_mask:0xf bound_ctrl:0
  s_nop 1
  v_readlane_b32 s65, v51, 7
  s_nop 1
  v_rcp_f32 v50, s65
  s_nop 0
  v_mul_f32 v50, 0x42900000, v50
  v_mul_f32 v51, v51, v50
  v_rndne_f32 v51, v51
  v_cvt_u32_f32 v51, v51
  v_min_u32 v51, 72, v51
  s_sub_u32 s66, s61, 1
  s_and_b32 s66, s66, 7
  s_nop 1
  v_readlane_b32 s67, v51, s61
  v_readlane_b32 s68, v51, s66
  s_nop 3
  s_cmp_eq_u32 s61, 7
  s_cselect_b32 s67, 72, s67
  s_cmp_eq_u32 s61, 0
  s_cselect_b32 s68, 0, s68
  s_sub_u32 s67, s67, s68
  s_add_u32 s68, s68, 1976
  v_mov_b32 v52, s68
  v_mov_b32 v53, s67
  v_mov_b32 v51, 0
  s_waitcnt lgkmcnt(0)
  ds_write_b64 v51, v[52:53] offset:10320
  s_add_u32 s68, s67, s93
  s_add_u32 s68, s68, -12
  v_mov_b32 v51, 0
  s_mov_b32 s74, 262144
L_cw_59:
  ds_read_b32 v50, v51 offset:10304
  s_waitcnt lgkmcnt(0)
  v_readfirstlane_b32 s65, v50
  s_nop 3
  s_cmp_ge_u32 s65, s68
  s_cbranch_scc1 L_cwok_60
  s_sleep 4
  s_sub_u32 s74, s74, 1
  s_cmp_lg_u32 s74, 0
  s_cbranch_scc1 L_cw_59
L_cwok_60:
  s_mov_b32 s12, s40
  s_mov_b32 s13, s41
  s_mov_b32 s14, 0x400000
  s_mov_b32 s15, 0x00020000
  v_lshlrev_b32 v51, 14, v2
  v_lshl_add_u32 v51, v1, 4, v51
  s_lshl_b32 s65, s60, 17
  s_lshr_b32 s66, s61, 2
  s_lshl_b32 s66, s66, 16
  s_add_u32 s65, s65, s66
  s_and_b32 s66, s61, 3
  s_lshl_b32 s66, s66, 8
  s_add_u32 s65, s65, s66
  buffer_load_dwordx4 v[192:195], v51, s[12:15], s65 offen offset:0 nt
  buffer_load_dwordx4 v[196:199], v51, s[12:15], s65 offen offset:1024 nt
  buffer_load_dwordx4 v[200:203], v51, s[12:15], s65 offen offset:2048 nt
  buffer_load_dwordx4 v[204:207], v51, s[12:15], s65 offen offset:3072 nt
  s_add_u32 s65, s65, 4096
  buffer_load_dwordx4 v[208:211], v51, s[12:15], s65 offen offset:0 nt
  buffer_load_dwordx4 v[212:215], v51, s[12:15], s65 offen offset:1024 nt
  buffer_load_dwordx4 v[216:219], v51, s[12:15], s65 offen offset:2048 nt
  buffer_load_dwordx4 v[220:223], v51, s[12:15], s65 offen offset:3072 nt
  s_add_u32 s65, s65, 4096
  buffer_load_dwordx4 v[224:227], v51, s[12:15], s65 offen offset:0 nt
  buffer_load_dwordx4 v[228:231], v51, s[12:15], s65 offen offset:1024 nt
  buffer_load_dwordx4 v[232:235], v51, s[12:15], s65 offen offset:2048 nt
  buffer_load_dwordx4 v[236:239], v51, s[12:15], s65 offen offset:3072 nt
  s_add_u32 s65, s65, 4096
  buffer_load_dwordx4 v[240:243], v51, s[12:15], s65 offen offset:0 nt
  buffer_load_dwordx4 v[244:247], v51, s[12:15], s65 offen offset:1024 nt
  buffer_load_dwordx4 v[248:251], v51, s[12:15], s65 offen offset:2048 nt
  buffer_load_dwordx4 v[252:255], v51, s[12:15], s65 offen offset:3072 nt
  v_mov_b32 v52, 0
  s_lshl_b32 s65, s60, 3
  s_add_u32 s65, s65, s61
  s_lshl_b32 s66, s65, 4
  s_lshl_b32 s65, s65, 10
  s_add_u32 s65, s65, 1048576
  s_add_u32 s66, s66, 131072
  v_mov_b32 v41, s69
  v_mov_b32 v43, s69
  v_mov_b32 v45, s69
  v_mov_b32 v47, s69
  s_barrier
  ds_read_b64 v[144:145], v52 offset:10240
  ds_read_b64 v[146:147], v52 offset:10248
  ds_read_b64 v[148:149], v52 offset:10256
  ds_read_b64 v[150:151], v52 offset:10264
  ds_read_b64 v[128:129], v13 offset:6144
  ds_read_b64 v[130:131], v13 offset:6656
  ds_read_b64 v[132:133], v13 offset:7168
  ds_read_b64 v[134:135], v13 offset:7680
  s_waitcnt lgkmcnt(4)
  v_max_f32 v44, v144, v146
  v_max3_f32 v44, v148, v150, v44
  v_sub_f32 v144, v144, v44
  v_sub_f32 v146, v146, v44
  v_sub_f32 v148, v148, v44
  v_sub_f32 v150, v150, v44
  v_mul_f32 v144, s58, v144
  v_mul_f32 v146, s58, v146
  v_mul_f32 v148, s58, v148
  v_mul_f32 v150, s58, v150
  v_exp_f32 v144, v144
  v_exp_f32 v146, v146
  v_exp_f32 v148, v148
  v_exp_f32 v150, v150
  s_waitcnt lgkmcnt(0)
  v_mul_f32 v40, v128, v144
  v_mul_f32 v42, v129, v144
  v_mul_f32 v46, v145, v144
  v_fma_f32 v40, v130, v146, v40
  v_fma_f32 v42, v131, v146, v42
  v_fma_f32 v46, v147, v146, v46
  v_fma_f32 v40, v132, v148, v40
  v_fma_f32 v42, v133, v148, v42
  v_fma_f32 v46, v149, v148, v46
  v_fma_f32 v40, v134, v150, v40
  v_fma_f32 v42, v135, v150, v42
  v_fma_f32 v46, v151, v150, v46
  buffer_store_dwordx4 v[40:43], v15, s[16:19], s65 offen sc1
  s_mov_b64 exec, 1
  buffer_store_dwordx4 v[44:47], v52, s[16:19], s66 offen sc1
  s_mov_b64 exec, -1
L_tail:
  s_mov_b32 s74, 262144
L_poll_61:
  buffer_load_dwordx4 v[60:63], v12, s[16:19], s86 offen sc1
  buffer_load_dwordx2 v[128:129], v13, s[16:19], s84 offen offset:0 sc1
  buffer_load_dwordx2 v[130:131], v13, s[16:19], s84 offen offset:1024 sc1
  buffer_load_dwordx2 v[132:133], v13, s[16:19], s84 offen offset:2048 sc1
  buffer_load_dwordx2 v[134:135], v13, s[16:19], s84 offen offset:3072 sc1
  buffer_load_dwordx2 v[136:137], v13, s[16:19], s85 offen offset:0 sc1
  buffer_load_dwordx2 v[138:139], v13, s[16:19], s85 offen offset:1024 sc1
  buffer_load_dwordx2 v[140:141], v13, s[16:19], s85 offen offset:2048 sc1
  buffer_load_dwordx2 v[142:143], v13, s[16:19], s85 offen offset:3072 sc1
  s_waitcnt vmcnt(0)
  v_xor_b32 v50, s69, v61
  v_xor_b32 v51, s69, v63
  v_xor_b32 v9, s69, v129
  v_or3_b32 v50, v50, v51, v9
  v_xor_b32 v51, s69, v131
  v_xor_b32 v9, s69, v133
  v_or3_b32 v50, v50, v51, v9
  v_xor_b32 v51, s69, v135
  v_xor_b32 v9, s69, v137
  v_or3_b32 v50, v50, v51, v9
  v_xor_b32 v51, s69, v139
  v_xor_b32 v9, s69, v141
  v_or3_b32 v50, v50, v51, v9
  v_xor_b32 v51, s69, v143
  v_or_b32 v50, v50, v51
  v_cmp_ne_u32 vcc, 0, v50
  s_nop 4
  s_cbranch_vccz L_pdone_62
  s_sub_u32 s74, s74, 1
  s_cmp_lg_u32 s74, 0
  s_cbranch_scc1 L_poll_61
L_pdone_62:
  v_max_f32_dpp v50, v60, v60 quad_perm:[1,0,3,2] row_mask:0xf bank_mask:0xf
  s_nop 1
  v_max_f32_dpp v50, v50, v50 quad_perm:[2,3,0,1] row_mask:0xf bank_mask:0xf
  s_nop 1
  v_max_f32_dpp v50, v50, v50 row_half_mirror row_mask:0xf bank_mask:0xf
  v_sub_f32 v51, v60, v50
  v_mul_f32 v51, s58, v51
  v_exp_f32 v51, v51
  s_nop 0
  v_mul_f32 v52, v51, v62
  s_nop 0
  v_mul_f32_dpp v53, v51, v128 row_newbcast:0 row_mask:0xf bank_mask:0xf
  v_add_f32_dpp v52, v52, v52 quad_perm:[1,0,3,2] row_mask:0xf bank_mask:0xf
  v_fmac_f32_dpp v53, v51, v130 row_newbcast:1 row_mask:0xf bank_mask:0xf
  v_fmac_f32_dpp v53, v51, v132 row_newbcast:2 row_mask:0xf bank_mask:0xf
  v_add_f32_dpp v52, v52, v52 quad_perm:[2,3,0,1] row_mask:0xf bank_mask:0xf
  v_fmac_f32_dpp v53, v51, v134 row_newbcast:3 row_mask:0xf bank_mask:0xf
  v_fmac_f32_dpp v53, v51, v136 row_newbcast:4 row_mask:0xf bank_mask:0xf
  v_add_f32_dpp v52, v52, v52 row_half_mirror row_mask:0xf bank_mask:0xf
  v_fmac_f32_dpp v53, v51, v138 row_newbcast:5 row_mask:0xf bank_mask:0xf
  v_rcp_f32 v52, v52
  v_fmac_f32_dpp v53, v51, v140 row_newbcast:6 row_mask:0xf bank_mask:0xf
  v_fmac_f32_dpp v53, v51, v142 row_newbcast:7 row_mask:0xf bank_mask:0xf
  v_mul_f32 v53, v53, v52
  v_cvt_pk_bf16_f32 v53, v53, v53
  s_nop 1
  v_and_b32_dpp v144, v53, v5 row_newbcast:0 row_mask:0xf bank_mask:0xf
  v_and_b32_dpp v145, v53, v6 row_newbcast:0 row_mask:0xf bank_mask:0xf
  v_and_b32_dpp v146, v53, v7 row_newbcast:0 row_mask:0xf bank_mask:0xf
  v_and_b32_dpp v147, v53, v8 row_newbcast:0 row_mask:0xf bank_mask:0xf
  v_and_b32_dpp v148, v53, v5 row_newbcast:1 row_mask:0xf bank_mask:0xf
  v_and_b32_dpp v149, v53, v6 row_newbcast:1 row_mask:0xf bank_mask:0xf
  v_and_b32_dpp v150, v53, v7 row_newbcast:1 row_mask:0xf bank_mask:0xf
  v_and_b32_dpp v151, v53, v8 row_newbcast:1 row_mask:0xf bank_mask:0xf
  v_mfma_f32_16x16x32_bf16 v[32:35], v[192:195], v[144:147], 0
  v_and_b32_dpp v152, v53, v5 row_newbcast:2 row_mask:0xf bank_mask:0xf
  v_and_b32_dpp v153, v53, v6 row_newbcast:2 row_mask:0xf bank_mask:0xf
  v_and_b32_dpp v154, v53, v7 row_newbcast:2 row_mask:0xf bank_mask:0xf
  v_and_b32_dpp v155, v53, v8 row_newbcast:2 row_mask:0xf bank_mask:0xf
  v_mfma_f32_16x16x32_bf16 v[36:39], v[196:199], v[148:151], 0
  v_and_b32_dpp v156, v53, v5 row_newbcast:3 row_mask:0xf bank_mask:0xf
  v_and_b32_dpp v157, v53, v6 row_newbcast:3 row_mask:0xf bank_mask:0xf
  v_and_b32_dpp v158, v53, v7 row_newbcast:3 row_mask:0xf bank_mask:0xf
  v_and_b32_dpp v159, v53, v8 row_newbcast:3 row_mask:0xf bank_mask:0xf
  v_mfma_f32_16x16x32_bf16 v[32:35], v[200:203], v[152:155], v[32:35]
  v_and_b32_dpp v144, v53, v5 row_newbcast:4 row_mask:0xf bank_mask:0xf
  v_and_b32_dpp v145, v53, v6 row_newbcast:4 row_mask:0xf bank_mask:0xf
  v_and_b32_dpp v146, v53, v7 row_newbcast:4 row_mask:0xf bank_mask:0xf
  v_and_b32_dpp v147, v53, v8 row_newbcast:4 row_mask:0xf bank_mask:0xf
  v_mfma_f32_16x16x32_bf16 v[36:39], v[204:207], v[156:159], v[36:39]
  v_and_b32_dpp v148, v53, v5 row_newbcast:5 row_mask:0xf bank_mask:0xf
  v_and_b32_dpp v149, v53, v6 row_newbcast:5 row_mask:0xf bank_mask:0xf
  v_and_b32_dpp v150, v53, v7 row_newbcast:5 row_mask:0xf bank_mask:0xf
  v_and_b32_dpp v151, v53, v8 row_newbcast:5 row_mask:0xf bank_mask:0xf
  v_mfma_f32_16x16x32_bf16 v[32:35], v[208:211], v[144:147], v[32:35]
  v_and_b32_dpp v152, v53, v5 row_newbcast:6 row_mask:0xf bank_mask:0xf
  v_and_b32_dpp v153, v53, v6 row_newbcast:6 row_mask:0xf bank_mask:0xf
  v_and_b32_dpp v154, v53, v7 row_newbcast:6 row_mask:0xf bank_mask:0xf
  v_and_b32_dpp v155, v53, v8 row_newbcast:6 row_mask:0xf bank_mask:0xf
  v_mfma_f32_16x16x32_bf16 v[36:39], v[212:215], v[148:151], v[36:39]
  v_and_b32_dpp v156, v53, v5 row_newbcast:7 row_mask:0xf bank_mask:0xf
  v_and_b32_dpp v157, v53, v6 row_newbcast:7 row_mask:0xf bank_mask:0xf
  v_and_b32_dpp v158, v53, v7 row_newbcast:7 row_mask:0xf bank_mask:0xf
  v_and_b32_dpp v159, v53, v8 row_newbcast:7 row_mask:0xf bank_mask:0xf
  v_mfma_f32_16x16x32_bf16 v[32:35], v[216:219], v[152:155], v[32:35]
  v_and_b32_dpp v144, v53, v5 row_newbcast:8 row_mask:0xf bank_mask:0xf
  v_and_b32_dpp v145, v53, v6 row_newbcast:8 row_mask:0xf bank_mask:0xf
  v_and_b32_dpp v146, v53, v7 row_newbcast:8 row_mask:0xf bank_mask:0xf
  v_and_b32_dpp v147, v53, v8 row_newbcast:8 row_mask:0xf bank_mask:0xf
  v_mfma_f32_16x16x32_bf16 v[36:39], v[220:223], v[156:159], v[36:39]
  v_and_b32_dpp v148, v53, v5 row_newbcast:9 row_mask:0xf bank_mask:0xf
  v_and_b32_dpp v149, v53, v6 row_newbcast:9 row_mask:0xf bank_mask:0xf
  v_and_b32_dpp v150, v53, v7 row_newbcast:9 row_mask:0xf bank_mask:0xf
  v_and_b32_dpp v151, v53, v8 row_newbcast:9 row_mask:0xf bank_mask:0xf
  v_mfma_f32_16x16x32_bf16 v[32:35], v[224:227], v[144:147], v[32:35]
  v_and_b32_dpp v152, v53, v5 row_newbcast:10 row_mask:0xf bank_mask:0xf
  v_and_b32_dpp v153, v53, v6 row_newbcast:10 row_mask:0xf bank_mask:0xf
  v_and_b32_dpp v154, v53, v7 row_newbcast:10 row_mask:0xf bank_mask:0xf
  v_and_b32_dpp v155, v53, v8 row_newbcast:10 row_mask:0xf bank_mask:0xf
  v_mfma_f32_16x16x32_bf16 v[36:39], v[228:231], v[148:151], v[36:39]
  v_and_b32_dpp v156, v53, v5 row_newbcast:11 row_mask:0xf bank_mask:0xf
  v_and_b32_dpp v157, v53, v6 row_newbcast:11 row_mask:0xf bank_mask:0xf
  v_and_b32_dpp v158, v53, v7 row_newbcast:11 row_mask:0xf bank_mask:0xf
  v_and_b32_dpp v159, v53, v8 row_newbcast:11 row_mask:0xf bank_mask:0xf
  v_mfma_f32_16x16x32_bf16 v[32:35], v[232:235], v[152:155], v[32:35]
  v_and_b32_dpp v144, v53, v5 row_newbcast:12 row_mask:0xf bank_mask:0xf
  v_and_b32_dpp v145, v53, v6 row_newbcast:12 row_mask:0xf bank_mask:0xf
  v_and_b32_dpp v146, v53, v7 row_newbcast:12 row_mask:0xf bank_mask:0xf
  v_and_b32_dpp v147, v53, v8 row_newbcast:12 row_mask:0xf bank_mask:0xf
  v_mfma_f32_16x16x32_bf16 v[36:39], v[236:239], v[156:159], v[36:39]
  v_and_b32_dpp v148, v53, v5 row_newbcast:13 row_mask:0xf bank_mask:0xf
  v_and_b32_dpp v149, v53, v6 row_newbcast:13 row_mask:0xf bank_mask:0xf
  v_and_b32_dpp v150, v53, v7 row_newbcast:13 row_mask:0xf bank_mask:0xf
  v_and_b32_dpp v151, v53, v8 row_newbcast:13 row_mask:0xf bank_mask:0xf
  v_mfma_f32_16x16x32_bf16 v[32:35], v[240:243], v[144:147], v[32:35]
  v_and_b32_dpp v152, v53, v5 row_newbcast:14 row_mask:0xf bank_mask:0xf
  v_and_b32_dpp v153, v53, v6 row_newbcast:14 row_mask:0xf bank_mask:0xf
  v_and_b32_dpp v154, v53, v7 row_newbcast:14 row_mask:0xf bank_mask:0xf
  v_and_b32_dpp v155, v53, v8 row_newbcast:14 row_mask:0xf bank_mask:0xf
  v_mfma_f32_16x16x32_bf16 v[36:39], v[244:247], v[148:151], v[36:39]
  v_and_b32_dpp v156, v53, v5 row_newbcast:15 row_mask:0xf bank_mask:0xf
  v_and_b32_dpp v157, v53, v6 row_newbcast:15 row_mask:0xf bank_mask:0xf
  v_and_b32_dpp v158, v53, v7 row_newbcast:15 row_mask:0xf bank_mask:0xf
  v_and_b32_dpp v159, v53, v8 row_newbcast:15 row_mask:0xf bank_mask:0xf
  v_mfma_f32_16x16x32_bf16 v[32:35], v[248:251], v[152:155], v[32:35]
  v_mfma_f32_16x16x32_bf16 v[36:39], v[252:255], v[156:159], v[36:39]
  v_mov_b32 v41, s69
  v_mov_b32 v43, s69
  s_nop 6
  v_add_f32 v32, v32, v36
  v_add_f32 v33, v33, v37
  v_add_f32 v34, v34, v38
  v_add_f32 v35, v35, v39
  v_cndmask_b32 v40, v32, v34, s[72:73]
  v_cndmask_b32 v42, v33, v35, s[72:73]
  buffer_store_dwordx4 v[40:43], v14, s[16:19], s87 offen sc1
L_tail2:
  s_cmp_eq_u32 s94, 0
  s_cbranch_scc1 L_tail_end
  s_add_u32 s65, s88, 4096
  s_add_u32 s66, s88, 8192
  s_add_u32 s67, s88, 12288
  s_mov_b32 s74, 262144
L_poll_63:
  buffer_load_dwordx4 v[128:131], v15, s[16:19], s88 offen offset:0 sc1
  buffer_load_dwordx4 v[132:135], v15, s[16:19], s88 offen offset:1024 sc1
  buffer_load_dwordx4 v[136:139], v15, s[16:19], s88 offen offset:2048 sc1
  buffer_load_dwordx4 v[140:143], v15, s[16:19], s88 offen offset:3072 sc1
  buffer_load_dwordx4 v[144:147], v15, s[16:19], s65 offen offset:0 sc1
  buffer_load_dwordx4 v[148:151], v15, s[16:19], s65 offen offset:1024 sc1
  buffer_load_dwordx4 v[152:155], v15, s[16:19], s65 offen offset:2048 sc1
  buffer_load_dwordx4 v[156:159], v15, s[16:19], s65 offen offset:3072 sc1
  buffer_load_dwordx4 v[160:163], v15, s[16:19], s66 offen offset:0 sc1
  buffer_load_dwordx4 v[164:167], v15, s[16:19], s66 offen offset:1024 sc1
  buffer_load_dwordx4 v[168:171], v15, s[16:19], s66 offen offset:2048 sc1
  buffer_load_dwordx4 v[172:175], v15, s[16:19], s66 offen offset:3072 sc1
  buffer_load_dwordx4 v[176:179], v15, s[16:19], s67 offen offset:0 sc1
  buffer_load_dwordx4 v[180:183], v15, s[16:19], s67 offen offset:1024 sc1
  buffer_load_dwordx4 v[184:187], v15, s[16:19], s67 offen offset:2048 sc1
  buffer_load_dwordx4 v[188:191], v15, s[16:19], s67 offen offset:3072 sc1
  s_waitcnt vmcnt(0)
  v_xor_b32 v50, s69, v129
  v_xor_b32 v51, s69, v131
  v_xor_b32 v9, s69, v133
  v_or3_b32 v50, v50, v51, v9
  v_xor_b32 v51, s69, v135
  v_xor_b32 v9, s69, v137
  v_or3_b32 v50, v50, v51, v9
  v_xor_b32 v51, s69, v139
  v_xor_b32 v9, s69, v141
  v_or3_b32 v50, v50, v51, v9
  v_xor_b32 v51, s69, v143
  v_xor_b32 v9, s69, v145
  v_or3_b32 v50, v50, v51, v9
  v_xor_b32 v51, s69, v147
  v_xor_b32 v9, s69, v149
  v_or3_b32 v50, v50, v51, v9
  v_xor_b32 v51, s69, v151
  v_xor_b32 v9, s69, v153
  v_or3_b32 v50, v50, v51, v9
  v_xor_b32 v51, s69, v155
  v_xor_b32 v9, s69, v157
  v_or3_b32 v50, v50, v51, v9
  v_xor_b32 v51, s69, v159
  v_xor_b32 v9, s69, v161
  v_or3_b32 v50, v50, v51, v9
  v_xor_b32 v51, s69, v163
  v_xor_b32 v9, s69, v165
  v_or3_b32 v50, v50, v51, v9
  v_xor_b32 v51, s69, v167
  v_xor_b32 v9, s69, v169
  v_or3_b32 v50, v50, v51, v9
  v_xor_b32 v51, s69, v171
  v_xor_b32 v9, s69, v173
  v_or3_b32 v50, v50, v51, v9
  v_xor_b32 v51, s69, v175
  v_xor_b32 v9, s69, v177
  v_or3_b32 v50, v50, v51, v9
  v_xor_b32 v51, s69, v179
  v_xor_b32 v9, s69, v181
  v_or3_b32 v50, v50, v51, v9
  v_xor_b32 v51, s69, v183
  v_xor_b32 v9, s69, v185
  v_or3_b32 v50, v50, v51, v9
  v_xor_b32 v51, s69, v187
  v_xor_b32 v9, s69, v189
  v_or3_b32 v50, v50, v51, v9
  v_xor_b32 v51, s69, v191
  v_or_b32 v50, v50, v51
  v_cmp_ne_u32 vcc, 0, v50
  s_nop 4
  s_cbranch_vccz L_pdone_64
  s_sub_u32 s74, s74, 1
  s_cmp_lg_u32 s74, 0
  s_cbranch_scc1 L_poll_63
L_pdone_64:
  v_add_f32 v128, v128, v160
  v_add_f32 v130, v130, v162
  v_add_f32 v132, v132, v164
  v_add_f32 v134, v134, v166
  v_add_f32 v136, v136, v168
  v_add_f32 v138, v138, v170
  v_add_f32 v140, v140, v172
  v_add_f32 v142, v142, v174
  v_add_f32 v144, v144, v176
  v_add_f32 v146, v146, v178
  v_add_f32 v148, v148, v180
  v_add_f32 v150, v150, v182
  v_add_f32 v152, v152, v184
  v_add_f32 v154, v154, v186
  v_add_f32 v156, v156, v188
  v_add_f32 v158, v158, v190
  v_add_f32 v128, v128, v132
  v_add_f32 v130, v130, v134
  v_add_f32 v128, v128, v136
  v_add_f32 v130, v130, v138
  v_add_f32 v128, v128, v140
  v_add_f32 v130, v130, v142
  v_add_f32 v128, v128, v144
  v_add_f32 v130, v130, v146
  v_add_f32 v128, v128, v148
  v_add_f32 v130, v130, v150
  v_add_f32 v128, v128, v152
  v_add_f32 v130, v130, v154
  v_add_f32 v128, v128, v156
  v_add_f32 v130, v130, v158
  v_mov_b32 v50, v128
  v_mov_b32 v51, v130
  s_nop 0
  v_permlane16_swap_b32 v128, v50
  v_permlane16_swap_b32 v130, v51
  v_add_f32 v128, v128, v50
  v_add_f32 v130, v130, v51
  v_mov_b32 v50, v128
  v_mov_b32 v51, v130
  s_nop 0
  v_permlane32_swap_b32 v128, v50
  v_permlane32_swap_b32 v130, v51
  v_add_f32 v128, v128, v50
  v_add_f32 v130, v130, v51
  v_cvt_pk_bf16_f32 v50, v128, v130
  s_mov_b64 exec, 0xffff
  buffer_store_short v50, v16, s[28:31], s89 offen
  buffer_store_short_d16_hi v50, v16, s[28:31], s89 offen offset:16
  s_mov_b64 exec, -1
L_tail_end:
  s_endpgm
L_end:
  s_endpgm
.section .rodata,"a"
.p2align 6
.amdhsa_kernel concat_heads__mha_block_cached__sliding_block_cached__decode_kernel
  .amdhsa_next_free_vgpr 256
  .amdhsa_next_free_sgpr 102
  .amdhsa_accum_offset 256
  .amdhsa_group_segment_fixed_size 0
  .amdhsa_kernarg_size 104
  .amdhsa_user_sgpr_count 2
  .amdhsa_user_sgpr_kernarg_segment_ptr 1
  .amdhsa_system_sgpr_workgroup_id_x 1
.end_amdhsa_kernel
```
